```python
import torch

def _softmax(x, axis=-1):
    return torch.softmax(x, dim=axis)
def _gelu(x):
    return torch.nn.functional.gelu(x, approximate="tanh")
def _silu(x):
    return torch.nn.functional.silu(x)
def _sigmoid(x):
    return torch.sigmoid(x)
def _layernorm(x, axis=-1, eps=1e-5):
    m = x.mean(dim=axis, keepdim=True)
    v = x.var(dim=axis, keepdim=True, unbiased=False)
    return (x - m) / torch.sqrt(v + eps)
def _scatter_add(tgt, idx, src, axis=0):
    return tgt.clone().index_add_(axis, idx, src)
def _segment_sum(src, seg, n):
    out = torch.zeros((n,) + src.shape[1:], dtype=src.dtype)
    return out.index_add_(0, seg, src)
def _pad(x, pw):
    flat = tuple(v for pair in reversed(pw) for v in pair)
    return torch.nn.functional.pad(x, flat)

kernel_name = 'parallel_sum__linear_attn_block__dense_activation_squared_relu__prompt'

def setup_inputs():

    _w = (lambda a: (lambda t: t.to(torch.bfloat16) if t.is_floating_point() else t)(torch.as_tensor(a)))
    def _A_setup():
        B, S, D = 1, 2048, 512
        return {
            "x": _w((lambda *s: torch.randn(*s, dtype=torch.bfloat16) * 0.05)(B, S, D)),
            "wqkv": _w((lambda *s: torch.randn(*s, dtype=torch.bfloat16) * 0.4)(D, 3 * D)),
            "wo": _w((lambda *s: torch.randn(*s, dtype=torch.bfloat16) * 0.2)(D, D)),
        }
    _A_in = _A_setup()

    def _B_setup():
        B, S, D, F = 1, 2048, 512, 1376
        return {
            "x": _w((lambda *s: torch.randn(*s, dtype=torch.bfloat16) * 0.05)(B, S, D)),
            "w1": _w((lambda *s: torch.randn(*s, dtype=torch.bfloat16) * 0.05)(D, F)),
            "b1": _w((lambda *s: torch.randn(*s, dtype=torch.bfloat16) * 0.2)(F)),
            "w2": _w((lambda *s: torch.randn(*s, dtype=torch.bfloat16) * 0.05)(F, D)),
            "b2": _w((lambda *s: torch.randn(*s, dtype=torch.bfloat16) * 0.8)(D)),
        }
    _B_in = _B_setup()

    return {
        "A_x": _A_in["x"],
        "A_wqkv": _A_in["wqkv"],
        "A_wo": _A_in["wo"],
        "B_x": _B_in["x"],
        "B_w1": _B_in["w1"],
        "B_b1": _B_in["b1"],
        "B_w2": _B_in["w2"],
        "B_b2": _B_in["b2"],
    }

def reference(A_x, A_wqkv, A_wo, B_x, B_w1, B_b1, B_w2, B_b2):
    def _A_ref(x, wqkv, wo):
        B, S, D = x.shape
        H = 32; Dh = D // H
        qkv = (lambda x, *d: x.permute(*d))((x @ wqkv).reshape(B, S, 3, H, Dh), 2, 0, 3, 1, 4)
        q, k, v = qkv[0], qkv[1], qkv[2]
        phi = lambda t: torch.where(t > 0, t + 1, torch.exp(t)) + 1e-6
        pq, pk = phi(q), phi(k)
        kv = torch.einsum("bhsd,bhse->bhde", pk, v)
        z = torch.einsum("bhsd->bhd", pk)
        num = torch.einsum("bhqd,bhde->bhqe", pq, kv)
        den = torch.einsum("bhqd,bhd->bhq", pq, z)[..., None] + 1e-6
        o = num / den
        return (lambda x, *d: x.permute(*d))(o, 0, 2, 1, 3).reshape(B, S, D) @ wo

    def _B_ref(x, w1, b1, w2, b2):
        h = torch.einsum("bsd,df->bsf", x, w1) + b1
        zero = torch.zeros_like(h)
        r = torch.where(h > zero, h, zero)
        h = r * r
        out = torch.einsum("bsf,fd->bsd", h, w2) + b2
        return out

    x = A_x
    xn = _layernorm(x, axis=-1)
    return x + _A_ref(xn, A_wqkv, A_wo) + _B_ref(xn, B_w1, B_b1, B_w2, B_b2)
```

```asm
; @launch grid=(256,1,1) block=(512,1,1) lds=163840
.amdgcn_target "amdgcn-amd-amdhsa--gfx950"
.text
.globl parallel_sum__linear_attn_block__dense_activation_squared_relu__prompt_kernel
.p2align 8
.type parallel_sum__linear_attn_block__dense_activation_squared_relu__prompt_kernel,@function
parallel_sum__linear_attn_block__dense_activation_squared_relu__prompt_kernel:
    s_cmp_ge_u32 s2, 256
    s_cbranch_scc0 L_go
    s_endpgm
L_go:
    s_load_dwordx16 s[4:19], s[0:1], 0
    s_load_dwordx4 s[20:23], s[0:1], 64
    s_load_dwordx2 s[24:25], s[0:1], 80
    s_getpc_b64 s[80:81]
L_pc:
    s_lshr_b32 s82, s2, 3
    v_lshlrev_b32 v2, 7, v0
    v_lshl_add_u32 v2, s82, 7, v2
    v_min_u32 v2, L_end-L_pc-4, v2
    s_mov_b32 exec_lo, 1
    s_mov_b32 exec_hi, 1
    global_load_dword v253, v2, s[80:81]
    s_mov_b64 exec, -1
    v_lshrrev_b32 v1, 6, v0
    v_and_b32 v0, 63, v0
    v_readfirstlane_b32 s3, v1
    s_and_b32 s80, s2, 1
    s_bfe_u32 s81, s2, 0x20001
    s_lshr_b32 s82, s2, 3
    s_and_b32 s26, s82, 7
    s_lshl3_add_u32 s26, s80, s26
    s_bfe_u32 s28, s82, 0x10003
    s_lshr_b32 s27, s82, 4
    s_lshl1_add_u32 s27, s81, s27
    s_bfe_u32 s84, s2, 0x10001
    s_lshl1_add_u32 s29, s26, s84
    s_bfe_u32 s84, s2, 0x10002
    s_lshr_b32 s30, s82, 3
    s_lshl2_add_u32 s30, s84, s30
    s_xor_b32 s30, s30, 4
    s_and_b32 s31, s3, 3
    s_mul_i32 s83, s27, 11
    s_add_u32 s83, s83, 1
    s_lshr_b32 s83, s83, 1
    s_min_u32 s83, s83, 38
    s_cmp_ge_u32 s3, 4
    s_cbranch_scc1 L_Lpro
    s_lshl1_add_u32 s82, s27, s28
    s_lshl4_add_u32 s82, s26, s82
    s_lshl2_add_u32 s82, s82, s31
    s_lshl_b32 s82, s82, 11
    v_lshlrev_b32 v250, 4, v0
    v_and_b32 v240, 32, v0
    v_lshl_add_u32 v240, v240, 4, v250
    s_mov_b32 s38, 2097152
    s_mov_b32 s39, 0x20000
    s_waitcnt lgkmcnt(0)
    s_mov_b64 s[36:37], s[4:5]
    buffer_load_dwordx4 v[144:147], v240, s[36:39], s82 offen offset:0
    buffer_load_dwordx4 v[148:151], v240, s[36:39], s82 offen offset:512
    s_branch L_C
L_Lpro:
    v_lshrrev_b32 v210, 3, v0
    v_and_b32 v206, 7, v0
    v_lshrrev_b32 v207, 4, v0
    v_xor_b32 v208, v206, v207
    v_lshlrev_b32 v208, 4, v208
    v_lshl_add_u32 v196, v210, 10, v208
    v_xor_b32 v197, 0x2040, v196
    v_add_u32 v198, 0x4000, v196
    v_add_u32 v199, 0x4000, v197
    v_and_b32 v207, 1, v207
    v_lshlrev_b32 v206, 4, v206
    v_lshlrev_b32 v208, 5, v207
    v_xor_b32 v208, v206, v208
    s_xor_b32 s92, s31, s26
    s_and_b32 s92, s92, 1
    s_lshl_b32 s80, s92, 6
    v_xor_b32 v208, s80, v208
    v_xor_b32 v209, 64, v208
    s_lshl_b32 s80, s27, 7
    s_lshl_b32 s81, s83, 6
    s_movk_i32 s84, 2752
    s_movk_i32 s82, 0x80
    s_cmp_eq_u32 s28, 0
    s_cmovk_i32 s84, 3072
    s_cselect_b32 s80, s80, s81
    s_cselect_b32 s81, 0x400, 0
    s_cmovk_i32 s82, 0x800
    s_cselect_b32 s91, 0, 0x100
    s_add_u32 s81, s81, s80
    s_add_u32 s82, s82, s80
    s_add_u32 s80, s91, s80
    s_lshl1_add_u32 s91, s31, s92
    s_lshl_b32 s91, s91, 3
    v_add_u32 v206, s91, v210
    v_xor_b32 v207, 8, v206
    v_mad_u32_u24 v206, s84, v206, v208
    v_mad_u32_u24 v207, s84, v207, v209
    v_add_u32 v200, s81, v206
    v_add_u32 v203, s81, v207
    v_add_u32 v201, s82, v206
    v_add_u32 v204, s82, v207
    v_add_u32 v202, s80, v206
    v_add_u32 v205, s80, v207
    s_bitcmp1_b32 0xea, s27
    s_cselect_b32 s80, s28, 0
    s_lshl_b32 s80, s80, 6
    v_and_b32 v208, s80, v208
    v_and_b32 v209, s80, v209
    v_lshl_add_u32 v202, v208, 24, v202
    v_lshl_add_u32 v205, v209, 24, v205
    s_lshl2_add_u32 s85, s26, s31
    s_lshl_b32 s85, s85, 15
    s_lshl_b32 s86, s31, 12
    s_mul_i32 s87, s31, 6144
    s_add_u32 s87, s87, 65536
    s_lshl_b32 s100, s92, 10
    s_add_u32 s100, s100, s87
    s_xor_b32 s101, s100, 0x400
    s_lshl_b32 s84, s84, 6
    s_lshr_b32 s90, s26, 1
    s_mov_b32 s34, 2097152
    s_mov_b32 s35, 0x20000
    s_mov_b32 s38, 1409024
    s_mov_b32 s39, 0x20000
    s_cmp_eq_u32 s28, 0
    s_cmov_b32 s38, 1572864
    s_waitcnt lgkmcnt(0)
    s_mov_b64 s[32:33], s[4:5]
    s_cselect_b64 s[36:37], s[6:7], s[12:13]
    s_lshl_b32 s88, s90, 7
    s_add_u32 s88, s88, s85
    s_mul_i32 s89, s90, s84
    s_add_u32 s80, s90, 1
    s_and_b32 s80, s80, 3
    s_and_b32 s90, s90, 4
    s_or_b32 s90, s90, s80
    s_add_u32 m0, s86, 0
    s_nop 0
    buffer_load_dwordx4 v196, s[32:35], s88 offen lds
    s_add_u32 m0, s86, 1024
    s_nop 0
    buffer_load_dwordx4 v197, s[32:35], s88 offen lds
    s_add_u32 m0, s86, 2048
    s_nop 0
    buffer_load_dwordx4 v198, s[32:35], s88 offen lds
    s_add_u32 m0, s86, 3072
    s_nop 0
    buffer_load_dwordx4 v199, s[32:35], s88 offen lds
    s_add_u32 m0, s100, 0
    s_nop 0
    buffer_load_dwordx4 v200, s[36:39], s89 offen lds
    s_add_u32 m0, s100, 2048
    s_nop 0
    buffer_load_dwordx4 v201, s[36:39], s89 offen lds
    s_add_u32 m0, s100, 4096
    s_nop 0
    buffer_load_dwordx4 v202, s[36:39], s89 offen lds
    s_mov_b32 s40, s16
    s_mov_b32 s41, s17
    s_mov_b32 s42, 1409024
    s_mov_b32 s43, 0x20000
    s_mov_b32 s44, s8
    s_mov_b32 s45, s9
    s_mov_b32 s46, 524288
    s_mov_b32 s47, 0x20000
    s_mul_i32 s80, s29, 327680
    s_add_u32 s48, s24, s80
    s_addc_u32 s49, s25, 0
    s_mov_b32 s50, 220160
    s_mov_b32 s51, 0x20000
    s_add_u32 s52, s48, 220160
    s_addc_u32 s53, s49, 0
    s_mov_b32 s54, 81920
    s_mov_b32 s55, 0x20000
    s_mov_b32 s56, s20
    s_mov_b32 s57, s21
    s_mov_b32 s58, 2097152
    s_mov_b32 s59, 0x20000
    s_mov_b32 s60, s18
    s_mov_b32 s61, s19
    s_mov_b32 s62, 1024
    s_mov_b32 s63, 0x20000
    s_mov_b32 s68, s22
    s_mov_b32 s69, s23
    s_mov_b32 s70, 256
    s_mov_b32 s71, 0x20000
    s_mov_b32 s72, s24
    s_mov_b32 s73, s25
    s_mov_b32 s74, 11894784
    s_mov_b32 s75, 0x20000
    s_and_b32 s80, s30, 3
    s_lshl3_add_u32 s80, s29, s80
    s_lshl2_add_u32 s80, s80, s31
    s_lshl_b32 s80, s80, 9
    s_add_u32 s80, s80, 10813440
    s_add_u32 s94, s24, s80
    s_addc_u32 s95, s25, 0
    s_load_dword s64, s[94:95], 0 glc
    s_mul_i32 s10, s31, 96
    s_lshl_b32 s11, s83, 6
    s_add_u32 s11, s11, s10
    v_and_b32 v206, 7, v0
    v_and_b32 v207, 6, v210
    v_xor_b32 v207, v206, v207
    s_lshl_b32 s91, s30, 7
    v_lshl_add_u32 v207, v207, 4, s91
    v_lshl_add_u32 v244, v210, 10, v207
    v_add_u32 v245, 7168, v244
    v_and_b32 v208, 4, v210
    v_lshl_add_u32 v246, v208, 10, v244
    v_add_u32 v247, 15360, v246
    s_lshl2_add_u32 s81, s29, s31
    s_lshl_b32 s81, s81, 14
    s_add_u32 s81, s81, s91
    v_lshl_add_u32 v208, v210, 10, s81
    v_lshl_add_u32 v2, v206, 4, v208
    v_xor_b32 v206, v206, v210
    v_lshl_add_u32 v249, v206, 4, v208
    s_lshl_b32 s93, s31, 11
    v_lshrrev_b32 v206, 5, v0
    v_and_b32 v207, 7, v0
    v_xor_b32 v206, v206, v207
    v_lshl_add_u32 v206, v206, 4, s93
    v_and_b32 v207, 15, v0
    v_lshl_add_u32 v206, v207, 7, v206
    v_bfe_u32 v207, v0, 4, 1
    v_lshl_add_u32 v250, v207, 3, v206
    s_sub_u32 s79, s30, s90
    s_add_u32 s79, s79, 1
    s_xor_b32 s80, s30, s90
    s_and_b32 s80, s80, 4
    s_cselect_b32 s79, s30, s79
    s_and_b32 s79, s79, 3
    s_or_b32 s79, s79, s80
    v_and_b32 v206, 7, v0
    v_bfe_u32 v207, v0, 1, 3
    v_xor_b32 v206, v206, v207
    v_lshlrev_b32 v206, 4, v206
    v_xor_b32 v206, v206, v250
    s_and_b32 s80, s29, 1
    s_lshl_b32 s80, s80, 13
    v_add_u32 v12, s80, v206
    v_xor_b32 v13, 32, v12
    v_xor_b32 v14, 64, v12
    v_xor_b32 v15, 96, v12
    v_lshrrev_b32 v206, 2, v0
    v_lshl_add_u32 v206, v206, 7, s93
    v_bfe_u32 v207, v0, 3, 2
    v_lshl_add_u32 v206, v207, 5, v206
    v_and_b32 v207, 3, v0
    v_lshl_add_u32 v236, v207, 3, v206
    v_xor_b32 v237, 32, v236
    v_xor_b32 v238, 64, v236
    v_xor_b32 v239, 96, v236
    v_add_u32 v240, 0x10000, v236
    v_add_u32 v241, 0x10000, v237
    v_add_u32 v242, 0x10000, v238
    v_add_u32 v243, 0x10000, v239
    v_lshlrev_b32 v1, 4, v0
    v_lshrrev_b32 v208, 4, v0
    s_lshl_b32 s80, s31, 7
    s_add_u32 s65, s80, 153088
    v_lshl_add_u32 v208, v208, 3, s65
    v_and_b32 v207, 31, v0
    v_mov_b32 v3, 151552
    s_lshl1_add_u32 s82, s27, s28
    v_and_b32 v62, 15, v0
    s_lshl_b32 s80, s31, 4
    v_add_u32 v63, s80, v62
    v_lshlrev_b32 v60, 2, v63
    v_add_u32 v56, 149504, v60
    v_lshrrev_b32 v209, 4, v0
    v_lshl_add_u32 v60, v209, 8, v60
    v_add_u32 v60, 147968, v60
    s_lshl_b32 s80, s82, 14
    s_add_u32 s80, s80, 11632640
    v_lshl_add_u32 v63, v63, 4, s80
    v_lshl_add_u32 v58, v209, 10, v63
    s_and_b32 s81, s26, 1
    s_lshl2_add_u32 s81, s81, s31
    s_lshl_b32 s81, s81, 3
    v_add_u32 v63, s81, v62
    v_lshlrev_b32 v56, 2, v63
    v_add_u32 v56, 149504, v56
    v_lshl_add_u32 v63, v63, 4, s80
    s_lshr_b32 s80, s26, 1
    s_lshl_b32 s80, s80, 10
    v_add_u32 v57, s80, v63
    s_lshl4_add_u32 s80, s26, s82
    s_lshl_b32 s80, s80, 7
    s_add_u32 s80, s80, 11599872
    s_cmp_eq_u32 s31, 0
    s_cselect_b32 s80, s80, 0x40000000
    v_lshl_add_u32 v63, v62, 4, s80
    v_lshlrev_b32 v62, 2, v62
    v_add_u32 v62, 150528, v62
    v_cmp_lt_u32 vcc, 15, v0
    s_lshl2_add_u32 s80, s26, s31
    s_lshl_b32 s80, s80, 9
    s_add_u32 s80, s80, 11599872
    v_cndmask_b32 v57, v57, v63, vcc
    v_cndmask_b32 v56, v56, v62, vcc
    v_lshl_add_u32 v59, v207, 4, s80
    s_lshl_b32 s80, s31, 7
    s_add_u32 s80, s80, 147456
    s_mov_b32 exec_hi, 0
    v_lshl_add_u32 v60, v207, 2, s80
    s_mov_b32 exec_hi, -1
    s_mov_b32 s26, 0xffff0000
    s_mul_i32 s81, s31, 11
    s_bfe_u32 s82, s29, 196609
    s_mul_i32 s80, s82, 11
    s_lshr_b32 s80, s80, 3
    s_add_u32 s80, s80, s81
    s_add_u32 s83, s81, 11
    s_mul_i32 s27, s82, 1
    s_mov_b32 s92, s80
    s_add_u32 m0, s101, 0
    s_nop 0
    buffer_load_dwordx4 v203, s[36:39], s89 offen lds
    s_add_u32 m0, s101, 2048
    s_nop 0
    buffer_load_dwordx4 v204, s[36:39], s89 offen lds
    s_add_u32 m0, s101, 4096
    s_nop 0
    buffer_load_dwordx4 v205, s[36:39], s89 offen lds
    s_lshl_b32 s88, s90, 7
    s_add_u32 s88, s88, s85
    s_mul_i32 s89, s90, s84
    s_add_u32 s80, s90, 1
    s_and_b32 s80, s80, 3
    s_and_b32 s90, s90, 4
    s_or_b32 s90, s90, s80
    s_add_u32 m0, s86, 16384
    s_nop 0
    buffer_load_dwordx4 v196, s[32:35], s88 offen lds
    s_add_u32 m0, s86, 17408
    s_nop 0
    buffer_load_dwordx4 v197, s[32:35], s88 offen lds
    s_add_u32 m0, s86, 18432
    s_nop 0
    buffer_load_dwordx4 v198, s[32:35], s88 offen lds
    s_add_u32 m0, s86, 19456
    s_nop 0
    buffer_load_dwordx4 v199, s[32:35], s88 offen lds
    s_add_u32 m0, s100, 24576
    s_nop 0
    buffer_load_dwordx4 v200, s[36:39], s89 offen lds
    s_add_u32 m0, s100, 26624
    s_nop 0
    buffer_load_dwordx4 v201, s[36:39], s89 offen lds
    s_add_u32 m0, s100, 28672
    s_nop 0
    buffer_load_dwordx4 v202, s[36:39], s89 offen lds
    s_add_u32 m0, s101, 24576
    s_nop 0
    buffer_load_dwordx4 v203, s[36:39], s89 offen lds
    s_add_u32 m0, s101, 26624
    s_nop 0
    buffer_load_dwordx4 v204, s[36:39], s89 offen lds
    s_add_u32 m0, s101, 28672
    s_nop 0
    buffer_load_dwordx4 v205, s[36:39], s89 offen lds
    s_cmp_eq_u32 s28, 0
    s_cbranch_scc1 L_L_attn
    s_branch L_L_mlp
    .p2align 12
    .fill 862, 4, 0xbf810000
L_L_mlp:
    s_waitcnt vmcnt(10)
    s_barrier
    s_mov_b32 m0, s65
    s_mov_b64 exec, 0xff
    buffer_load_dwordx4 v1, s[60:63], s91 offen lds
    s_mov_b64 s[60:61], s[14:15]
    s_movk_i32 s62, 2752
    s_add_u32 m0, s10, 152576
    s_mov_b64 exec, 0x3f
    buffer_load_dwordx4 v1, s[60:63], s11 offen lds
    s_mov_b64 exec, -1
    s_lshl_b32 s88, s90, 7
    s_add_u32 s88, s88, s85
    s_mul_i32 s89, s90, s84
    s_add_u32 s80, s90, 1
    s_and_b32 s80, s80, 3
    s_and_b32 s90, s90, 4
    s_or_b32 s90, s90, s80
    s_add_u32 m0, s86, 32768
    s_nop 0
    buffer_load_dwordx4 v196, s[32:35], s88 offen lds
    s_add_u32 m0, s86, 33792
    s_nop 0
    buffer_load_dwordx4 v197, s[32:35], s88 offen lds
    s_add_u32 m0, s86, 34816
    s_nop 0
    buffer_load_dwordx4 v198, s[32:35], s88 offen lds
    s_add_u32 m0, s86, 35840
    s_nop 0
    buffer_load_dwordx4 v199, s[32:35], s88 offen lds
    s_add_u32 m0, s100, 49152
    s_nop 0
    buffer_load_dwordx4 v200, s[36:39], s89 offen lds
    s_add_u32 m0, s100, 51200
    s_nop 0
    buffer_load_dwordx4 v201, s[36:39], s89 offen lds
    s_add_u32 m0, s100, 53248
    s_nop 0
    buffer_load_dwordx4 v202, s[36:39], s89 offen lds
    s_add_u32 m0, s101, 49152
    s_nop 0
    buffer_load_dwordx4 v203, s[36:39], s89 offen lds
    s_cmp_eq_u32 s79, 0
    s_cbranch_scc0 L_xr_1
    ds_read_b64 v[20:21], v12 offset:0
    ds_read_b64 v[22:23], v13 offset:0
    ds_read_b64 v[24:25], v14 offset:0
    ds_read_b64 v[26:27], v15 offset:0
    s_waitcnt lgkmcnt(0)
L_xr_1:
    s_add_u32 m0, s101, 51200
    s_nop 0
    buffer_load_dwordx4 v204, s[36:39], s89 offen lds
    s_add_u32 m0, s101, 53248
    s_nop 0
    buffer_load_dwordx4 v205, s[36:39], s89 offen lds
    s_waitcnt vmcnt(12)
    s_barrier
    s_mov_b64 exec, 1
    buffer_load_dword v248, off, s[68:71], 0 sc1
    s_mov_b64 exec, -1
    s_lshl_b32 s88, s90, 7
    s_add_u32 s88, s88, s85
    s_mul_i32 s89, s90, s84
    s_andn2_b32 s90, 4, s90
    s_add_u32 m0, s86, 0
    s_nop 0
    buffer_load_dwordx4 v196, s[32:35], s88 offen lds
    s_add_u32 m0, s86, 1024
    s_nop 0
    buffer_load_dwordx4 v197, s[32:35], s88 offen lds
    s_add_u32 m0, s86, 2048
    s_nop 0
    buffer_load_dwordx4 v198, s[32:35], s88 offen lds
    s_add_u32 m0, s86, 3072
    s_nop 0
    buffer_load_dwordx4 v199, s[32:35], s88 offen lds
    s_add_u32 m0, s100, 0
    s_nop 0
    buffer_load_dwordx4 v200, s[36:39], s89 offen lds
    s_add_u32 m0, s100, 2048
    s_nop 0
    buffer_load_dwordx4 v201, s[36:39], s89 offen lds
    s_add_u32 m0, s100, 4096
    s_nop 0
    buffer_load_dwordx4 v202, s[36:39], s89 offen lds
    s_add_u32 m0, s101, 0
    s_nop 0
    buffer_load_dwordx4 v203, s[36:39], s89 offen lds
    s_cmp_eq_u32 s79, 1
    s_cbranch_scc0 L_xr_2
    ds_read_b64 v[20:21], v12 offset:16384
    ds_read_b64 v[22:23], v13 offset:16384
    ds_read_b64 v[24:25], v14 offset:16384
    ds_read_b64 v[26:27], v15 offset:16384
    s_waitcnt lgkmcnt(0)
L_xr_2:
    s_add_u32 m0, s101, 2048
    s_nop 0
    buffer_load_dwordx4 v204, s[36:39], s89 offen lds
    s_add_u32 m0, s101, 4096
    s_nop 0
    buffer_load_dwordx4 v205, s[36:39], s89 offen lds
    s_waitcnt vmcnt(11)
    s_barrier
    ds_read_b64 v[28:29], v208 offset:0
    ds_read_b64 v[30:31], v208 offset:32
    ds_read_b64 v[32:33], v208 offset:64
    ds_read_b64 v[34:35], v208 offset:96
    ds_read2_b32 v[4:5], v56 offset0:0 offset1:64
    ds_read_b32 v6, v56 offset:512
    s_lshl_b32 s88, s90, 7
    s_add_u32 s88, s88, s85
    s_mul_i32 s89, s90, s84
    s_add_u32 s90, s90, 1
    s_and_b32 s90, s90, 7
    s_add_u32 m0, s86, 16384
    s_nop 0
    buffer_load_dwordx4 v196, s[32:35], s88 offen lds
    s_add_u32 m0, s86, 17408
    s_nop 0
    buffer_load_dwordx4 v197, s[32:35], s88 offen lds
    s_add_u32 m0, s86, 18432
    s_nop 0
    buffer_load_dwordx4 v198, s[32:35], s88 offen lds
    s_add_u32 m0, s86, 19456
    s_nop 0
    buffer_load_dwordx4 v199, s[32:35], s88 offen lds
    s_waitcnt vmcnt(14)
    v_readfirstlane_b32 s60, v248
    s_nop 0
    s_cmp_eq_u32 s60, 0
    s_cbranch_scc1 L_tag_wait_m
L_tag_ok_m:
    s_mov_b32 s61, s60
    v_mov_b32 v7, s60
    s_waitcnt lgkmcnt(0)
    s_mov_b64 exec, 0xff00ff
    buffer_store_dwordx4 v[4:7], v57, s[72:75], 0 offen sc1
    s_mov_b64 exec, -1
    v_mov_b32 v55, s60
    s_add_u32 m0, s100, 24576
    s_nop 0
    buffer_load_dwordx4 v200, s[36:39], s89 offen lds
    s_add_u32 m0, s100, 26624
    s_nop 0
    buffer_load_dwordx4 v201, s[36:39], s89 offen lds
    s_add_u32 m0, s100, 28672
    s_nop 0
    buffer_load_dwordx4 v202, s[36:39], s89 offen lds
    s_add_u32 m0, s101, 24576
    s_nop 0
    buffer_load_dwordx4 v203, s[36:39], s89 offen lds
    s_cmp_eq_u32 s79, 2
    s_cbranch_scc0 L_xr_3
    ds_read_b64 v[20:21], v12 offset:32768
    ds_read_b64 v[22:23], v13 offset:32768
    ds_read_b64 v[24:25], v14 offset:32768
    ds_read_b64 v[26:27], v15 offset:32768
    s_waitcnt lgkmcnt(0)
L_xr_3:
    s_add_u32 m0, s101, 26624
    s_nop 0
    buffer_load_dwordx4 v204, s[36:39], s89 offen lds
    s_add_u32 m0, s101, 28672
    s_nop 0
    buffer_load_dwordx4 v205, s[36:39], s89 offen lds
    s_waitcnt vmcnt(11)
    s_barrier
    s_lshl_b32 s88, s90, 7
    s_add_u32 s88, s88, s85
    s_mul_i32 s89, s90, s84
    s_add_u32 s90, s90, 1
    s_and_b32 s90, s90, 7
    s_add_u32 m0, s86, 32768
    s_nop 0
    buffer_load_dwordx4 v196, s[32:35], s88 offen lds
    s_add_u32 m0, s86, 33792
    s_nop 0
    buffer_load_dwordx4 v197, s[32:35], s88 offen lds
    s_add_u32 m0, s86, 34816
    s_nop 0
    buffer_load_dwordx4 v198, s[32:35], s88 offen lds
    s_add_u32 m0, s86, 35840
    s_nop 0
    buffer_load_dwordx4 v199, s[32:35], s88 offen lds
    s_add_u32 m0, s100, 49152
    s_nop 0
    buffer_load_dwordx4 v200, s[36:39], s89 offen lds
    s_add_u32 m0, s100, 51200
    s_nop 0
    buffer_load_dwordx4 v201, s[36:39], s89 offen lds
    s_add_u32 m0, s100, 53248
    s_nop 0
    buffer_load_dwordx4 v202, s[36:39], s89 offen lds
    s_add_u32 m0, s101, 49152
    s_nop 0
    buffer_load_dwordx4 v203, s[36:39], s89 offen lds
    s_cmp_eq_u32 s79, 3
    s_cbranch_scc0 L_xr_4
    ds_read_b64 v[20:21], v12 offset:0
    ds_read_b64 v[22:23], v13 offset:0
    ds_read_b64 v[24:25], v14 offset:0
    ds_read_b64 v[26:27], v15 offset:0
    s_waitcnt lgkmcnt(0)
L_xr_4:
    s_add_u32 m0, s101, 51200
    s_nop 0
    buffer_load_dwordx4 v204, s[36:39], s89 offen lds
    s_add_u32 m0, s101, 53248
    s_nop 0
    buffer_load_dwordx4 v205, s[36:39], s89 offen lds
    s_waitcnt vmcnt(10)
    s_barrier
    s_lshl_b32 s88, s90, 7
    s_add_u32 s88, s88, s85
    s_mul_i32 s89, s90, s84
    s_add_u32 s90, s90, 1
    s_and_b32 s90, s90, 7
    s_add_u32 m0, s86, 0
    s_nop 0
    buffer_load_dwordx4 v196, s[32:35], s88 offen lds
    s_add_u32 m0, s86, 1024
    s_nop 0
    buffer_load_dwordx4 v197, s[32:35], s88 offen lds
    s_add_u32 m0, s86, 2048
    s_nop 0
    buffer_load_dwordx4 v198, s[32:35], s88 offen lds
    s_add_u32 m0, s86, 3072
    s_nop 0
    buffer_load_dwordx4 v199, s[32:35], s88 offen lds
    s_add_u32 m0, s100, 0
    s_nop 0
    buffer_load_dwordx4 v200, s[36:39], s89 offen lds
    s_add_u32 m0, s100, 2048
    s_nop 0
    buffer_load_dwordx4 v201, s[36:39], s89 offen lds
    s_add_u32 m0, s100, 4096
    s_nop 0
    buffer_load_dwordx4 v202, s[36:39], s89 offen lds
    s_add_u32 m0, s101, 0
    s_nop 0
    buffer_load_dwordx4 v203, s[36:39], s89 offen lds
    s_cmp_eq_u32 s79, 4
    s_cbranch_scc0 L_xr_5
    ds_read_b64 v[20:21], v12 offset:16384
    ds_read_b64 v[22:23], v13 offset:16384
    ds_read_b64 v[24:25], v14 offset:16384
    ds_read_b64 v[26:27], v15 offset:16384
    s_waitcnt lgkmcnt(0)
L_xr_5:
    s_add_u32 m0, s101, 2048
    s_nop 0
    buffer_load_dwordx4 v204, s[36:39], s89 offen lds
    s_add_u32 m0, s101, 4096
    s_nop 0
    buffer_load_dwordx4 v205, s[36:39], s89 offen lds
    s_waitcnt vmcnt(10)
    s_barrier
    s_mov_b32 exec_hi, 0
    buffer_load_dwordx4 v[52:55], v59, s[72:75], 0 offen sc1
    s_mov_b32 exec_hi, -1
    s_movk_i32 s82, 0
    buffer_load_dwordx4 v[36:39], v58, s[72:75], s82 offen sc1
    s_movk_i32 s82, 4096
    buffer_load_dwordx4 v[40:43], v58, s[72:75], s82 offen sc1
    s_lshl_b32 s88, s90, 7
    s_add_u32 s88, s88, s85
    s_mul_i32 s89, s90, s84
    s_add_u32 s90, s90, 1
    s_and_b32 s90, s90, 7
    s_add_u32 m0, s86, 16384
    s_nop 0
    buffer_load_dwordx4 v196, s[32:35], s88 offen lds
    s_add_u32 m0, s86, 17408
    s_nop 0
    buffer_load_dwordx4 v197, s[32:35], s88 offen lds
    s_add_u32 m0, s86, 18432
    s_nop 0
    buffer_load_dwordx4 v198, s[32:35], s88 offen lds
    s_add_u32 m0, s86, 19456
    s_nop 0
    buffer_load_dwordx4 v199, s[32:35], s88 offen lds
    s_add_u32 m0, s100, 24576
    s_nop 0
    buffer_load_dwordx4 v200, s[36:39], s89 offen lds
    s_add_u32 m0, s100, 26624
    s_nop 0
    buffer_load_dwordx4 v201, s[36:39], s89 offen lds
    s_add_u32 m0, s100, 28672
    s_nop 0
    buffer_load_dwordx4 v202, s[36:39], s89 offen lds
    s_add_u32 m0, s101, 24576
    s_nop 0
    buffer_load_dwordx4 v203, s[36:39], s89 offen lds
    s_cmp_eq_u32 s79, 5
    s_cbranch_scc0 L_xr_6
    ds_read_b64 v[20:21], v12 offset:32768
    ds_read_b64 v[22:23], v13 offset:32768
    ds_read_b64 v[24:25], v14 offset:32768
    ds_read_b64 v[26:27], v15 offset:32768
    s_waitcnt lgkmcnt(0)
L_xr_6:
    s_add_u32 m0, s101, 26624
    s_nop 0
    buffer_load_dwordx4 v204, s[36:39], s89 offen lds
    s_add_u32 m0, s101, 28672
    s_nop 0
    buffer_load_dwordx4 v205, s[36:39], s89 offen lds
    s_waitcnt vmcnt(13)
    s_barrier
    s_cmp_eq_u32 s79, 6
    s_cbranch_scc0 L_xr_7
    ds_read_b64 v[20:21], v12 offset:0
    ds_read_b64 v[22:23], v13 offset:0
    ds_read_b64 v[24:25], v14 offset:0
    ds_read_b64 v[26:27], v15 offset:0
    s_waitcnt lgkmcnt(0)
L_xr_7:
    s_waitcnt vmcnt(10)
    v_xor_b32 v62, s60, v55
    v_xor_b32 v39, s60, v39
    v_xor_b32 v43, s60, v43
    v_or3_b32 v62, v62, v39, v43
    v_cmp_ne_u32 vcc, 0, v62
    s_nop 0
    s_cmp_lg_u64 vcc, 0
    s_cbranch_scc1 L_gat_wait_m
L_gat_ok_m:
    v_add_f32 v36, v36, v40
    v_add_f32 v37, v37, v41
    v_add_f32 v38, v38, v42
    s_add_u32 m0, s93, 139264
    s_add_u32 s82, s92, 7
    s_cmp_ge_u32 s82, s83
    s_cselect_b32 s80, 11, 0
    s_sub_u32 s82, s82, s80
    s_lshl_b32 s82, s82, 15
    buffer_load_dwordx4 v244, s[40:43], s82 offen lds
    buffer_load_dwordx4 v245, s[40:43], s82 offen offset:1024 lds
    v_mov_b32 v40, v36
    v_mov_b32 v41, v37
    v_mov_b32 v42, v38
    v_permlane32_swap_b32 v36, v40
    v_permlane32_swap_b32 v37, v41
    v_permlane32_swap_b32 v38, v42
    v_add_f32 v36, v36, v40
    v_add_f32 v37, v37, v41
    v_add_f32 v38, v38, v42
    s_add_u32 m0, s93, 155648
    s_add_u32 s82, s92, 7
    s_cmp_ge_u32 s82, s83
    s_cselect_b32 s80, 11, 0
    s_sub_u32 s82, s82, s80
    s_lshl_b32 s82, s82, 15
    s_add_u32 s82, s82, 16384
    buffer_load_dwordx4 v244, s[40:43], s82 offen lds
    buffer_load_dwordx4 v245, s[40:43], s82 offen offset:1024 lds
    v_mov_b32 v40, v36
    v_mov_b32 v41, v37
    v_mov_b32 v42, v38
    v_permlane16_swap_b32 v36, v40
    v_permlane16_swap_b32 v37, v41
    v_permlane16_swap_b32 v38, v42
    v_add_f32 v36, v36, v40
    v_add_f32 v37, v37, v41
    v_add_f32 v38, v38, v42
    s_mov_b32 exec_lo, 0
    v_mov_b32 v52, v36
    v_mov_b32 v53, v37
    s_mov_b32 exec_hi, 0xffff0000
    v_mov_b32 v52, v38
    v_mov_b32 v53, s60
    s_mov_b64 exec, -1
    ds_write2_b32 v60, v52, v53 offset0:0 offset1:128
    s_add_u32 m0, s93, 131072
    s_add_u32 s82, s92, 8
    s_cmp_ge_u32 s82, s83
    s_cselect_b32 s80, 11, 0
    s_sub_u32 s82, s82, s80
    s_lshl_b32 s82, s82, 15
    buffer_load_dwordx4 v244, s[40:43], s82 offen lds
    buffer_load_dwordx4 v245, s[40:43], s82 offen offset:1024 lds
    s_waitcnt vmcnt(6) lgkmcnt(0)
    s_barrier
    s_cmp_eq_u32 s79, 7
    s_cbranch_scc0 L_xr_8
    ds_read_b64 v[20:21], v12 offset:16384
    ds_read_b64 v[22:23], v13 offset:16384
    ds_read_b64 v[24:25], v14 offset:16384
    ds_read_b64 v[26:27], v15 offset:16384
    s_waitcnt lgkmcnt(0)
L_xr_8:
    s_add_u32 m0, s93, 49152
    s_add_u32 s82, s92, 8
    s_cmp_ge_u32 s82, s83
    s_cselect_b32 s80, 11, 0
    s_sub_u32 s82, s82, s80
    s_lshl_b32 s82, s82, 15
    s_add_u32 s82, s82, 16384
    buffer_load_dwordx4 v244, s[40:43], s82 offen lds
    buffer_load_dwordx4 v245, s[40:43], s82 offen offset:1024 lds
    s_add_u32 m0, s93, 57344
    s_add_u32 s82, s27, 0
    s_and_b32 s82, s82, 3
    s_lshl2_add_u32 s82, s31, s82
    s_lshl_b32 s82, s82, 15
    buffer_load_dwordx4 v246, s[44:47], s82 offen lds
    buffer_load_dwordx4 v247, s[44:47], s82 offen offset:1024 lds
    s_add_u32 m0, s93, 32768
    s_add_u32 s82, s27, 0
    s_and_b32 s82, s82, 3
    s_lshl2_add_u32 s82, s31, s82
    s_lshl_b32 s82, s82, 15
    s_add_u32 s82, s82, 4096
    buffer_load_dwordx4 v246, s[44:47], s82 offen lds
    buffer_load_dwordx4 v247, s[44:47], s82 offen offset:1024 lds
    s_waitcnt vmcnt(10)
    v_add_u32 v240, 65536, v240
    v_add_u32 v241, 65536, v241
    v_add_u32 v242, 65536, v242
    v_add_u32 v243, 65536, v243
    ds_read_b64_tr_b16 v[68:69], v240 offset:8192
    ds_read_b64_tr_b16 v[72:73], v241 offset:8192
    ds_read_b64_tr_b16 v[76:77], v242 offset:8192
    ds_read_b64_tr_b16 v[80:81], v243 offset:8192
    s_add_u32 m0, s93, 40960
    s_add_u32 s82, s92, 9
    s_cmp_ge_u32 s82, s83
    s_cselect_b32 s80, 11, 0
    s_sub_u32 s82, s82, s80
    s_lshl_b32 s82, s82, 15
    buffer_load_dwordx4 v244, s[40:43], s82 offen lds
    buffer_load_dwordx4 v245, s[40:43], s82 offen offset:1024 lds
    s_waitcnt vmcnt(10)
    s_waitcnt lgkmcnt(0)
    ds_read_b64_tr_b16 v[70:71], v240 offset:24576
    ds_read_b64_tr_b16 v[74:75], v241 offset:24576
    ds_read_b64_tr_b16 v[78:79], v242 offset:24576
    ds_read_b64_tr_b16 v[82:83], v243 offset:24576
    s_add_u32 m0, s93, 139264
    s_add_u32 s82, s92, 9
    s_cmp_ge_u32 s82, s83
    s_cselect_b32 s80, 11, 0
    s_sub_u32 s82, s82, s80
    s_lshl_b32 s82, s82, 15
    s_add_u32 s82, s82, 16384
    buffer_load_dwordx4 v244, s[40:43], s82 offen lds
    buffer_load_dwordx4 v245, s[40:43], s82 offen offset:1024 lds
    s_waitcnt vmcnt(10)
    s_waitcnt lgkmcnt(0)
    ds_read_b64_tr_b16 v[84:85], v240 offset:0
    ds_read_b64_tr_b16 v[88:89], v241 offset:0
    ds_read_b64_tr_b16 v[92:93], v242 offset:0
    ds_read_b64_tr_b16 v[96:97], v243 offset:0
    s_add_u32 m0, s93, 155648
    s_add_u32 s82, s92, 10
    s_cmp_ge_u32 s82, s83
    s_cselect_b32 s80, 11, 0
    s_sub_u32 s82, s82, s80
    s_lshl_b32 s82, s82, 15
    buffer_load_dwordx4 v244, s[40:43], s82 offen lds
    buffer_load_dwordx4 v245, s[40:43], s82 offen offset:1024 lds
    s_waitcnt vmcnt(10)
    s_waitcnt lgkmcnt(0)
    ds_read_b64_tr_b16 v[86:87], v236 offset:49152
    ds_read_b64_tr_b16 v[90:91], v237 offset:49152
    ds_read_b64_tr_b16 v[94:95], v238 offset:49152
    ds_read_b64_tr_b16 v[98:99], v239 offset:49152
    s_mov_b32 s80, 800000
L_ls_9:
    ds_read_b128 v[164:167], v3 offset:48
    s_sub_u32 s80, s80, 1
    s_cbranch_scc1 L_lsok_10
    s_waitcnt lgkmcnt(0)
    v_and_b32 v164, v164, v165
    v_and_b32 v166, v166, v167
    v_and_b32 v164, v164, v166
    s_nop 0
    v_readfirstlane_b32 s81, v164
    s_nop 0
    s_cmp_eq_u32 s81, 0
    s_waitcnt lgkmcnt(0)
    s_cbranch_scc1 L_ls_9
L_lsok_10:
    s_waitcnt lgkmcnt(0)
    s_add_u32 m0, s93, 131072
    s_add_u32 s82, s92, 10
    s_cmp_ge_u32 s82, s83
    s_cselect_b32 s80, 11, 0
    s_sub_u32 s82, s82, s80
    s_lshl_b32 s82, s82, 15
    s_add_u32 s82, s82, 16384
    buffer_load_dwordx4 v244, s[40:43], s82 offen lds
    buffer_load_dwordx4 v245, s[40:43], s82 offen offset:1024 lds
    s_waitcnt vmcnt(10)
    s_waitcnt lgkmcnt(0)
    ds_read_b64_tr_b16 v[132:133], v236 offset:57344
    ds_read_b64_tr_b16 v[136:137], v237 offset:57344
    ds_read_b64_tr_b16 v[140:141], v238 offset:57344
    ds_read_b64_tr_b16 v[144:145], v239 offset:57344
    s_add_u32 m0, s93, 114688
    s_add_u32 s82, s27, 1
    s_and_b32 s82, s82, 3
    s_lshl2_add_u32 s82, s31, s82
    s_lshl_b32 s82, s82, 15
    buffer_load_dwordx4 v246, s[44:47], s82 offen lds
    buffer_load_dwordx4 v247, s[44:47], s82 offen offset:1024 lds
    s_waitcnt vmcnt(10)
    s_waitcnt lgkmcnt(0)
    ds_read_b64_tr_b16 v[134:135], v236 offset:32768
    ds_read_b64_tr_b16 v[138:139], v237 offset:32768
    ds_read_b64_tr_b16 v[142:143], v238 offset:32768
    ds_read_b64_tr_b16 v[146:147], v239 offset:32768
    s_add_u32 m0, s93, 122880
    s_add_u32 s82, s27, 1
    s_and_b32 s82, s82, 3
    s_lshl2_add_u32 s82, s31, s82
    s_lshl_b32 s82, s82, 15
    s_add_u32 s82, s82, 4096
    buffer_load_dwordx4 v246, s[44:47], s82 offen lds
    buffer_load_dwordx4 v247, s[44:47], s82 offen offset:1024 lds
    s_waitcnt vmcnt(10)
    s_waitcnt lgkmcnt(0)
    ds_read_b64_tr_b16 v[100:101], v236 offset:40960
    ds_read_b64_tr_b16 v[104:105], v237 offset:40960
    ds_read_b64_tr_b16 v[108:109], v238 offset:40960
    ds_read_b64_tr_b16 v[112:113], v239 offset:40960
    s_add_u32 m0, s93, 0
    s_add_u32 s82, s92, 1
    s_cmp_ge_u32 s82, s83
    s_cselect_b32 s80, 11, 0
    s_sub_u32 s82, s82, s80
    s_lshl_b32 s82, s82, 15
    buffer_load_dwordx4 v244, s[40:43], s82 offen lds
    buffer_load_dwordx4 v245, s[40:43], s82 offen offset:1024 lds
    s_waitcnt vmcnt(10)
    s_waitcnt lgkmcnt(0)
    ds_read_b64_tr_b16 v[102:103], v240 offset:8192
    ds_read_b64_tr_b16 v[106:107], v241 offset:8192
    ds_read_b64_tr_b16 v[110:111], v242 offset:8192
    ds_read_b64_tr_b16 v[114:115], v243 offset:8192
    s_add_u32 m0, s93, 8192
    s_add_u32 s82, s92, 1
    s_cmp_ge_u32 s82, s83
    s_cselect_b32 s80, 11, 0
    s_sub_u32 s82, s82, s80
    s_lshl_b32 s82, s82, 15
    s_add_u32 s82, s82, 16384
    buffer_load_dwordx4 v244, s[40:43], s82 offen lds
    buffer_load_dwordx4 v245, s[40:43], s82 offen offset:1024 lds
    s_waitcnt vmcnt(10)
    s_waitcnt lgkmcnt(0)
    ds_read_b64_tr_b16 v[116:117], v240 offset:24576
    ds_read_b64_tr_b16 v[120:121], v241 offset:24576
    ds_read_b64_tr_b16 v[124:125], v242 offset:24576
    ds_read_b64_tr_b16 v[128:129], v243 offset:24576
    s_add_u32 m0, s93, 65536
    s_add_u32 s82, s92, 2
    s_cmp_ge_u32 s82, s83
    s_cselect_b32 s80, 11, 0
    s_sub_u32 s82, s82, s80
    s_lshl_b32 s82, s82, 15
    buffer_load_dwordx4 v244, s[40:43], s82 offen lds
    buffer_load_dwordx4 v245, s[40:43], s82 offen offset:1024 lds
    s_waitcnt vmcnt(10)
    s_waitcnt lgkmcnt(0)
    ds_read_b64_tr_b16 v[118:119], v240 offset:0
    ds_read_b64_tr_b16 v[122:123], v241 offset:0
    ds_read_b64_tr_b16 v[126:127], v242 offset:0
    ds_read_b64_tr_b16 v[130:131], v243 offset:0
    s_add_u32 m0, s93, 73728
    s_add_u32 s82, s92, 2
    s_cmp_ge_u32 s82, s83
    s_cselect_b32 s80, 11, 0
    s_sub_u32 s82, s82, s80
    s_lshl_b32 s82, s82, 15
    s_add_u32 s82, s82, 16384
    buffer_load_dwordx4 v244, s[40:43], s82 offen lds
    buffer_load_dwordx4 v245, s[40:43], s82 offen offset:1024 lds
    s_waitcnt vmcnt(10)
    s_waitcnt lgkmcnt(0)
    v_add_u32 v236, 65536, v236
    v_add_u32 v237, 65536, v237
    v_add_u32 v238, 65536, v238
    v_add_u32 v239, 65536, v239
    ds_read_b64_tr_b16 v[148:149], v236 offset:49152
    ds_read_b64_tr_b16 v[152:153], v237 offset:49152
    ds_read_b64_tr_b16 v[156:157], v238 offset:49152
    ds_read_b64_tr_b16 v[160:161], v239 offset:49152
    s_add_u32 m0, s93, 81920
    s_add_u32 s82, s92, 3
    s_cmp_ge_u32 s82, s83
    s_cselect_b32 s80, 11, 0
    s_sub_u32 s82, s82, s80
    s_lshl_b32 s82, s82, 15
    buffer_load_dwordx4 v244, s[40:43], s82 offen lds
    buffer_load_dwordx4 v245, s[40:43], s82 offen offset:1024 lds
    s_waitcnt vmcnt(10)
    s_waitcnt lgkmcnt(0)
    ds_read_b64_tr_b16 v[150:151], v236 offset:57344
    ds_read_b64_tr_b16 v[154:155], v237 offset:57344
    ds_read_b64_tr_b16 v[158:159], v238 offset:57344
    ds_read_b64_tr_b16 v[162:163], v239 offset:57344
    s_add_u32 m0, s93, 16384
    s_add_u32 s82, s92, 3
    s_cmp_ge_u32 s82, s83
    s_cselect_b32 s80, 11, 0
    s_sub_u32 s82, s82, s80
    s_lshl_b32 s82, s82, 15
    s_add_u32 s82, s82, 16384
    buffer_load_dwordx4 v244, s[40:43], s82 offen lds
    buffer_load_dwordx4 v245, s[40:43], s82 offen offset:1024 lds
    s_waitcnt vmcnt(10)
    s_waitcnt lgkmcnt(0)
    s_add_u32 m0, s93, 24576
    s_add_u32 s82, s92, 4
    s_cmp_ge_u32 s82, s83
    s_cselect_b32 s80, 11, 0
    s_sub_u32 s82, s82, s80
    s_lshl_b32 s82, s82, 15
    buffer_load_dwordx4 v244, s[40:43], s82 offen lds
    buffer_load_dwordx4 v245, s[40:43], s82 offen offset:1024 lds
    s_waitcnt vmcnt(10)
    s_add_u32 m0, s93, 90112
    s_add_u32 s82, s92, 4
    s_cmp_ge_u32 s82, s83
    s_cselect_b32 s80, 11, 0
    s_sub_u32 s82, s82, s80
    s_lshl_b32 s82, s82, 15
    s_add_u32 s82, s82, 16384
    buffer_load_dwordx4 v244, s[40:43], s82 offen lds
    buffer_load_dwordx4 v245, s[40:43], s82 offen offset:1024 lds
    s_waitcnt vmcnt(10)
    s_add_u32 m0, s93, 139264
    s_add_u32 s82, s92, 0
    s_cmp_ge_u32 s82, s83
    s_cselect_b32 s80, 11, 0
    s_sub_u32 s82, s82, s80
    s_lshl_b32 s82, s82, 15
    buffer_load_dwordx4 v244, s[40:43], s82 offen lds
    buffer_load_dwordx4 v245, s[40:43], s82 offen offset:1024 lds
    s_waitcnt vmcnt(10)
    s_add_u32 s32, s92, 0
    s_cmp_ge_u32 s32, s83
    s_cselect_b32 s80, 11, 0
    s_sub_u32 s32, s32, s80
    s_mul_i32 s32, s32, 5120
    s_add_u32 s33, s92, 1
    s_cmp_ge_u32 s33, s83
    s_cselect_b32 s80, 11, 0
    s_sub_u32 s33, s33, s80
    s_mul_i32 s33, s33, 5120
    s_add_u32 s34, s92, 2
    s_cmp_ge_u32 s34, s83
    s_cselect_b32 s80, 11, 0
    s_sub_u32 s34, s34, s80
    s_mul_i32 s34, s34, 5120
    s_add_u32 m0, s93, 155648
    s_add_u32 s82, s92, 0
    s_cmp_ge_u32 s82, s83
    s_cselect_b32 s80, 11, 0
    s_sub_u32 s82, s82, s80
    s_lshl_b32 s82, s82, 15
    s_add_u32 s82, s82, 16384
    buffer_load_dwordx4 v244, s[40:43], s82 offen lds
    buffer_load_dwordx4 v245, s[40:43], s82 offen offset:1024 lds
    s_waitcnt vmcnt(10)
    s_add_u32 s35, s92, 3
    s_cmp_ge_u32 s35, s83
    s_cselect_b32 s80, 11, 0
    s_sub_u32 s35, s35, s80
    s_mul_i32 s35, s35, 5120
    s_add_u32 s36, s92, 4
    s_cmp_ge_u32 s36, s83
    s_cselect_b32 s80, 11, 0
    s_sub_u32 s36, s36, s80
    s_mul_i32 s36, s36, 5120
    s_add_u32 s37, s92, 5
    s_cmp_ge_u32 s37, s83
    s_cselect_b32 s80, 11, 0
    s_sub_u32 s37, s37, s80
    s_mul_i32 s37, s37, 5120
    s_add_u32 m0, s93, 98304
    s_add_u32 s82, s92, 5
    s_cmp_ge_u32 s82, s83
    s_cselect_b32 s80, 11, 0
    s_sub_u32 s82, s82, s80
    s_lshl_b32 s82, s82, 15
    buffer_load_dwordx4 v244, s[40:43], s82 offen lds
    buffer_load_dwordx4 v245, s[40:43], s82 offen offset:1024 lds
    s_waitcnt vmcnt(10)
    s_add_u32 s38, s92, 6
    s_cmp_ge_u32 s38, s83
    s_cselect_b32 s80, 11, 0
    s_sub_u32 s38, s38, s80
    s_mul_i32 s38, s38, 5120
    s_add_u32 s39, s92, 7
    s_cmp_ge_u32 s39, s83
    s_cselect_b32 s80, 11, 0
    s_sub_u32 s39, s39, s80
    s_mul_i32 s39, s39, 5120
    s_add_u32 s88, s92, 8
    s_cmp_ge_u32 s88, s83
    s_cselect_b32 s80, 11, 0
    s_sub_u32 s88, s88, s80
    s_mul_i32 s88, s88, 5120
    s_add_u32 m0, s93, 106496
    s_add_u32 s82, s92, 5
    s_cmp_ge_u32 s82, s83
    s_cselect_b32 s80, 11, 0
    s_sub_u32 s82, s82, s80
    s_lshl_b32 s82, s82, 15
    s_add_u32 s82, s82, 16384
    buffer_load_dwordx4 v244, s[40:43], s82 offen lds
    buffer_load_dwordx4 v245, s[40:43], s82 offen offset:1024 lds
    s_waitcnt vmcnt(10)
    s_add_u32 s85, s92, 9
    s_cmp_ge_u32 s85, s83
    s_cselect_b32 s80, 11, 0
    s_sub_u32 s85, s85, s80
    s_mul_i32 s85, s85, 5120
    s_add_u32 s86, s92, 10
    s_cmp_ge_u32 s86, s83
    s_cselect_b32 s80, 11, 0
    s_sub_u32 s86, s86, s80
    s_mul_i32 s86, s86, 5120
    s_add_u32 m0, s93, 49152
    s_add_u32 s82, s92, 6
    s_cmp_ge_u32 s82, s83
    s_cselect_b32 s80, 11, 0
    s_sub_u32 s82, s82, s80
    s_lshl_b32 s82, s82, 15
    buffer_load_dwordx4 v244, s[40:43], s82 offen lds
    buffer_load_dwordx4 v245, s[40:43], s82 offen offset:1024 lds
    s_waitcnt vmcnt(10)
    s_add_u32 s89, s27, 0
    s_and_b32 s89, s89, 3
    s_lshl2_add_u32 s89, s31, s89
    s_mul_i32 s89, s89, 5120
    s_add_u32 s90, s27, 1
    s_and_b32 s90, s90, 3
    s_lshl2_add_u32 s90, s31, s90
    s_mul_i32 s90, s90, 5120
    s_add_u32 s84, s27, 2
    s_and_b32 s84, s84, 3
    s_lshl2_add_u32 s84, s31, s84
    s_mul_i32 s84, s84, 5120
    s_add_u32 s91, s27, 3
    s_and_b32 s91, s91, 3
    s_lshl2_add_u32 s91, s31, s91
    s_mul_i32 s91, s91, 5120
    s_add_u32 m0, s93, 57344
    s_add_u32 s82, s92, 6
    s_cmp_ge_u32 s82, s83
    s_cselect_b32 s80, 11, 0
    s_sub_u32 s82, s82, s80
    s_lshl_b32 s82, s82, 15
    s_add_u32 s82, s82, 16384
    buffer_load_dwordx4 v244, s[40:43], s82 offen lds
    buffer_load_dwordx4 v245, s[40:43], s82 offen offset:1024 lds
    s_waitcnt vmcnt(10)
    v_add_u32 v249, s93, v1
    v_lshrrev_b32 v248, 7, v1
    v_cmp_eq_u32 vcc, 3, v248
    v_add_u32 v248, 4224, v1
    s_nop 0
    v_cndmask_b32 v1, v1, v248, vcc
    v_cndmask_b32_e64 v248, 8, 1, vcc
    v_lshlrev_b32 v248, 7, v248
    v_mov_b32 v38, v248
    s_xor_b32 s80, s31, 3
    v_mad_u32_u24 v252, v38, s80, v1
    s_xor_b32 s80, s31, 2
    v_mad_u32_u24 v251, v38, s80, v1
    s_xor_b32 s80, s31, 1
    v_mad_u32_u24 v248, v38, s80, v1
    s_xor_b32 s80, s31, 0
    v_mad_u32_u24 v1, v38, s80, v1
    s_add_u32 m0, s93, 32768
    s_add_u32 s82, s27, 2
    s_and_b32 s82, s82, 3
    s_lshl2_add_u32 s82, s31, s82
    s_lshl_b32 s82, s82, 15
    buffer_load_dwordx4 v246, s[44:47], s82 offen lds
    buffer_load_dwordx4 v247, s[44:47], s82 offen offset:1024 lds
    s_waitcnt vmcnt(10)
    v_lshlrev_b32 v4, 16, v20
    v_and_b32 v5, s26, v20
    v_lshlrev_b32 v36, 16, v28
    v_and_b32 v37, s26, v28
    v_add_f32 v4, v4, v36
    v_add_f32 v5, v5, v37
    v_lshlrev_b32 v6, 16, v21
    v_and_b32 v7, s26, v21
    v_lshlrev_b32 v36, 16, v29
    v_and_b32 v37, s26, v29
    v_add_f32 v6, v6, v36
    v_add_f32 v7, v7, v37
    s_load_dwordx4 s[64:67], s[94:95], 0 glc
    s_add_u32 m0, s93, 40960
    s_add_u32 s82, s27, 2
    s_and_b32 s82, s82, 3
    s_lshl2_add_u32 s82, s31, s82
    s_lshl_b32 s82, s82, 15
    s_add_u32 s82, s82, 4096
    buffer_load_dwordx4 v246, s[44:47], s82 offen lds
    buffer_load_dwordx4 v247, s[44:47], s82 offen offset:1024 lds
    s_waitcnt vmcnt(10)
    v_lshlrev_b32 v8, 16, v22
    v_and_b32 v9, s26, v22
    v_lshlrev_b32 v36, 16, v30
    v_and_b32 v37, s26, v30
    v_add_f32 v8, v8, v36
    v_add_f32 v9, v9, v37
    v_lshlrev_b32 v10, 16, v23
    v_and_b32 v11, s26, v23
    v_lshlrev_b32 v36, 16, v31
    v_and_b32 v37, s26, v31
    v_add_f32 v10, v10, v36
    v_add_f32 v11, v11, v37
    s_add_u32 m0, s93, 114688
    s_add_u32 s82, s27, 3
    s_and_b32 s82, s82, 3
    s_lshl2_add_u32 s82, s31, s82
    s_lshl_b32 s82, s82, 15
    buffer_load_dwordx4 v246, s[44:47], s82 offen lds
    buffer_load_dwordx4 v247, s[44:47], s82 offen offset:1024 lds
    s_waitcnt vmcnt(10)
    v_lshlrev_b32 v12, 16, v24
    v_and_b32 v13, s26, v24
    v_lshlrev_b32 v36, 16, v32
    v_and_b32 v37, s26, v32
    v_add_f32 v12, v12, v36
    v_add_f32 v13, v13, v37
    v_lshlrev_b32 v14, 16, v25
    v_and_b32 v15, s26, v25
    v_lshlrev_b32 v36, 16, v33
    v_and_b32 v37, s26, v33
    v_add_f32 v14, v14, v36
    v_add_f32 v15, v15, v37
    s_add_u32 m0, s93, 122880
    s_add_u32 s82, s27, 3
    s_and_b32 s82, s82, 3
    s_lshl2_add_u32 s82, s31, s82
    s_lshl_b32 s82, s82, 15
    s_add_u32 s82, s82, 4096
    buffer_load_dwordx4 v246, s[44:47], s82 offen lds
    buffer_load_dwordx4 v247, s[44:47], s82 offen offset:1024 lds
    s_waitcnt vmcnt(10)
    v_lshlrev_b32 v16, 16, v26
    v_and_b32 v17, s26, v26
    v_lshlrev_b32 v36, 16, v34
    v_and_b32 v37, s26, v34
    v_add_f32 v16, v16, v36
    v_add_f32 v17, v17, v37
    v_lshlrev_b32 v18, 16, v27
    v_and_b32 v19, s26, v27
    v_lshlrev_b32 v36, 16, v35
    v_and_b32 v37, s26, v35
    v_add_f32 v18, v18, v36
    v_add_f32_e64 v19, v19, v37
    ds_read_b64_tr_b16 v[164:165], v240 offset:8192
    ds_read_b64_tr_b16 v[168:169], v241 offset:8192
    ds_read_b64_tr_b16 v[172:173], v242 offset:8192
    ds_read_b64_tr_b16 v[176:177], v243 offset:8192
    ds_read_b64_tr_b16 v[166:167], v240 offset:24576
    ds_read_b64_tr_b16 v[170:171], v241 offset:24576
    ds_read_b64_tr_b16 v[174:175], v242 offset:24576
    ds_read_b64_tr_b16 v[178:179], v243 offset:24576
    v_add_u32 v240, 4294836224, v240
    v_add_u32 v241, 4294836224, v241
    v_add_u32 v242, 4294836224, v242
    v_add_u32 v243, 4294836224, v243
    v_lshrrev_b32 v246, 3, v0
    v_lshlrev_b32 v246, 4, v246
    v_xor_b32 v246, v246, v249
    s_waitcnt lgkmcnt(0)
    s_xor_b64 s[64:65], s[64:65], s[60:61]
    s_xor_b64 s[66:67], s[66:67], s[60:61]
    s_or_b64 s[64:65], s[64:65], s[66:67]
    s_cbranch_scc0 L_flok_12
    s_mov_b32 s80, 200000
L_fl_11:
    s_load_dwordx4 s[64:67], s[94:95], 0 glc
    s_sub_u32 s80, s80, 1
    s_waitcnt lgkmcnt(0)
    s_cbranch_scc1 L_flok_12
    s_xor_b64 s[64:65], s[64:65], s[60:61]
    s_xor_b64 s[66:67], s[66:67], s[60:61]
    s_or_b64 s[64:65], s[64:65], s[66:67]
    s_cbranch_scc1 L_fl_11
L_flok_12:
    buffer_load_dwordx4 v[196:199], v1, s[48:51], s32 offen sc1
    buffer_load_dwordx4 v[200:203], v248, s[48:51], s32 offen sc1
    buffer_load_dwordx4 v[204:207], v251, s[48:51], s32 offen sc1
    buffer_load_dwordx4 v[208:211], v252, s[48:51], s32 offen sc1
    buffer_load_dwordx4 v[212:215], v1, s[48:51], s33 offen sc1
    buffer_load_dwordx4 v[216:219], v248, s[48:51], s33 offen sc1
    buffer_load_dwordx4 v[220:223], v251, s[48:51], s33 offen sc1
    buffer_load_dwordx4 v[224:227], v252, s[48:51], s33 offen sc1
    buffer_load_dwordx4 v[228:231], v1, s[48:51], s34 offen sc1
    s_waitcnt vmcnt(8) lgkmcnt(0)
    v_mfma_f32_16x16x32_bf16 v[4:7], v[164:167], v[196:199], v[4:7]
    buffer_load_dwordx4 v[232:235], v248, s[48:51], s34 offen sc1
    v_mfma_f32_16x16x32_bf16 v[8:11], v[168:171], v[196:199], v[8:11]
    ds_read_b64_tr_b16 v[180:181], v240 offset:0
    v_mfma_f32_16x16x32_bf16 v[12:15], v[172:175], v[196:199], v[12:15]
    ds_read_b64_tr_b16 v[184:185], v241 offset:0
    v_mfma_f32_16x16x32_bf16 v[16:19], v[176:179], v[196:199], v[16:19]
    ds_read_b64_tr_b16 v[188:189], v242 offset:0
    s_waitcnt vmcnt(8)
    v_mfma_f32_16x16x32_bf16 v[32:35], v[176:179], v[200:203], 0
    buffer_load_dwordx4 v[196:199], v251, s[48:51], s34 offen sc1
    v_mfma_f32_16x16x32_bf16 v[28:31], v[172:175], v[200:203], 0
    ds_read_b64_tr_b16 v[192:193], v243 offset:0
    v_mfma_f32_16x16x32_bf16 v[24:27], v[168:171], v[200:203], 0
    ds_read_b64_tr_b16 v[182:183], v240 offset:8192
    v_mfma_f32_16x16x32_bf16 v[20:23], v[164:167], v[200:203], 0
    ds_read_b64_tr_b16 v[186:187], v241 offset:8192
    s_waitcnt vmcnt(8)
    v_mfma_f32_16x16x32_bf16 v[36:39], v[164:167], v[204:207], 0
    buffer_load_dwordx4 v[200:203], v252, s[48:51], s34 offen sc1
    v_mfma_f32_16x16x32_bf16 v[40:43], v[168:171], v[204:207], 0
    ds_read_b64_tr_b16 v[190:191], v242 offset:8192
    v_mfma_f32_16x16x32_bf16 v[44:47], v[172:175], v[204:207], 0
    ds_read_b64_tr_b16 v[194:195], v243 offset:8192
    v_mfma_f32_16x16x32_bf16 v[48:51], v[176:179], v[204:207], 0
    s_waitcnt vmcnt(8)
    v_mfma_f32_16x16x32_bf16 v[64:67], v[176:179], v[208:211], 0
    buffer_load_dwordx4 v[204:207], v1, s[48:51], s35 offen sc1
    v_mfma_f32_16x16x32_bf16 v[60:63], v[172:175], v[208:211], 0
    v_mfma_f32_16x16x32_bf16 v[56:59], v[168:171], v[208:211], 0
    v_mfma_f32_16x16x32_bf16 v[52:55], v[164:167], v[208:211], 0
    s_waitcnt vmcnt(8) lgkmcnt(0)
    v_mfma_f32_16x16x32_bf16 v[4:7], v[180:183], v[212:215], v[4:7]
    buffer_load_dwordx4 v[208:211], v248, s[48:51], s35 offen sc1
    v_mfma_f32_16x16x32_bf16 v[8:11], v[184:187], v[212:215], v[8:11]
    ds_read_b64_tr_b16 v[164:165], v236 offset:0
    v_mfma_f32_16x16x32_bf16 v[12:15], v[188:191], v[212:215], v[12:15]
    ds_read_b64_tr_b16 v[168:169], v237 offset:0
    v_mfma_f32_16x16x32_bf16 v[16:19], v[192:195], v[212:215], v[16:19]
    ds_read_b64_tr_b16 v[172:173], v238 offset:0
    s_waitcnt vmcnt(8)
    v_mfma_f32_16x16x32_bf16 v[32:35], v[192:195], v[216:219], v[32:35]
    buffer_load_dwordx4 v[212:215], v251, s[48:51], s35 offen sc1
    v_mfma_f32_16x16x32_bf16 v[28:31], v[188:191], v[216:219], v[28:31]
    ds_read_b64_tr_b16 v[176:177], v239 offset:0
    v_mfma_f32_16x16x32_bf16 v[24:27], v[184:187], v[216:219], v[24:27]
    ds_read_b64_tr_b16 v[166:167], v236 offset:8192
    v_mfma_f32_16x16x32_bf16 v[20:23], v[180:183], v[216:219], v[20:23]
    ds_read_b64_tr_b16 v[170:171], v237 offset:8192
    s_waitcnt vmcnt(8)
    v_mfma_f32_16x16x32_bf16 v[36:39], v[180:183], v[220:223], v[36:39]
    buffer_load_dwordx4 v[216:219], v252, s[48:51], s35 offen sc1
    v_mfma_f32_16x16x32_bf16 v[40:43], v[184:187], v[220:223], v[40:43]
    ds_read_b64_tr_b16 v[174:175], v238 offset:8192
    v_mfma_f32_16x16x32_bf16 v[44:47], v[188:191], v[220:223], v[44:47]
    ds_read_b64_tr_b16 v[178:179], v239 offset:8192
    v_mfma_f32_16x16x32_bf16 v[48:51], v[192:195], v[220:223], v[48:51]
    s_waitcnt vmcnt(8)
    v_mfma_f32_16x16x32_bf16 v[64:67], v[192:195], v[224:227], v[64:67]
    buffer_load_dwordx4 v[220:223], v1, s[48:51], s36 offen sc1
    v_mfma_f32_16x16x32_bf16 v[60:63], v[188:191], v[224:227], v[60:63]
    v_mfma_f32_16x16x32_bf16 v[56:59], v[184:187], v[224:227], v[56:59]
    v_mfma_f32_16x16x32_bf16 v[52:55], v[180:183], v[224:227], v[52:55]
    s_waitcnt vmcnt(8) lgkmcnt(0)
    v_mfma_f32_16x16x32_bf16 v[4:7], v[164:167], v[228:231], v[4:7]
    buffer_load_dwordx4 v[224:227], v248, s[48:51], s36 offen sc1
    v_mfma_f32_16x16x32_bf16 v[8:11], v[168:171], v[228:231], v[8:11]
    ds_read_b64_tr_b16 v[180:181], v236 offset:16384
    v_mfma_f32_16x16x32_bf16 v[12:15], v[172:175], v[228:231], v[12:15]
    ds_read_b64_tr_b16 v[184:185], v237 offset:16384
    v_mfma_f32_16x16x32_bf16 v[16:19], v[176:179], v[228:231], v[16:19]
    ds_read_b64_tr_b16 v[188:189], v238 offset:16384
    s_waitcnt vmcnt(8)
    v_mfma_f32_16x16x32_bf16 v[32:35], v[176:179], v[232:235], v[32:35]
    buffer_load_dwordx4 v[228:231], v251, s[48:51], s36 offen sc1
    v_mfma_f32_16x16x32_bf16 v[28:31], v[172:175], v[232:235], v[28:31]
    ds_read_b64_tr_b16 v[192:193], v239 offset:16384
    v_mfma_f32_16x16x32_bf16 v[24:27], v[168:171], v[232:235], v[24:27]
    ds_read_b64_tr_b16 v[182:183], v240 offset:16384
    v_mfma_f32_16x16x32_bf16 v[20:23], v[164:167], v[232:235], v[20:23]
    ds_read_b64_tr_b16 v[186:187], v241 offset:16384
    s_waitcnt vmcnt(8)
    v_mfma_f32_16x16x32_bf16 v[36:39], v[164:167], v[196:199], v[36:39]
    buffer_load_dwordx4 v[232:235], v252, s[48:51], s36 offen sc1
    v_mfma_f32_16x16x32_bf16 v[40:43], v[168:171], v[196:199], v[40:43]
    ds_read_b64_tr_b16 v[190:191], v242 offset:16384
    v_mfma_f32_16x16x32_bf16 v[44:47], v[172:175], v[196:199], v[44:47]
    ds_read_b64_tr_b16 v[194:195], v243 offset:16384
    v_mfma_f32_16x16x32_bf16 v[48:51], v[176:179], v[196:199], v[48:51]
    s_waitcnt vmcnt(8)
    v_mfma_f32_16x16x32_bf16 v[64:67], v[176:179], v[200:203], v[64:67]
    buffer_load_dwordx4 v[196:199], v1, s[48:51], s37 offen sc1
    v_mfma_f32_16x16x32_bf16 v[60:63], v[172:175], v[200:203], v[60:63]
    v_mfma_f32_16x16x32_bf16 v[56:59], v[168:171], v[200:203], v[56:59]
    v_mfma_f32_16x16x32_bf16 v[52:55], v[164:167], v[200:203], v[52:55]
    s_waitcnt vmcnt(8) lgkmcnt(0)
    v_mfma_f32_16x16x32_bf16 v[4:7], v[180:183], v[204:207], v[4:7]
    buffer_load_dwordx4 v[200:203], v248, s[48:51], s37 offen sc1
    v_mfma_f32_16x16x32_bf16 v[8:11], v[184:187], v[204:207], v[8:11]
    ds_read_b64_tr_b16 v[164:165], v240 offset:24576
    v_mfma_f32_16x16x32_bf16 v[12:15], v[188:191], v[204:207], v[12:15]
    ds_read_b64_tr_b16 v[168:169], v241 offset:24576
    v_mfma_f32_16x16x32_bf16 v[16:19], v[192:195], v[204:207], v[16:19]
    ds_read_b64_tr_b16 v[172:173], v242 offset:24576
    s_waitcnt vmcnt(8)
    v_mfma_f32_16x16x32_bf16 v[32:35], v[192:195], v[208:211], v[32:35]
    buffer_load_dwordx4 v[204:207], v251, s[48:51], s37 offen sc1
    v_mfma_f32_16x16x32_bf16 v[28:31], v[188:191], v[208:211], v[28:31]
    ds_read_b64_tr_b16 v[176:177], v243 offset:24576
    v_mfma_f32_16x16x32_bf16 v[24:27], v[184:187], v[208:211], v[24:27]
    ds_read_b64_tr_b16 v[166:167], v236 offset:24576
    v_mfma_f32_16x16x32_bf16 v[20:23], v[180:183], v[208:211], v[20:23]
    ds_read_b64_tr_b16 v[170:171], v237 offset:24576
    s_waitcnt vmcnt(8)
    v_mfma_f32_16x16x32_bf16 v[36:39], v[180:183], v[212:215], v[36:39]
    buffer_load_dwordx4 v[208:211], v252, s[48:51], s37 offen sc1
    v_mfma_f32_16x16x32_bf16 v[40:43], v[184:187], v[212:215], v[40:43]
    ds_read_b64_tr_b16 v[174:175], v238 offset:24576
    v_mfma_f32_16x16x32_bf16 v[44:47], v[188:191], v[212:215], v[44:47]
    ds_read_b64_tr_b16 v[178:179], v239 offset:24576
    v_mfma_f32_16x16x32_bf16 v[48:51], v[192:195], v[212:215], v[48:51]
    s_waitcnt vmcnt(8)
    v_mfma_f32_16x16x32_bf16 v[64:67], v[192:195], v[216:219], v[64:67]
    buffer_load_dwordx4 v[212:215], v1, s[48:51], s38 offen sc1
    v_mfma_f32_16x16x32_bf16 v[60:63], v[188:191], v[216:219], v[60:63]
    v_mfma_f32_16x16x32_bf16 v[56:59], v[184:187], v[216:219], v[56:59]
    v_mfma_f32_16x16x32_bf16 v[52:55], v[180:183], v[216:219], v[52:55]
    s_waitcnt vmcnt(8) lgkmcnt(0)
    v_mfma_f32_16x16x32_bf16 v[4:7], v[164:167], v[220:223], v[4:7]
    buffer_load_dwordx4 v[216:219], v248, s[48:51], s38 offen sc1
    v_mfma_f32_16x16x32_bf16 v[8:11], v[168:171], v[220:223], v[8:11]
    ds_read_b64_tr_b16 v[180:181], v236 offset:32768
    v_mfma_f32_16x16x32_bf16 v[12:15], v[172:175], v[220:223], v[12:15]
    ds_read_b64_tr_b16 v[184:185], v237 offset:32768
    v_mfma_f32_16x16x32_bf16 v[16:19], v[176:179], v[220:223], v[16:19]
    ds_read_b64_tr_b16 v[188:189], v238 offset:32768
    s_waitcnt vmcnt(8)
    v_mfma_f32_16x16x32_bf16 v[32:35], v[176:179], v[224:227], v[32:35]
    buffer_load_dwordx4 v[220:223], v251, s[48:51], s38 offen sc1
    v_mfma_f32_16x16x32_bf16 v[28:31], v[172:175], v[224:227], v[28:31]
    ds_read_b64_tr_b16 v[192:193], v239 offset:32768
    v_mfma_f32_16x16x32_bf16 v[24:27], v[168:171], v[224:227], v[24:27]
    ds_read_b64_tr_b16 v[182:183], v236 offset:40960
    v_mfma_f32_16x16x32_bf16 v[20:23], v[164:167], v[224:227], v[20:23]
    ds_read_b64_tr_b16 v[186:187], v237 offset:40960
    s_waitcnt vmcnt(8)
    v_mfma_f32_16x16x32_bf16 v[36:39], v[164:167], v[228:231], v[36:39]
    buffer_load_dwordx4 v[224:227], v252, s[48:51], s38 offen sc1
    v_mfma_f32_16x16x32_bf16 v[40:43], v[168:171], v[228:231], v[40:43]
    ds_read_b64_tr_b16 v[190:191], v238 offset:40960
    v_mfma_f32_16x16x32_bf16 v[44:47], v[172:175], v[228:231], v[44:47]
    ds_read_b64_tr_b16 v[194:195], v239 offset:40960
    v_mfma_f32_16x16x32_bf16 v[48:51], v[176:179], v[228:231], v[48:51]
    s_waitcnt vmcnt(8)
    v_mfma_f32_16x16x32_bf16 v[64:67], v[176:179], v[232:235], v[64:67]
    buffer_load_dwordx4 v[228:231], v1, s[48:51], s39 offen sc1
    v_mfma_f32_16x16x32_bf16 v[60:63], v[172:175], v[232:235], v[60:63]
    v_mfma_f32_16x16x32_bf16 v[56:59], v[168:171], v[232:235], v[56:59]
    v_mfma_f32_16x16x32_bf16 v[52:55], v[164:167], v[232:235], v[52:55]
    s_waitcnt vmcnt(8) lgkmcnt(0)
    v_mfma_f32_16x16x32_bf16 v[4:7], v[180:183], v[196:199], v[4:7]
    buffer_load_dwordx4 v[232:235], v248, s[48:51], s39 offen sc1
    v_mfma_f32_16x16x32_bf16 v[8:11], v[184:187], v[196:199], v[8:11]
    ds_read_b64_tr_b16 v[164:165], v240 offset:49152
    v_mfma_f32_16x16x32_bf16 v[12:15], v[188:191], v[196:199], v[12:15]
    ds_read_b64_tr_b16 v[168:169], v241 offset:49152
    v_mfma_f32_16x16x32_bf16 v[16:19], v[192:195], v[196:199], v[16:19]
    ds_read_b64_tr_b16 v[172:173], v242 offset:49152
    s_waitcnt vmcnt(8)
    v_mfma_f32_16x16x32_bf16 v[32:35], v[192:195], v[200:203], v[32:35]
    buffer_load_dwordx4 v[196:199], v251, s[48:51], s39 offen sc1
    v_mfma_f32_16x16x32_bf16 v[28:31], v[188:191], v[200:203], v[28:31]
    ds_read_b64_tr_b16 v[176:177], v243 offset:49152
    v_mfma_f32_16x16x32_bf16 v[24:27], v[184:187], v[200:203], v[24:27]
    ds_read_b64_tr_b16 v[166:167], v240 offset:57344
    v_mfma_f32_16x16x32_bf16 v[20:23], v[180:183], v[200:203], v[20:23]
    ds_read_b64_tr_b16 v[170:171], v241 offset:57344
    s_waitcnt vmcnt(8)
    v_mfma_f32_16x16x32_bf16 v[36:39], v[180:183], v[204:207], v[36:39]
    buffer_load_dwordx4 v[200:203], v252, s[48:51], s39 offen sc1
    v_mfma_f32_16x16x32_bf16 v[40:43], v[184:187], v[204:207], v[40:43]
    ds_read_b64_tr_b16 v[174:175], v242 offset:57344
    v_mfma_f32_16x16x32_bf16 v[44:47], v[188:191], v[204:207], v[44:47]
    ds_read_b64_tr_b16 v[178:179], v243 offset:57344
    v_mfma_f32_16x16x32_bf16 v[48:51], v[192:195], v[204:207], v[48:51]
    s_waitcnt vmcnt(8)
    v_mfma_f32_16x16x32_bf16 v[64:67], v[192:195], v[208:211], v[64:67]
    buffer_load_dwordx4 v[204:207], v1, s[48:51], s88 offen sc1
    v_mfma_f32_16x16x32_bf16 v[60:63], v[188:191], v[208:211], v[60:63]
    v_mfma_f32_16x16x32_bf16 v[56:59], v[184:187], v[208:211], v[56:59]
    v_mfma_f32_16x16x32_bf16 v[52:55], v[180:183], v[208:211], v[52:55]
    s_waitcnt vmcnt(8) lgkmcnt(0)
    v_mfma_f32_16x16x32_bf16 v[4:7], v[164:167], v[212:215], v[4:7]
    buffer_load_dwordx4 v[208:211], v248, s[48:51], s88 offen sc1
    v_mfma_f32_16x16x32_bf16 v[8:11], v[168:171], v[212:215], v[8:11]
    ds_read_b64_tr_b16 v[180:181], v240 offset:32768
    v_mfma_f32_16x16x32_bf16 v[12:15], v[172:175], v[212:215], v[12:15]
    ds_read_b64_tr_b16 v[184:185], v241 offset:32768
    v_mfma_f32_16x16x32_bf16 v[16:19], v[176:179], v[212:215], v[16:19]
    ds_read_b64_tr_b16 v[188:189], v242 offset:32768
    s_waitcnt vmcnt(8)
    v_mfma_f32_16x16x32_bf16 v[32:35], v[176:179], v[216:219], v[32:35]
    buffer_load_dwordx4 v[212:215], v251, s[48:51], s88 offen sc1
    v_mfma_f32_16x16x32_bf16 v[28:31], v[172:175], v[216:219], v[28:31]
    ds_read_b64_tr_b16 v[192:193], v243 offset:32768
    v_mfma_f32_16x16x32_bf16 v[24:27], v[168:171], v[216:219], v[24:27]
    ds_read_b64_tr_b16 v[182:183], v240 offset:40960
    v_mfma_f32_16x16x32_bf16 v[20:23], v[164:167], v[216:219], v[20:23]
    ds_read_b64_tr_b16 v[186:187], v241 offset:40960
    s_waitcnt vmcnt(8)
    v_mfma_f32_16x16x32_bf16 v[36:39], v[164:167], v[220:223], v[36:39]
    buffer_load_dwordx4 v[216:219], v252, s[48:51], s88 offen sc1
    v_mfma_f32_16x16x32_bf16 v[40:43], v[168:171], v[220:223], v[40:43]
    ds_read_b64_tr_b16 v[190:191], v242 offset:40960
    v_mfma_f32_16x16x32_bf16 v[44:47], v[172:175], v[220:223], v[44:47]
    ds_read_b64_tr_b16 v[194:195], v243 offset:40960
    v_mfma_f32_16x16x32_bf16 v[48:51], v[176:179], v[220:223], v[48:51]
    s_waitcnt vmcnt(8)
    v_mfma_f32_16x16x32_bf16 v[64:67], v[176:179], v[224:227], v[64:67]
    buffer_load_dwordx4 v[220:223], v1, s[48:51], s85 offen sc1
    v_mfma_f32_16x16x32_bf16 v[60:63], v[172:175], v[224:227], v[60:63]
    v_mfma_f32_16x16x32_bf16 v[56:59], v[168:171], v[224:227], v[56:59]
    v_mfma_f32_16x16x32_bf16 v[52:55], v[164:167], v[224:227], v[52:55]
    s_waitcnt vmcnt(8)
    v_mfma_f32_16x16x32_bf16 v[4:7], v[68:71], v[228:231], v[4:7]
    buffer_load_dwordx4 v[224:227], v248, s[48:51], s85 offen sc1
    v_mfma_f32_16x16x32_bf16 v[8:11], v[72:75], v[228:231], v[8:11]
    ds_read_b64_tr_b16 v[164:165], v236 offset:49152
    v_mfma_f32_16x16x32_bf16 v[12:15], v[76:79], v[228:231], v[12:15]
    ds_read_b64_tr_b16 v[168:169], v237 offset:49152
    v_mfma_f32_16x16x32_bf16 v[16:19], v[80:83], v[228:231], v[16:19]
    ds_read_b64_tr_b16 v[172:173], v238 offset:49152
    s_load_dwordx8 s[64:71], s[94:95], 32 glc
    s_waitcnt vmcnt(8)
    v_mfma_f32_16x16x32_bf16 v[32:35], v[80:83], v[232:235], v[32:35]
    buffer_load_dwordx4 v[228:231], v251, s[48:51], s85 offen sc1
    v_mfma_f32_16x16x32_bf16 v[28:31], v[76:79], v[232:235], v[28:31]
    ds_read_b64_tr_b16 v[176:177], v239 offset:49152
    v_mfma_f32_16x16x32_bf16 v[24:27], v[72:75], v[232:235], v[24:27]
    ds_read_b64_tr_b16 v[166:167], v236 offset:57344
    v_mfma_f32_16x16x32_bf16 v[20:23], v[68:71], v[232:235], v[20:23]
    ds_read_b64_tr_b16 v[170:171], v237 offset:57344
    s_waitcnt vmcnt(8)
    v_mfma_f32_16x16x32_bf16 v[36:39], v[68:71], v[196:199], v[36:39]
    buffer_load_dwordx4 v[232:235], v252, s[48:51], s85 offen sc1
    v_mfma_f32_16x16x32_bf16 v[40:43], v[72:75], v[196:199], v[40:43]
    ds_read_b64_tr_b16 v[174:175], v238 offset:57344
    v_mfma_f32_16x16x32_bf16 v[44:47], v[76:79], v[196:199], v[44:47]
    ds_read_b64_tr_b16 v[178:179], v239 offset:57344
    v_mfma_f32_16x16x32_bf16 v[48:51], v[80:83], v[196:199], v[48:51]
    s_waitcnt vmcnt(8)
    v_mfma_f32_16x16x32_bf16 v[64:67], v[80:83], v[200:203], v[64:67]
    buffer_load_dwordx4 v[196:199], v1, s[48:51], s86 offen sc1
    v_mfma_f32_16x16x32_bf16 v[60:63], v[76:79], v[200:203], v[60:63]
    v_mfma_f32_16x16x32_bf16 v[56:59], v[72:75], v[200:203], v[56:59]
    v_mfma_f32_16x16x32_bf16 v[52:55], v[68:71], v[200:203], v[52:55]
    s_waitcnt vmcnt(8)
    v_mfma_f32_16x16x32_bf16 v[4:7], v[84:87], v[204:207], v[4:7]
    buffer_load_dwordx4 v[200:203], v248, s[48:51], s86 offen sc1
    v_mfma_f32_16x16x32_bf16 v[8:11], v[88:91], v[204:207], v[8:11]
    v_mfma_f32_16x16x32_bf16 v[12:15], v[92:95], v[204:207], v[12:15]
    v_mfma_f32_16x16x32_bf16 v[16:19], v[96:99], v[204:207], v[16:19]
    s_waitcnt vmcnt(8)
    v_mfma_f32_16x16x32_bf16 v[32:35], v[96:99], v[208:211], v[32:35]
    buffer_load_dwordx4 v[204:207], v251, s[48:51], s86 offen sc1
    v_mfma_f32_16x16x32_bf16 v[28:31], v[92:95], v[208:211], v[28:31]
    v_mfma_f32_16x16x32_bf16 v[24:27], v[88:91], v[208:211], v[24:27]
    v_mfma_f32_16x16x32_bf16 v[20:23], v[84:87], v[208:211], v[20:23]
    s_waitcnt vmcnt(8)
    v_mfma_f32_16x16x32_bf16 v[36:39], v[84:87], v[212:215], v[36:39]
    buffer_load_dwordx4 v[208:211], v252, s[48:51], s86 offen sc1
    v_mfma_f32_16x16x32_bf16 v[40:43], v[88:91], v[212:215], v[40:43]
    v_mfma_f32_16x16x32_bf16 v[44:47], v[92:95], v[212:215], v[44:47]
    v_mfma_f32_16x16x32_bf16 v[48:51], v[96:99], v[212:215], v[48:51]
    s_waitcnt lgkmcnt(0)
    s_xor_b64 s[64:65], s[64:65], s[60:61]
    s_xor_b64 s[66:67], s[66:67], s[60:61]
    s_xor_b64 s[68:69], s[68:69], s[60:61]
    s_xor_b64 s[70:71], s[70:71], s[60:61]
    s_or_b64 s[64:65], s[64:65], s[68:69]
    s_or_b64 s[66:67], s[66:67], s[70:71]
    s_or_b64 s[64:65], s[64:65], s[66:67]
    s_cbranch_scc0 L_flok_14
    s_mov_b32 s80, 200000
L_fl_13:
    s_load_dwordx8 s[64:71], s[94:95], 32 glc
    s_sub_u32 s80, s80, 1
    s_waitcnt lgkmcnt(0)
    s_cbranch_scc1 L_flok_14
    s_xor_b64 s[64:65], s[64:65], s[60:61]
    s_xor_b64 s[66:67], s[66:67], s[60:61]
    s_xor_b64 s[68:69], s[68:69], s[60:61]
    s_xor_b64 s[70:71], s[70:71], s[60:61]
    s_or_b64 s[64:65], s[64:65], s[68:69]
    s_or_b64 s[66:67], s[66:67], s[70:71]
    s_or_b64 s[64:65], s[64:65], s[66:67]
    s_cbranch_scc1 L_fl_13
L_flok_14:
    s_waitcnt vmcnt(8)
    v_mfma_f32_16x16x32_bf16 v[64:67], v[96:99], v[216:219], v[64:67]
    buffer_load_dwordx4 v[212:215], v248, s[52:55], s89 offen sc1
    v_mfma_f32_16x16x32_bf16 v[60:63], v[92:95], v[216:219], v[60:63]
    v_mfma_f32_16x16x32_bf16 v[56:59], v[88:91], v[216:219], v[56:59]
    v_mfma_f32_16x16x32_bf16 v[52:55], v[84:87], v[216:219], v[52:55]
    s_waitcnt vmcnt(8)
    v_mfma_f32_16x16x32_bf16 v[4:7], v[100:103], v[220:223], v[4:7]
    buffer_load_dwordx4 v[216:219], v248, s[52:55], s90 offen sc1
    v_mfma_f32_16x16x32_bf16 v[8:11], v[104:107], v[220:223], v[8:11]
    v_mfma_f32_16x16x32_bf16 v[12:15], v[108:111], v[220:223], v[12:15]
    v_mfma_f32_16x16x32_bf16 v[16:19], v[112:115], v[220:223], v[16:19]
    s_waitcnt vmcnt(8)
    v_mfma_f32_16x16x32_bf16 v[32:35], v[112:115], v[224:227], v[32:35]
    buffer_load_dwordx4 v[220:223], v248, s[52:55], s84 offen sc1
    v_mfma_f32_16x16x32_bf16 v[28:31], v[108:111], v[224:227], v[28:31]
    v_mfma_f32_16x16x32_bf16 v[24:27], v[104:107], v[224:227], v[24:27]
    v_mfma_f32_16x16x32_bf16 v[20:23], v[100:103], v[224:227], v[20:23]
    s_waitcnt vmcnt(8)
    v_mfma_f32_16x16x32_bf16 v[36:39], v[100:103], v[228:231], v[36:39]
    buffer_load_dwordx4 v[224:227], v248, s[52:55], s91 offen sc1
    v_mfma_f32_16x16x32_bf16 v[40:43], v[104:107], v[228:231], v[40:43]
    v_mfma_f32_16x16x32_bf16 v[44:47], v[108:111], v[228:231], v[44:47]
    v_mfma_f32_16x16x32_bf16 v[48:51], v[112:115], v[228:231], v[48:51]
    s_waitcnt vmcnt(8)
    v_mfma_f32_16x16x32_bf16 v[64:67], v[112:115], v[232:235], v[64:67]
    buffer_load_dwordx4 v[228:231], v251, s[52:55], s89 offen sc1
    v_mfma_f32_16x16x32_bf16 v[60:63], v[108:111], v[232:235], v[60:63]
    v_mfma_f32_16x16x32_bf16 v[56:59], v[104:107], v[232:235], v[56:59]
    v_mfma_f32_16x16x32_bf16 v[52:55], v[100:103], v[232:235], v[52:55]
    s_waitcnt vmcnt(8)
    v_mfma_f32_16x16x32_bf16 v[4:7], v[116:119], v[196:199], v[4:7]
    buffer_load_dwordx4 v[232:235], v251, s[52:55], s90 offen sc1
    v_mfma_f32_16x16x32_bf16 v[8:11], v[120:123], v[196:199], v[8:11]
    v_mfma_f32_16x16x32_bf16 v[12:15], v[124:127], v[196:199], v[12:15]
    v_mfma_f32_16x16x32_bf16 v[16:19], v[128:131], v[196:199], v[16:19]
    s_waitcnt vmcnt(8)
    v_mfma_f32_16x16x32_bf16 v[32:35], v[128:131], v[200:203], v[32:35]
    buffer_load_dwordx4 v[196:199], v251, s[52:55], s84 offen sc1
    v_mfma_f32_16x16x32_bf16 v[28:31], v[124:127], v[200:203], v[28:31]
    v_mfma_f32_16x16x32_bf16 v[24:27], v[120:123], v[200:203], v[24:27]
    v_mfma_f32_16x16x32_bf16 v[20:23], v[116:119], v[200:203], v[20:23]
    s_waitcnt vmcnt(8)
    v_mfma_f32_16x16x32_bf16 v[36:39], v[116:119], v[204:207], v[36:39]
    buffer_load_dwordx4 v[200:203], v251, s[52:55], s91 offen sc1
    v_mfma_f32_16x16x32_bf16 v[40:43], v[120:123], v[204:207], v[40:43]
    v_mfma_f32_16x16x32_bf16 v[44:47], v[124:127], v[204:207], v[44:47]
    v_mfma_f32_16x16x32_bf16 v[48:51], v[128:131], v[204:207], v[48:51]
    s_waitcnt vmcnt(8)
    v_mfma_f32_16x16x32_bf16 v[64:67], v[128:131], v[208:211], v[64:67]
    buffer_load_dwordx4 v[204:207], v252, s[52:55], s89 offen sc1
    v_mfma_f32_16x16x32_bf16 v[60:63], v[124:127], v[208:211], v[60:63]
    v_mfma_f32_16x16x32_bf16 v[56:59], v[120:123], v[208:211], v[56:59]
    v_mfma_f32_16x16x32_bf16 v[52:55], v[116:119], v[208:211], v[52:55]
    s_waitcnt vmcnt(8) lgkmcnt(0)
    v_mfma_f32_16x16x32_bf16 v[20:23], v[132:135], v[212:215], v[20:23]
    buffer_load_dwordx4 v[208:211], v252, s[52:55], s90 offen sc1
    v_mfma_f32_16x16x32_bf16 v[24:27], v[136:139], v[212:215], v[24:27]
    v_xor_b32 v237, 2048, v249
    v_mfma_f32_16x16x32_bf16 v[28:31], v[140:143], v[212:215], v[28:31]
    v_xor_b32 v238, 4096, v249
    v_mfma_f32_16x16x32_bf16 v[32:35], v[144:147], v[212:215], v[32:35]
    v_xor_b32 v239, 6144, v249
    s_waitcnt vmcnt(8)
    v_mfma_f32_16x16x32_bf16 v[32:35], v[160:163], v[216:219], v[32:35]
    buffer_load_dwordx4 v[212:215], v252, s[52:55], s84 offen sc1
    v_mfma_f32_16x16x32_bf16 v[28:31], v[156:159], v[216:219], v[28:31]
    v_xor_b32_e64 v241, 32, v250
    v_mfma_f32_16x16x32_bf16 v[24:27], v[152:155], v[216:219], v[24:27]
    v_xor_b32_e64 v242, 64, v250
    v_mfma_f32_16x16x32_bf16 v[20:23], v[148:151], v[216:219], v[20:23]
    v_xor_b32_e64 v243, 32, v242
    s_waitcnt vmcnt(8)
    v_mfma_f32_16x16x32_bf16 v[20:23], v[180:183], v[220:223], v[20:23]
    buffer_load_dwordx4 v[216:219], v252, s[52:55], s91 offen sc1
    v_mfma_f32_16x16x32_bf16 v[24:27], v[184:187], v[220:223], v[24:27]
    v_mfma_f32_16x16x32_bf16 v[28:31], v[188:191], v[220:223], v[28:31]
    v_mfma_f32_16x16x32_bf16 v[32:35], v[192:195], v[220:223], v[32:35]
    s_waitcnt vmcnt(8)
    v_mfma_f32_16x16x32_bf16 v[32:35], v[176:179], v[224:227], v[32:35]
    buffer_load_dwordx4 v[220:223], v1, s[52:55], s89 offen sc1
    v_mfma_f32_16x16x32_bf16 v[28:31], v[172:175], v[224:227], v[28:31]
    v_mfma_f32_16x16x32_bf16 v[24:27], v[168:171], v[224:227], v[24:27]
    v_mfma_f32_16x16x32_bf16 v[20:23], v[164:167], v[224:227], v[20:23]
    s_waitcnt vmcnt(8)
    v_mfma_f32_16x16x32_bf16 v[36:39], v[132:135], v[228:231], v[36:39]
    buffer_load_dwordx4 v[224:227], v1, s[52:55], s90 offen sc1
    v_mfma_f32_16x16x32_bf16 v[40:43], v[136:139], v[228:231], v[40:43]
    v_mfma_f32_16x16x32_bf16 v[44:47], v[140:143], v[228:231], v[44:47]
    ds_write_b128 v249, v[32:35] offset:9216
    v_mfma_f32_16x16x32_bf16 v[48:51], v[144:147], v[228:231], v[48:51]
    s_waitcnt vmcnt(8)
    v_mfma_f32_16x16x32_bf16 v[48:51], v[160:163], v[232:235], v[48:51]
    buffer_load_dwordx4 v[228:231], v1, s[52:55], s84 offen sc1
    v_mfma_f32_16x16x32_bf16 v[44:47], v[156:159], v[232:235], v[44:47]
    ds_write_b128 v249, v[28:31] offset:8192
    v_mfma_f32_16x16x32_bf16 v[40:43], v[152:155], v[232:235], v[40:43]
    ds_write_b128 v249, v[24:27] offset:1024
    v_mfma_f32_16x16x32_bf16 v[36:39], v[148:151], v[232:235], v[36:39]
    s_waitcnt vmcnt(8)
    v_mfma_f32_16x16x32_bf16 v[36:39], v[180:183], v[196:199], v[36:39]
    buffer_load_dwordx4 v[232:235], v1, s[52:55], s91 offen sc1
    v_mfma_f32_16x16x32_bf16 v[40:43], v[184:187], v[196:199], v[40:43]
    v_mfma_f32_16x16x32_bf16 v[44:47], v[188:191], v[196:199], v[44:47]
    ds_write_b128 v249, v[20:23] offset:0
    v_mfma_f32_16x16x32_bf16 v[48:51], v[192:195], v[196:199], v[48:51]
    s_waitcnt vmcnt(8)
    v_mfma_f32_16x16x32_bf16 v[48:51], v[176:179], v[200:203], v[48:51]
    v_mfma_f32_16x16x32_bf16 v[44:47], v[172:175], v[200:203], v[44:47]
    v_mfma_f32_16x16x32_bf16 v[40:43], v[168:171], v[200:203], v[40:43]
    v_mfma_f32_16x16x32_bf16 v[36:39], v[164:167], v[200:203], v[36:39]
    s_waitcnt vmcnt(7)
    v_mfma_f32_16x16x32_bf16 v[52:55], v[132:135], v[204:207], v[52:55]
    v_mfma_f32_16x16x32_bf16 v[56:59], v[136:139], v[204:207], v[56:59]
    v_mfma_f32_16x16x32_bf16 v[60:63], v[140:143], v[204:207], v[60:63]
    s_nop 0
    ds_write_b128 v249, v[48:51] offset:25600
    v_mfma_f32_16x16x32_bf16 v[64:67], v[144:147], v[204:207], v[64:67]
    s_waitcnt vmcnt(6)
    v_mfma_f32_16x16x32_bf16 v[64:67], v[160:163], v[208:211], v[64:67]
    v_mfma_f32_16x16x32_bf16 v[60:63], v[156:159], v[208:211], v[60:63]
    ds_write_b128 v249, v[44:47] offset:24576
    v_mfma_f32_16x16x32_bf16 v[56:59], v[152:155], v[208:211], v[56:59]
    ds_write_b128 v249, v[40:43] offset:17408
    v_mfma_f32_16x16x32_bf16 v[52:55], v[148:151], v[208:211], v[52:55]
    s_waitcnt vmcnt(5)
    v_mfma_f32_16x16x32_bf16 v[52:55], v[180:183], v[212:215], v[52:55]
    v_mfma_f32_16x16x32_bf16 v[56:59], v[184:187], v[212:215], v[56:59]
    v_mfma_f32_16x16x32_bf16 v[60:63], v[188:191], v[212:215], v[60:63]
    ds_write_b128 v249, v[36:39] offset:16384
    v_mfma_f32_16x16x32_bf16 v[64:67], v[192:195], v[212:215], v[64:67]
    s_waitcnt vmcnt(4)
    v_mfma_f32_16x16x32_bf16 v[64:67], v[176:179], v[216:219], v[64:67]
    v_mfma_f32_16x16x32_bf16 v[60:63], v[172:175], v[216:219], v[60:63]
    v_mfma_f32_16x16x32_bf16 v[56:59], v[168:171], v[216:219], v[56:59]
    v_mfma_f32_16x16x32_bf16 v[52:55], v[164:167], v[216:219], v[52:55]
    s_waitcnt vmcnt(3)
    v_mfma_f32_16x16x32_bf16 v[4:7], v[132:135], v[220:223], v[4:7]
    v_mfma_f32_16x16x32_bf16 v[8:11], v[136:139], v[220:223], v[8:11]
    s_nop 1
    ds_write_b128 v249, v[64:67] offset:41984
    v_mfma_f32_16x16x32_bf16 v[12:15], v[140:143], v[220:223], v[12:15]
    ds_write_b128 v249, v[60:63] offset:40960
    v_mfma_f32_16x16x32_bf16 v[16:19], v[144:147], v[220:223], v[16:19]
    s_waitcnt vmcnt(2)
    v_mfma_f32_16x16x32_bf16 v[16:19], v[160:163], v[224:227], v[16:19]
    v_mfma_f32_16x16x32_bf16 v[12:15], v[156:159], v[224:227], v[12:15]
    ds_write_b128 v249, v[56:59] offset:33792
    v_mfma_f32_16x16x32_bf16 v[8:11], v[152:155], v[224:227], v[8:11]
    ds_write_b128 v249, v[52:55] offset:32768
    v_mfma_f32_16x16x32_bf16 v[4:7], v[148:151], v[224:227], v[4:7]
    s_waitcnt lgkmcnt(0)
    s_barrier
    ds_read_b128 v[96:99], v237 offset:9216
    ds_read_b128 v[112:115], v238 offset:25600
    ds_read_b128 v[128:131], v239 offset:41984
    ds_read_b128 v[92:95], v237 offset:8192
    s_waitcnt vmcnt(1)
    v_mfma_f32_16x16x32_bf16 v[4:7], v[180:183], v[228:231], v[4:7]
    v_mfma_f32_16x16x32_bf16 v[8:11], v[184:187], v[228:231], v[8:11]
    ds_read_b128 v[108:111], v238 offset:24576
    ds_read_b128 v[124:127], v239 offset:40960
    v_mfma_f32_16x16x32_bf16 v[12:15], v[188:191], v[228:231], v[12:15]
    ds_read_b128 v[88:91], v237 offset:1024
    v_mfma_f32_16x16x32_bf16 v[16:19], v[192:195], v[228:231], v[16:19]
    ds_read_b128 v[104:107], v238 offset:17408
    s_waitcnt vmcnt(0)
    v_mfma_f32_16x16x32_bf16 v[16:19], v[176:179], v[232:235], v[16:19]
    v_mfma_f32_16x16x32_bf16 v[12:15], v[172:175], v[232:235], v[12:15]
    ds_read_b128 v[120:123], v239 offset:33792
    ds_read_b128 v[84:87], v237 offset:0
    v_mfma_f32_16x16x32_bf16 v[8:11], v[168:171], v[232:235], v[8:11]
    ds_read_b128 v[100:103], v238 offset:16384
    v_mfma_f32_16x16x32_bf16 v[4:7], v[164:167], v[232:235], v[4:7]
    ds_read_b128 v[116:119], v239 offset:32768
    s_waitcnt lgkmcnt(9)
    v_pk_add_f32 v[96:97], v[96:97], v[112:113]
    v_pk_add_f32 v[98:99], v[98:99], v[114:115]
    v_pk_add_f32 v[16:17], v[16:17], v[128:129]
    v_pk_add_f32 v[18:19], v[18:19], v[130:131]
    v_pk_add_f32 v[16:17], v[16:17], v[96:97]
    v_pk_add_f32 v[18:19], v[18:19], v[98:99]
    v_cvt_pk_bf16_f32 v74, v16, v17
    v_cvt_pk_bf16_f32 v75, v18, v19
    ds_write_b64 v243, v[74:75] offset:49152
    s_waitcnt lgkmcnt(7)
    v_pk_add_f32 v[92:93], v[92:93], v[108:109]
    v_pk_add_f32 v[94:95], v[94:95], v[110:111]
    v_pk_add_f32 v[12:13], v[12:13], v[124:125]
    v_pk_add_f32 v[14:15], v[14:15], v[126:127]
    v_pk_add_f32 v[12:13], v[12:13], v[92:93]
    v_pk_add_f32 v[14:15], v[14:15], v[94:95]
    v_cvt_pk_bf16_f32 v72, v12, v13
    v_cvt_pk_bf16_f32 v73, v14, v15
    ds_write_b64 v242, v[72:73] offset:49152
    s_waitcnt lgkmcnt(5)
    v_pk_add_f32 v[88:89], v[88:89], v[104:105]
    v_pk_add_f32 v[90:91], v[90:91], v[106:107]
    v_pk_add_f32 v[8:9], v[8:9], v[120:121]
    v_pk_add_f32 v[10:11], v[10:11], v[122:123]
    v_pk_add_f32 v[8:9], v[8:9], v[88:89]
    v_pk_add_f32 v[10:11], v[10:11], v[90:91]
    v_cvt_pk_bf16_f32 v70, v8, v9
    v_cvt_pk_bf16_f32 v71, v10, v11
    ds_write_b64 v241, v[70:71] offset:49152
    s_waitcnt lgkmcnt(3)
    s_nop 0
    v_pk_add_f32 v[84:85], v[84:85], v[100:101]
    v_pk_add_f32 v[86:87], v[86:87], v[102:103]
    v_pk_add_f32 v[4:5], v[4:5], v[116:117]
    v_pk_add_f32 v[6:7], v[6:7], v[118:119]
    v_pk_add_f32 v[4:5], v[4:5], v[84:85]
    v_pk_add_f32 v[6:7], v[6:7], v[86:87]
    v_cvt_pk_bf16_f32 v68, v4, v5
    v_cvt_pk_bf16_f32 v69, v6, v7
    ds_write_b64 v250, v[68:69] offset:49152
    ds_read_b128 v[76:79], v246 offset:49152
    ds_read_b128 v[80:83], v246 offset:50176
    s_movk_i32 s82, 0x2000
    s_waitcnt lgkmcnt(1)
    buffer_store_dwordx4 v[76:79], v2, s[56:59], 0 offen
    s_waitcnt lgkmcnt(0)
    buffer_store_dwordx4 v[80:83], v2, s[56:59], s82 offen
L_anchor_lm:
    s_endpgm
L_gat_wait_m:
    s_mov_b32 s81, 200000
L_gat_lp_m:
    s_mov_b32 exec_hi, 0
    buffer_load_dwordx4 v[52:55], v59, s[72:75], 0 offen sc1
    s_mov_b32 exec_hi, -1
    s_movk_i32 s82, 0
    buffer_load_dwordx4 v[36:39], v58, s[72:75], s82 offen sc1
    s_movk_i32 s82, 4096
    buffer_load_dwordx4 v[40:43], v58, s[72:75], s82 offen sc1
    s_waitcnt vmcnt(0)
    s_sub_u32 s81, s81, 1
    s_cbranch_scc1 L_gat_ok_m
    v_xor_b32 v62, s60, v55
    v_xor_b32 v39, s60, v39
    v_xor_b32 v43, s60, v43
    v_or3_b32 v62, v62, v39, v43
    v_cmp_ne_u32 vcc, 0, v62
    s_nop 0
    s_cmp_lg_u64 vcc, 0
    s_cbranch_scc1 L_gat_lp_m
    s_branch L_gat_ok_m
L_tag_wait_m:
    s_mov_b32 s80, 200000
    s_mov_b64 exec, 1
L_tag_lp_m:
    buffer_load_dword v248, off, s[68:71], 0 sc1
    s_waitcnt vmcnt(0)
    v_readfirstlane_b32 s60, v248
    s_sub_u32 s80, s80, 1
    s_cbranch_scc1 L_tag_out_m
    s_cmp_eq_u32 s60, 0
    s_cbranch_scc1 L_tag_lp_m
L_tag_out_m:
    s_mov_b64 exec, -1
    s_branch L_tag_ok_m
    .p2align 3
    .fill 834, 4, 0xbf810000
L_L_attn:
    s_waitcnt vmcnt(10)
    s_barrier
    s_mov_b32 m0, s65
    s_mov_b64 exec, 0xff
    buffer_load_dwordx4 v1, s[60:63], s91 offen lds
    s_mov_b64 exec, -1
    s_lshl_b32 s88, s90, 7
    s_add_u32 s88, s88, s85
    s_mul_i32 s89, s90, s84
    s_add_u32 s80, s90, 1
    s_and_b32 s80, s80, 3
    s_and_b32 s90, s90, 4
    s_or_b32 s90, s90, s80
    s_add_u32 m0, s86, 32768
    s_nop 0
    buffer_load_dwordx4 v196, s[32:35], s88 offen lds
    s_add_u32 m0, s86, 33792
    s_nop 0
    buffer_load_dwordx4 v197, s[32:35], s88 offen lds
    s_add_u32 m0, s86, 34816
    s_nop 0
    buffer_load_dwordx4 v198, s[32:35], s88 offen lds
    s_add_u32 m0, s86, 35840
    s_nop 0
    buffer_load_dwordx4 v199, s[32:35], s88 offen lds
    s_add_u32 m0, s100, 49152
    s_nop 0
    buffer_load_dwordx4 v200, s[36:39], s89 offen lds
    s_add_u32 m0, s100, 51200
    s_nop 0
    buffer_load_dwordx4 v201, s[36:39], s89 offen lds
    s_add_u32 m0, s100, 53248
    s_nop 0
    buffer_load_dwordx4 v202, s[36:39], s89 offen lds
    s_add_u32 m0, s101, 49152
    s_nop 0
    buffer_load_dwordx4 v203, s[36:39], s89 offen lds
    s_cmp_eq_u32 s79, 0
    s_cbranch_scc0 L_xr_15
    ds_read_b64 v[20:21], v12 offset:0
    ds_read_b64 v[22:23], v13 offset:0
    ds_read_b64 v[24:25], v14 offset:0
    ds_read_b64 v[26:27], v15 offset:0
    s_waitcnt lgkmcnt(0)
L_xr_15:
    s_add_u32 m0, s101, 51200
    s_nop 0
    buffer_load_dwordx4 v204, s[36:39], s89 offen lds
    s_add_u32 m0, s101, 53248
    s_nop 0
    buffer_load_dwordx4 v205, s[36:39], s89 offen lds
    s_waitcnt vmcnt(11)
    s_barrier
    s_mov_b64 exec, 1
    buffer_load_dword v248, off, s[68:71], 0 sc1
    s_mov_b64 exec, -1
    s_lshl_b32 s88, s90, 7
    s_add_u32 s88, s88, s85
    s_mul_i32 s89, s90, s84
    s_andn2_b32 s90, 4, s90
    s_add_u32 m0, s86, 0
    s_nop 0
    buffer_load_dwordx4 v196, s[32:35], s88 offen lds
    s_add_u32 m0, s86, 1024
    s_nop 0
    buffer_load_dwordx4 v197, s[32:35], s88 offen lds
    s_add_u32 m0, s86, 2048
    s_nop 0
    buffer_load_dwordx4 v198, s[32:35], s88 offen lds
    s_add_u32 m0, s86, 3072
    s_nop 0
    buffer_load_dwordx4 v199, s[32:35], s88 offen lds
    s_add_u32 m0, s100, 0
    s_nop 0
    buffer_load_dwordx4 v200, s[36:39], s89 offen lds
    s_add_u32 m0, s100, 2048
    s_nop 0
    buffer_load_dwordx4 v201, s[36:39], s89 offen lds
    s_add_u32 m0, s100, 4096
    s_nop 0
    buffer_load_dwordx4 v202, s[36:39], s89 offen lds
    s_add_u32 m0, s101, 0
    s_nop 0
    buffer_load_dwordx4 v203, s[36:39], s89 offen lds
    s_cmp_eq_u32 s79, 1
    s_cbranch_scc0 L_xr_16
    ds_read_b64 v[20:21], v12 offset:16384
    ds_read_b64 v[22:23], v13 offset:16384
    ds_read_b64 v[24:25], v14 offset:16384
    ds_read_b64 v[26:27], v15 offset:16384
    s_waitcnt lgkmcnt(0)
L_xr_16:
    s_add_u32 m0, s101, 2048
    s_nop 0
    buffer_load_dwordx4 v204, s[36:39], s89 offen lds
    s_add_u32 m0, s101, 4096
    s_nop 0
    buffer_load_dwordx4 v205, s[36:39], s89 offen lds
    s_waitcnt vmcnt(11)
    s_barrier
    ds_read_b64 v[28:29], v208 offset:0
    ds_read_b64 v[30:31], v208 offset:32
    ds_read_b64 v[32:33], v208 offset:64
    ds_read_b64 v[34:35], v208 offset:96
    ds_read2_b32 v[4:5], v56 offset0:0 offset1:64
    ds_read_b32 v6, v56 offset:512
    s_lshl_b32 s88, s90, 7
    s_add_u32 s88, s88, s85
    s_mul_i32 s89, s90, s84
    s_add_u32 s90, s90, 1
    s_and_b32 s90, s90, 7
    s_add_u32 m0, s86, 16384
    s_nop 0
    buffer_load_dwordx4 v196, s[32:35], s88 offen lds
    s_add_u32 m0, s86, 17408
    s_nop 0
    buffer_load_dwordx4 v197, s[32:35], s88 offen lds
    s_add_u32 m0, s86, 18432
    s_nop 0
    buffer_load_dwordx4 v198, s[32:35], s88 offen lds
    s_add_u32 m0, s86, 19456
    s_nop 0
    buffer_load_dwordx4 v199, s[32:35], s88 offen lds
    s_waitcnt vmcnt(14)
    v_readfirstlane_b32 s60, v248
    s_nop 0
    s_cmp_eq_u32 s60, 0
    s_cbranch_scc1 L_tag_wait_a
L_tag_ok_a:
    s_mov_b32 s61, s60
    v_mov_b32 v7, s60
    s_waitcnt lgkmcnt(0)
    s_mov_b64 exec, 0xff00ff
    buffer_store_dwordx4 v[4:7], v57, s[72:75], 0 offen sc1
    s_mov_b64 exec, -1
    v_mov_b32 v55, s60
    s_add_u32 m0, s100, 24576
    s_nop 0
    buffer_load_dwordx4 v200, s[36:39], s89 offen lds
    s_add_u32 m0, s100, 26624
    s_nop 0
    buffer_load_dwordx4 v201, s[36:39], s89 offen lds
    s_add_u32 m0, s100, 28672
    s_nop 0
    buffer_load_dwordx4 v202, s[36:39], s89 offen lds
    s_add_u32 m0, s101, 24576
    s_nop 0
    buffer_load_dwordx4 v203, s[36:39], s89 offen lds
    s_cmp_eq_u32 s79, 2
    s_cbranch_scc0 L_xr_17
    ds_read_b64 v[20:21], v12 offset:32768
    ds_read_b64 v[22:23], v13 offset:32768
    ds_read_b64 v[24:25], v14 offset:32768
    ds_read_b64 v[26:27], v15 offset:32768
    s_waitcnt lgkmcnt(0)
L_xr_17:
    s_add_u32 m0, s101, 26624
    s_nop 0
    buffer_load_dwordx4 v204, s[36:39], s89 offen lds
    s_add_u32 m0, s101, 28672
    s_nop 0
    buffer_load_dwordx4 v205, s[36:39], s89 offen lds
    s_waitcnt vmcnt(11)
    s_barrier
    s_lshl_b32 s88, s90, 7
    s_add_u32 s88, s88, s85
    s_mul_i32 s89, s90, s84
    s_add_u32 s90, s90, 1
    s_and_b32 s90, s90, 7
    s_add_u32 m0, s86, 32768
    s_nop 0
    buffer_load_dwordx4 v196, s[32:35], s88 offen lds
    s_add_u32 m0, s86, 33792
    s_nop 0
    buffer_load_dwordx4 v197, s[32:35], s88 offen lds
    s_add_u32 m0, s86, 34816
    s_nop 0
    buffer_load_dwordx4 v198, s[32:35], s88 offen lds
    s_add_u32 m0, s86, 35840
    s_nop 0
    buffer_load_dwordx4 v199, s[32:35], s88 offen lds
    s_add_u32 m0, s100, 49152
    s_nop 0
    buffer_load_dwordx4 v200, s[36:39], s89 offen lds
    s_add_u32 m0, s100, 51200
    s_nop 0
    buffer_load_dwordx4 v201, s[36:39], s89 offen lds
    s_add_u32 m0, s100, 53248
    s_nop 0
    buffer_load_dwordx4 v202, s[36:39], s89 offen lds
    s_add_u32 m0, s101, 49152
    s_nop 0
    buffer_load_dwordx4 v203, s[36:39], s89 offen lds
    s_cmp_eq_u32 s79, 3
    s_cbranch_scc0 L_xr_18
    ds_read_b64 v[20:21], v12 offset:0
    ds_read_b64 v[22:23], v13 offset:0
    ds_read_b64 v[24:25], v14 offset:0
    ds_read_b64 v[26:27], v15 offset:0
    s_waitcnt lgkmcnt(0)
L_xr_18:
    s_add_u32 m0, s101, 51200
    s_nop 0
    buffer_load_dwordx4 v204, s[36:39], s89 offen lds
    s_add_u32 m0, s101, 53248
    s_nop 0
    buffer_load_dwordx4 v205, s[36:39], s89 offen lds
    s_waitcnt vmcnt(10)
    s_barrier
    s_lshl_b32 s88, s90, 7
    s_add_u32 s88, s88, s85
    s_mul_i32 s89, s90, s84
    s_add_u32 s90, s90, 1
    s_and_b32 s90, s90, 7
    s_add_u32 m0, s86, 0
    s_nop 0
    buffer_load_dwordx4 v196, s[32:35], s88 offen lds
    s_add_u32 m0, s86, 1024
    s_nop 0
    buffer_load_dwordx4 v197, s[32:35], s88 offen lds
    s_add_u32 m0, s86, 2048
    s_nop 0
    buffer_load_dwordx4 v198, s[32:35], s88 offen lds
    s_add_u32 m0, s86, 3072
    s_nop 0
    buffer_load_dwordx4 v199, s[32:35], s88 offen lds
    s_add_u32 m0, s100, 0
    s_nop 0
    buffer_load_dwordx4 v200, s[36:39], s89 offen lds
    s_add_u32 m0, s100, 2048
    s_nop 0
    buffer_load_dwordx4 v201, s[36:39], s89 offen lds
    s_add_u32 m0, s100, 4096
    s_nop 0
    buffer_load_dwordx4 v202, s[36:39], s89 offen lds
    s_add_u32 m0, s101, 0
    s_nop 0
    buffer_load_dwordx4 v203, s[36:39], s89 offen lds
    s_cmp_eq_u32 s79, 4
    s_cbranch_scc0 L_xr_19
    ds_read_b64 v[20:21], v12 offset:16384
    ds_read_b64 v[22:23], v13 offset:16384
    ds_read_b64 v[24:25], v14 offset:16384
    ds_read_b64 v[26:27], v15 offset:16384
    s_waitcnt lgkmcnt(0)
L_xr_19:
    s_add_u32 m0, s101, 2048
    s_nop 0
    buffer_load_dwordx4 v204, s[36:39], s89 offen lds
    s_add_u32 m0, s101, 4096
    s_nop 0
    buffer_load_dwordx4 v205, s[36:39], s89 offen lds
    s_waitcnt vmcnt(10)
    s_barrier
    s_mov_b32 exec_hi, 0
    buffer_load_dwordx4 v[52:55], v59, s[72:75], 0 offen sc1
    s_mov_b32 exec_hi, -1
    s_movk_i32 s82, 0
    buffer_load_dwordx4 v[36:39], v58, s[72:75], s82 offen sc1
    s_movk_i32 s82, 4096
    buffer_load_dwordx4 v[40:43], v58, s[72:75], s82 offen sc1
    s_lshl_b32 s88, s90, 7
    s_add_u32 s88, s88, s85
    s_mul_i32 s89, s90, s84
    s_add_u32 s90, s90, 1
    s_and_b32 s90, s90, 7
    s_add_u32 m0, s86, 16384
    s_nop 0
    buffer_load_dwordx4 v196, s[32:35], s88 offen lds
    s_add_u32 m0, s86, 17408
    s_nop 0
    buffer_load_dwordx4 v197, s[32:35], s88 offen lds
    s_add_u32 m0, s86, 18432
    s_nop 0
    buffer_load_dwordx4 v198, s[32:35], s88 offen lds
    s_add_u32 m0, s86, 19456
    s_nop 0
    buffer_load_dwordx4 v199, s[32:35], s88 offen lds
    s_add_u32 m0, s100, 24576
    s_nop 0
    buffer_load_dwordx4 v200, s[36:39], s89 offen lds
    s_add_u32 m0, s100, 26624
    s_nop 0
    buffer_load_dwordx4 v201, s[36:39], s89 offen lds
    s_add_u32 m0, s100, 28672
    s_nop 0
    buffer_load_dwordx4 v202, s[36:39], s89 offen lds
    s_add_u32 m0, s101, 24576
    s_nop 0
    buffer_load_dwordx4 v203, s[36:39], s89 offen lds
    s_cmp_eq_u32 s79, 5
    s_cbranch_scc0 L_xr_20
    ds_read_b64 v[20:21], v12 offset:32768
    ds_read_b64 v[22:23], v13 offset:32768
    ds_read_b64 v[24:25], v14 offset:32768
    ds_read_b64 v[26:27], v15 offset:32768
    s_waitcnt lgkmcnt(0)
L_xr_20:
    s_add_u32 m0, s101, 26624
    s_nop 0
    buffer_load_dwordx4 v204, s[36:39], s89 offen lds
    s_add_u32 m0, s101, 28672
    s_nop 0
    buffer_load_dwordx4 v205, s[36:39], s89 offen lds
    s_waitcnt vmcnt(13)
    s_barrier
    s_cmp_eq_u32 s79, 6
    s_cbranch_scc0 L_xr_21
    ds_read_b64 v[20:21], v12 offset:0
    ds_read_b64 v[22:23], v13 offset:0
    ds_read_b64 v[24:25], v14 offset:0
    ds_read_b64 v[26:27], v15 offset:0
    s_waitcnt lgkmcnt(0)
L_xr_21:
    s_waitcnt vmcnt(10)
    v_xor_b32 v62, s60, v55
    v_xor_b32 v39, s60, v39
    v_xor_b32 v43, s60, v43
    v_or3_b32 v62, v62, v39, v43
    v_cmp_ne_u32 vcc, 0, v62
    s_nop 0
    s_cmp_lg_u64 vcc, 0
    s_cbranch_scc1 L_gat_wait_a
L_gat_ok_a:
    v_add_f32 v36, v36, v40
    v_add_f32 v37, v37, v41
    v_add_f32 v38, v38, v42
    s_add_u32 m0, s93, 139264
    s_add_u32 s82, s92, 7
    s_cmp_ge_u32 s82, s83
    s_cselect_b32 s80, 11, 0
    s_sub_u32 s82, s82, s80
    s_lshl_b32 s82, s82, 15
    buffer_load_dwordx4 v244, s[40:43], s82 offen lds
    buffer_load_dwordx4 v245, s[40:43], s82 offen offset:1024 lds
    v_mov_b32 v40, v36
    v_mov_b32 v41, v37
    v_mov_b32 v42, v38
    v_permlane32_swap_b32 v36, v40
    v_permlane32_swap_b32 v37, v41
    v_permlane32_swap_b32 v38, v42
    v_add_f32 v36, v36, v40
    v_add_f32 v37, v37, v41
    v_add_f32 v38, v38, v42
    s_add_u32 m0, s93, 155648
    s_add_u32 s82, s92, 7
    s_cmp_ge_u32 s82, s83
    s_cselect_b32 s80, 11, 0
    s_sub_u32 s82, s82, s80
    s_lshl_b32 s82, s82, 15
    s_add_u32 s82, s82, 16384
    buffer_load_dwordx4 v244, s[40:43], s82 offen lds
    buffer_load_dwordx4 v245, s[40:43], s82 offen offset:1024 lds
    v_mov_b32 v40, v36
    v_mov_b32 v41, v37
    v_mov_b32 v42, v38
    v_permlane16_swap_b32 v36, v40
    v_permlane16_swap_b32 v37, v41
    v_permlane16_swap_b32 v38, v42
    v_add_f32 v36, v36, v40
    v_add_f32 v37, v37, v41
    v_add_f32 v38, v38, v42
    s_mov_b32 exec_lo, 0
    v_mov_b32 v52, v36
    v_mov_b32 v53, v37
    s_mov_b32 exec_hi, 0xffff0000
    v_mov_b32 v52, v38
    v_mov_b32 v53, s60
    s_mov_b64 exec, -1
    ds_write2_b32 v60, v52, v53 offset0:0 offset1:128
    s_add_u32 m0, s93, 131072
    s_add_u32 s82, s92, 8
    s_cmp_ge_u32 s82, s83
    s_cselect_b32 s80, 11, 0
    s_sub_u32 s82, s82, s80
    s_lshl_b32 s82, s82, 15
    buffer_load_dwordx4 v244, s[40:43], s82 offen lds
    buffer_load_dwordx4 v245, s[40:43], s82 offen offset:1024 lds
    s_waitcnt vmcnt(6) lgkmcnt(0)
    s_barrier
    s_cmp_eq_u32 s79, 7
    s_cbranch_scc0 L_xr_22
    ds_read_b64 v[20:21], v12 offset:16384
    ds_read_b64 v[22:23], v13 offset:16384
    ds_read_b64 v[24:25], v14 offset:16384
    ds_read_b64 v[26:27], v15 offset:16384
    s_waitcnt lgkmcnt(0)
L_xr_22:
    s_add_u32 m0, s93, 49152
    s_add_u32 s82, s92, 8
    s_cmp_ge_u32 s82, s83
    s_cselect_b32 s80, 11, 0
    s_sub_u32 s82, s82, s80
    s_lshl_b32 s82, s82, 15
    s_add_u32 s82, s82, 16384
    buffer_load_dwordx4 v244, s[40:43], s82 offen lds
    buffer_load_dwordx4 v245, s[40:43], s82 offen offset:1024 lds
    s_add_u32 m0, s93, 57344
    s_add_u32 s82, s27, 0
    s_and_b32 s82, s82, 3
    s_lshl2_add_u32 s82, s31, s82
    s_lshl_b32 s82, s82, 15
    buffer_load_dwordx4 v246, s[44:47], s82 offen lds
    buffer_load_dwordx4 v247, s[44:47], s82 offen offset:1024 lds
    s_add_u32 m0, s93, 32768
    s_add_u32 s82, s27, 0
    s_and_b32 s82, s82, 3
    s_lshl2_add_u32 s82, s31, s82
    s_lshl_b32 s82, s82, 15
    s_add_u32 s82, s82, 4096
    buffer_load_dwordx4 v246, s[44:47], s82 offen lds
    buffer_load_dwordx4 v247, s[44:47], s82 offen offset:1024 lds
    s_waitcnt vmcnt(10)
    v_add_u32 v240, 65536, v240
    v_add_u32 v241, 65536, v241
    v_add_u32 v242, 65536, v242
    v_add_u32 v243, 65536, v243
    ds_read_b64_tr_b16 v[68:69], v240 offset:8192
    ds_read_b64_tr_b16 v[72:73], v241 offset:8192
    ds_read_b64_tr_b16 v[76:77], v242 offset:8192
    ds_read_b64_tr_b16 v[80:81], v243 offset:8192
    s_add_u32 m0, s93, 40960
    s_add_u32 s82, s92, 9
    s_cmp_ge_u32 s82, s83
    s_cselect_b32 s80, 11, 0
    s_sub_u32 s82, s82, s80
    s_lshl_b32 s82, s82, 15
    buffer_load_dwordx4 v244, s[40:43], s82 offen lds
    buffer_load_dwordx4 v245, s[40:43], s82 offen offset:1024 lds
    s_waitcnt vmcnt(10)
    s_waitcnt lgkmcnt(0)
    ds_read_b64_tr_b16 v[70:71], v240 offset:24576
    ds_read_b64_tr_b16 v[74:75], v241 offset:24576
    ds_read_b64_tr_b16 v[78:79], v242 offset:24576
    ds_read_b64_tr_b16 v[82:83], v243 offset:24576
    s_add_u32 m0, s93, 139264
    s_add_u32 s82, s92, 9
    s_cmp_ge_u32 s82, s83
    s_cselect_b32 s80, 11, 0
    s_sub_u32 s82, s82, s80
    s_lshl_b32 s82, s82, 15
    s_add_u32 s82, s82, 16384
    buffer_load_dwordx4 v244, s[40:43], s82 offen lds
    buffer_load_dwordx4 v245, s[40:43], s82 offen offset:1024 lds
    s_waitcnt vmcnt(10)
    s_waitcnt lgkmcnt(0)
    ds_read_b64_tr_b16 v[84:85], v240 offset:0
    ds_read_b64_tr_b16 v[88:89], v241 offset:0
    ds_read_b64_tr_b16 v[92:93], v242 offset:0
    ds_read_b64_tr_b16 v[96:97], v243 offset:0
    s_add_u32 m0, s93, 155648
    s_add_u32 s82, s92, 10
    s_cmp_ge_u32 s82, s83
    s_cselect_b32 s80, 11, 0
    s_sub_u32 s82, s82, s80
    s_lshl_b32 s82, s82, 15
    buffer_load_dwordx4 v244, s[40:43], s82 offen lds
    buffer_load_dwordx4 v245, s[40:43], s82 offen offset:1024 lds
    s_waitcnt vmcnt(10)
    s_waitcnt lgkmcnt(0)
    ds_read_b64_tr_b16 v[86:87], v236 offset:49152
    ds_read_b64_tr_b16 v[90:91], v237 offset:49152
    ds_read_b64_tr_b16 v[94:95], v238 offset:49152
    ds_read_b64_tr_b16 v[98:99], v239 offset:49152
    s_add_u32 m0, s93, 131072
    s_add_u32 s82, s92, 10
    s_cmp_ge_u32 s82, s83
    s_cselect_b32 s80, 11, 0
    s_sub_u32 s82, s82, s80
    s_lshl_b32 s82, s82, 15
    s_add_u32 s82, s82, 16384
    buffer_load_dwordx4 v244, s[40:43], s82 offen lds
    buffer_load_dwordx4 v245, s[40:43], s82 offen offset:1024 lds
    s_waitcnt vmcnt(10)
    s_waitcnt lgkmcnt(0)
    ds_read_b64_tr_b16 v[132:133], v236 offset:57344
    ds_read_b64_tr_b16 v[136:137], v237 offset:57344
    ds_read_b64_tr_b16 v[140:141], v238 offset:57344
    ds_read_b64_tr_b16 v[144:145], v239 offset:57344
    s_add_u32 m0, s93, 114688
    s_add_u32 s82, s27, 1
    s_and_b32 s82, s82, 3
    s_lshl2_add_u32 s82, s31, s82
    s_lshl_b32 s82, s82, 15
    buffer_load_dwordx4 v246, s[44:47], s82 offen lds
    buffer_load_dwordx4 v247, s[44:47], s82 offen offset:1024 lds
    s_waitcnt vmcnt(10)
    s_waitcnt lgkmcnt(0)
    ds_read_b64_tr_b16 v[134:135], v236 offset:32768
    ds_read_b64_tr_b16 v[138:139], v237 offset:32768
    ds_read_b64_tr_b16 v[142:143], v238 offset:32768
    ds_read_b64_tr_b16 v[146:147], v239 offset:32768
    s_add_u32 m0, s93, 122880
    s_add_u32 s82, s27, 1
    s_and_b32 s82, s82, 3
    s_lshl2_add_u32 s82, s31, s82
    s_lshl_b32 s82, s82, 15
    s_add_u32 s82, s82, 4096
    buffer_load_dwordx4 v246, s[44:47], s82 offen lds
    buffer_load_dwordx4 v247, s[44:47], s82 offen offset:1024 lds
    s_waitcnt vmcnt(10)
    s_waitcnt lgkmcnt(0)
    ds_read_b64_tr_b16 v[100:101], v236 offset:40960
    ds_read_b64_tr_b16 v[104:105], v237 offset:40960
    ds_read_b64_tr_b16 v[108:109], v238 offset:40960
    ds_read_b64_tr_b16 v[112:113], v239 offset:40960
    s_add_u32 m0, s93, 0
    s_add_u32 s82, s92, 1
    s_cmp_ge_u32 s82, s83
    s_cselect_b32 s80, 11, 0
    s_sub_u32 s82, s82, s80
    s_lshl_b32 s82, s82, 15
    buffer_load_dwordx4 v244, s[40:43], s82 offen lds
    buffer_load_dwordx4 v245, s[40:43], s82 offen offset:1024 lds
    s_waitcnt vmcnt(10)
    s_waitcnt lgkmcnt(0)
    ds_read_b64_tr_b16 v[102:103], v240 offset:8192
    ds_read_b64_tr_b16 v[106:107], v241 offset:8192
    ds_read_b64_tr_b16 v[110:111], v242 offset:8192
    ds_read_b64_tr_b16 v[114:115], v243 offset:8192
    s_add_u32 m0, s93, 8192
    s_add_u32 s82, s92, 1
    s_cmp_ge_u32 s82, s83
    s_cselect_b32 s80, 11, 0
    s_sub_u32 s82, s82, s80
    s_lshl_b32 s82, s82, 15
    s_add_u32 s82, s82, 16384
    buffer_load_dwordx4 v244, s[40:43], s82 offen lds
    buffer_load_dwordx4 v245, s[40:43], s82 offen offset:1024 lds
    s_waitcnt vmcnt(10)
    s_waitcnt lgkmcnt(0)
    ds_read_b64_tr_b16 v[116:117], v240 offset:24576
    ds_read_b64_tr_b16 v[120:121], v241 offset:24576
    ds_read_b64_tr_b16 v[124:125], v242 offset:24576
    ds_read_b64_tr_b16 v[128:129], v243 offset:24576
    s_add_u32 m0, s93, 65536
    s_add_u32 s82, s92, 2
    s_cmp_ge_u32 s82, s83
    s_cselect_b32 s80, 11, 0
    s_sub_u32 s82, s82, s80
    s_lshl_b32 s82, s82, 15
    buffer_load_dwordx4 v244, s[40:43], s82 offen lds
    buffer_load_dwordx4 v245, s[40:43], s82 offen offset:1024 lds
    s_waitcnt vmcnt(10)
    s_waitcnt lgkmcnt(0)
    ds_read_b64_tr_b16 v[118:119], v240 offset:0
    ds_read_b64_tr_b16 v[122:123], v241 offset:0
    ds_read_b64_tr_b16 v[126:127], v242 offset:0
    ds_read_b64_tr_b16 v[130:131], v243 offset:0
    s_add_u32 m0, s93, 73728
    s_add_u32 s82, s92, 2
    s_cmp_ge_u32 s82, s83
    s_cselect_b32 s80, 11, 0
    s_sub_u32 s82, s82, s80
    s_lshl_b32 s82, s82, 15
    s_add_u32 s82, s82, 16384
    buffer_load_dwordx4 v244, s[40:43], s82 offen lds
    buffer_load_dwordx4 v245, s[40:43], s82 offen offset:1024 lds
    s_waitcnt vmcnt(10)
    s_waitcnt lgkmcnt(0)
    v_add_u32 v236, 65536, v236
    v_add_u32 v237, 65536, v237
    v_add_u32 v238, 65536, v238
    v_add_u32 v239, 65536, v239
    ds_read_b64_tr_b16 v[148:149], v236 offset:49152
    ds_read_b64_tr_b16 v[152:153], v237 offset:49152
    ds_read_b64_tr_b16 v[156:157], v238 offset:49152
    ds_read_b64_tr_b16 v[160:161], v239 offset:49152
    s_add_u32 m0, s93, 81920
    s_add_u32 s82, s92, 3
    s_cmp_ge_u32 s82, s83
    s_cselect_b32 s80, 11, 0
    s_sub_u32 s82, s82, s80
    s_lshl_b32 s82, s82, 15
    buffer_load_dwordx4 v244, s[40:43], s82 offen lds
    buffer_load_dwordx4 v245, s[40:43], s82 offen offset:1024 lds
    s_waitcnt vmcnt(10)
    s_waitcnt lgkmcnt(0)
    ds_read_b64_tr_b16 v[150:151], v236 offset:57344
    ds_read_b64_tr_b16 v[154:155], v237 offset:57344
    ds_read_b64_tr_b16 v[158:159], v238 offset:57344
    ds_read_b64_tr_b16 v[162:163], v239 offset:57344
    s_add_u32 m0, s93, 49152
    s_add_u32 s82, s92, 3
    s_cmp_ge_u32 s82, s83
    s_cselect_b32 s80, 11, 0
    s_sub_u32 s82, s82, s80
    s_lshl_b32 s82, s82, 15
    s_add_u32 s82, s82, 16384
    buffer_load_dwordx4 v244, s[40:43], s82 offen lds
    buffer_load_dwordx4 v245, s[40:43], s82 offen offset:1024 lds
    s_waitcnt vmcnt(10)
    s_waitcnt lgkmcnt(0)
    s_add_u32 m0, s93, 57344
    s_add_u32 s82, s92, 4
    s_cmp_ge_u32 s82, s83
    s_cselect_b32 s80, 11, 0
    s_sub_u32 s82, s82, s80
    s_lshl_b32 s82, s82, 15
    buffer_load_dwordx4 v244, s[40:43], s82 offen lds
    buffer_load_dwordx4 v245, s[40:43], s82 offen offset:1024 lds
    s_waitcnt vmcnt(10)
    s_add_u32 m0, s93, 32768
    s_add_u32 s82, s92, 4
    s_cmp_ge_u32 s82, s83
    s_cselect_b32 s80, 11, 0
    s_sub_u32 s82, s82, s80
    s_lshl_b32 s82, s82, 15
    s_add_u32 s82, s82, 16384
    buffer_load_dwordx4 v244, s[40:43], s82 offen lds
    buffer_load_dwordx4 v245, s[40:43], s82 offen offset:1024 lds
    s_waitcnt vmcnt(10)
    s_add_u32 m0, s93, 139264
    s_add_u32 s82, s92, 0
    s_cmp_ge_u32 s82, s83
    s_cselect_b32 s80, 11, 0
    s_sub_u32 s82, s82, s80
    s_lshl_b32 s82, s82, 15
    buffer_load_dwordx4 v244, s[40:43], s82 offen lds
    buffer_load_dwordx4 v245, s[40:43], s82 offen offset:1024 lds
    s_waitcnt vmcnt(10)
    s_add_u32 s32, s92, 0
    s_cmp_ge_u32 s32, s83
    s_cselect_b32 s80, 11, 0
    s_sub_u32 s32, s32, s80
    s_mul_i32 s32, s32, 5120
    s_add_u32 s33, s92, 1
    s_cmp_ge_u32 s33, s83
    s_cselect_b32 s80, 11, 0
    s_sub_u32 s33, s33, s80
    s_mul_i32 s33, s33, 5120
    s_add_u32 s34, s92, 2
    s_cmp_ge_u32 s34, s83
    s_cselect_b32 s80, 11, 0
    s_sub_u32 s34, s34, s80
    s_mul_i32 s34, s34, 5120
    s_add_u32 m0, s93, 155648
    s_add_u32 s82, s92, 0
    s_cmp_ge_u32 s82, s83
    s_cselect_b32 s80, 11, 0
    s_sub_u32 s82, s82, s80
    s_lshl_b32 s82, s82, 15
    s_add_u32 s82, s82, 16384
    buffer_load_dwordx4 v244, s[40:43], s82 offen lds
    buffer_load_dwordx4 v245, s[40:43], s82 offen offset:1024 lds
    s_waitcnt vmcnt(10)
    s_add_u32 s35, s92, 3
    s_cmp_ge_u32 s35, s83
    s_cselect_b32 s80, 11, 0
    s_sub_u32 s35, s35, s80
    s_mul_i32 s35, s35, 5120
    s_add_u32 s36, s92, 4
    s_cmp_ge_u32 s36, s83
    s_cselect_b32 s80, 11, 0
    s_sub_u32 s36, s36, s80
    s_mul_i32 s36, s36, 5120
    s_add_u32 s37, s92, 5
    s_cmp_ge_u32 s37, s83
    s_cselect_b32 s80, 11, 0
    s_sub_u32 s37, s37, s80
    s_mul_i32 s37, s37, 5120
    s_add_u32 m0, s93, 40960
    s_add_u32 s82, s92, 5
    s_cmp_ge_u32 s82, s83
    s_cselect_b32 s80, 11, 0
    s_sub_u32 s82, s82, s80
    s_lshl_b32 s82, s82, 15
    buffer_load_dwordx4 v244, s[40:43], s82 offen lds
    buffer_load_dwordx4 v245, s[40:43], s82 offen offset:1024 lds
    s_waitcnt vmcnt(10)
    s_add_u32 s38, s92, 6
    s_cmp_ge_u32 s38, s83
    s_cselect_b32 s80, 11, 0
    s_sub_u32 s38, s38, s80
    s_mul_i32 s38, s38, 5120
    s_add_u32 s39, s92, 7
    s_cmp_ge_u32 s39, s83
    s_cselect_b32 s80, 11, 0
    s_sub_u32 s39, s39, s80
    s_mul_i32 s39, s39, 5120
    s_add_u32 s88, s92, 8
    s_cmp_ge_u32 s88, s83
    s_cselect_b32 s80, 11, 0
    s_sub_u32 s88, s88, s80
    s_mul_i32 s88, s88, 5120
    s_add_u32 m0, s93, 114688
    s_add_u32 s82, s92, 5
    s_cmp_ge_u32 s82, s83
    s_cselect_b32 s80, 11, 0
    s_sub_u32 s82, s82, s80
    s_lshl_b32 s82, s82, 15
    s_add_u32 s82, s82, 16384
    buffer_load_dwordx4 v244, s[40:43], s82 offen lds
    buffer_load_dwordx4 v245, s[40:43], s82 offen offset:1024 lds
    s_waitcnt vmcnt(10)
    s_add_u32 s85, s92, 9
    s_cmp_ge_u32 s85, s83
    s_cselect_b32 s80, 11, 0
    s_sub_u32 s85, s85, s80
    s_mul_i32 s85, s85, 5120
    s_add_u32 s86, s92, 10
    s_cmp_ge_u32 s86, s83
    s_cselect_b32 s80, 11, 0
    s_sub_u32 s86, s86, s80
    s_mul_i32 s86, s86, 5120
    s_add_u32 m0, s93, 122880
    s_add_u32 s82, s92, 6
    s_cmp_ge_u32 s82, s83
    s_cselect_b32 s80, 11, 0
    s_sub_u32 s82, s82, s80
    s_lshl_b32 s82, s82, 15
    buffer_load_dwordx4 v244, s[40:43], s82 offen lds
    buffer_load_dwordx4 v245, s[40:43], s82 offen offset:1024 lds
    s_waitcnt vmcnt(10)
    s_add_u32 s89, s27, 0
    s_and_b32 s89, s89, 3
    s_lshl2_add_u32 s89, s31, s89
    s_mul_i32 s89, s89, 5120
    s_add_u32 s90, s27, 1
    s_and_b32 s90, s90, 3
    s_lshl2_add_u32 s90, s31, s90
    s_mul_i32 s90, s90, 5120
    s_add_u32 s84, s27, 2
    s_and_b32 s84, s84, 3
    s_lshl2_add_u32 s84, s31, s84
    s_mul_i32 s84, s84, 5120
    s_add_u32 s91, s27, 3
    s_and_b32 s91, s91, 3
    s_lshl2_add_u32 s91, s31, s91
    s_mul_i32 s91, s91, 5120
    s_mov_b32 s80, 800000
L_ls_23:
    ds_read_b128 v[164:167], v3 offset:0
    s_sub_u32 s80, s80, 1
    s_cbranch_scc1 L_lsok_24
    s_waitcnt lgkmcnt(0)
    v_and_b32 v164, v164, v165
    v_and_b32 v166, v166, v167
    v_and_b32 v164, v164, v166
    s_nop 0
    v_readfirstlane_b32 s81, v164
    s_nop 0
    s_cmp_eq_u32 s81, 0
    s_waitcnt lgkmcnt(0)
    s_cbranch_scc1 L_ls_23
L_lsok_24:
    s_waitcnt lgkmcnt(0)
    s_add_u32 m0, s93, 16384
    s_add_u32 s82, s92, 6
    s_cmp_ge_u32 s82, s83
    s_cselect_b32 s80, 11, 0
    s_sub_u32 s82, s82, s80
    s_lshl_b32 s82, s82, 15
    s_add_u32 s82, s82, 16384
    buffer_load_dwordx4 v244, s[40:43], s82 offen lds
    buffer_load_dwordx4 v245, s[40:43], s82 offen offset:1024 lds
    s_waitcnt vmcnt(10)
    v_add_u32 v249, s93, v1
    v_lshrrev_b32 v248, 7, v1
    v_cmp_eq_u32 vcc, 3, v248
    v_add_u32 v248, 4224, v1
    s_nop 0
    v_cndmask_b32 v1, v1, v248, vcc
    v_cndmask_b32_e64 v248, 8, 1, vcc
    v_lshlrev_b32 v248, 7, v248
    v_mov_b32 v38, v248
    s_xor_b32 s80, s31, 3
    v_mad_u32_u24 v252, v38, s80, v1
    s_xor_b32 s80, s31, 2
    v_mad_u32_u24 v251, v38, s80, v1
    s_xor_b32 s80, s31, 1
    v_mad_u32_u24 v248, v38, s80, v1
    s_xor_b32 s80, s31, 0
    v_mad_u32_u24 v1, v38, s80, v1
    s_add_u32 m0, s93, 24576
    s_add_u32 s82, s27, 2
    s_and_b32 s82, s82, 3
    s_lshl2_add_u32 s82, s31, s82
    s_lshl_b32 s82, s82, 15
    buffer_load_dwordx4 v246, s[44:47], s82 offen lds
    buffer_load_dwordx4 v247, s[44:47], s82 offen offset:1024 lds
    s_waitcnt vmcnt(10)
    v_lshlrev_b32 v4, 16, v20
    v_and_b32 v5, s26, v20
    v_lshlrev_b32 v36, 16, v28
    v_and_b32 v37, s26, v28
    v_add_f32 v4, v4, v36
    v_add_f32 v5, v5, v37
    v_lshlrev_b32 v6, 16, v21
    v_and_b32 v7, s26, v21
    v_lshlrev_b32 v36, 16, v29
    v_and_b32 v37, s26, v29
    v_add_f32 v6, v6, v36
    v_add_f32 v7, v7, v37
    s_load_dwordx4 s[64:67], s[94:95], 0 glc
    s_add_u32 m0, s93, 90112
    s_add_u32 s82, s27, 2
    s_and_b32 s82, s82, 3
    s_lshl2_add_u32 s82, s31, s82
    s_lshl_b32 s82, s82, 15
    s_add_u32 s82, s82, 4096
    buffer_load_dwordx4 v246, s[44:47], s82 offen lds
    buffer_load_dwordx4 v247, s[44:47], s82 offen offset:1024 lds
    s_waitcnt vmcnt(10)
    v_lshlrev_b32 v8, 16, v22
    v_and_b32 v9, s26, v22
    v_lshlrev_b32 v36, 16, v30
    v_and_b32 v37, s26, v30
    v_add_f32 v8, v8, v36
    v_add_f32 v9, v9, v37
    v_lshlrev_b32 v10, 16, v23
    v_and_b32 v11, s26, v23
    v_lshlrev_b32 v36, 16, v31
    v_and_b32 v37, s26, v31
    v_add_f32 v10, v10, v36
    v_add_f32 v11, v11, v37
    s_add_u32 m0, s93, 98304
    s_add_u32 s82, s27, 3
    s_and_b32 s82, s82, 3
    s_lshl2_add_u32 s82, s31, s82
    s_lshl_b32 s82, s82, 15
    buffer_load_dwordx4 v246, s[44:47], s82 offen lds
    buffer_load_dwordx4 v247, s[44:47], s82 offen offset:1024 lds
    s_waitcnt vmcnt(10)
    v_lshlrev_b32 v12, 16, v24
    v_and_b32 v13, s26, v24
    v_lshlrev_b32 v36, 16, v32
    v_and_b32 v37, s26, v32
    v_add_f32 v12, v12, v36
    v_add_f32 v13, v13, v37
    v_lshlrev_b32 v14, 16, v25
    v_and_b32 v15, s26, v25
    v_lshlrev_b32 v36, 16, v33
    v_and_b32 v37, s26, v33
    v_add_f32 v14, v14, v36
    v_add_f32 v15, v15, v37
    s_add_u32 m0, s93, 106496
    s_add_u32 s82, s27, 3
    s_and_b32 s82, s82, 3
    s_lshl2_add_u32 s82, s31, s82
    s_lshl_b32 s82, s82, 15
    s_add_u32 s82, s82, 4096
    buffer_load_dwordx4 v246, s[44:47], s82 offen lds
    buffer_load_dwordx4 v247, s[44:47], s82 offen offset:1024 lds
    s_waitcnt vmcnt(10)
    v_lshlrev_b32 v16, 16, v26
    v_and_b32 v17, s26, v26
    v_lshlrev_b32 v36, 16, v34
    v_and_b32 v37, s26, v34
    v_add_f32 v16, v16, v36
    v_add_f32 v17, v17, v37
    v_lshlrev_b32 v18, 16, v27
    v_and_b32 v19, s26, v27
    v_lshlrev_b32 v36, 16, v35
    v_and_b32 v37, s26, v35
    v_add_f32 v18, v18, v36
    v_add_f32 v19, v19, v37
    ds_read_b64_tr_b16 v[164:165], v240 offset:8192
    ds_read_b64_tr_b16 v[168:169], v241 offset:8192
    ds_read_b64_tr_b16 v[172:173], v242 offset:8192
    ds_read_b64_tr_b16 v[176:177], v243 offset:8192
    ds_read_b64_tr_b16 v[166:167], v240 offset:24576
    ds_read_b64_tr_b16 v[170:171], v241 offset:24576
    ds_read_b64_tr_b16 v[174:175], v242 offset:24576
    ds_read_b64_tr_b16 v[178:179], v243 offset:24576
    v_add_u32 v240, 4294836224, v240
    v_add_u32 v241, 4294836224, v241
    v_add_u32 v242, 4294836224, v242
    v_add_u32 v243, 4294836224, v243
    v_lshrrev_b32 v246, 3, v0
    v_lshlrev_b32 v246, 4, v246
    v_xor_b32 v246, v246, v249
    s_waitcnt lgkmcnt(0)
    s_xor_b64 s[64:65], s[64:65], s[60:61]
    s_xor_b64 s[66:67], s[66:67], s[60:61]
    s_or_b64 s[64:65], s[64:65], s[66:67]
    s_cbranch_scc0 L_flok_26
    s_mov_b32 s80, 200000
L_fl_25:
    s_load_dwordx4 s[64:67], s[94:95], 0 glc
    s_sub_u32 s80, s80, 1
    s_waitcnt lgkmcnt(0)
    s_cbranch_scc1 L_flok_26
    s_xor_b64 s[64:65], s[64:65], s[60:61]
    s_xor_b64 s[66:67], s[66:67], s[60:61]
    s_or_b64 s[64:65], s[64:65], s[66:67]
    s_cbranch_scc1 L_fl_25
L_flok_26:
    buffer_load_dwordx4 v[196:199], v1, s[48:51], s32 offen sc1
    buffer_load_dwordx4 v[200:203], v248, s[48:51], s32 offen sc1
    buffer_load_dwordx4 v[204:207], v251, s[48:51], s32 offen sc1
    buffer_load_dwordx4 v[208:211], v252, s[48:51], s32 offen sc1
    buffer_load_dwordx4 v[212:215], v1, s[48:51], s33 offen sc1
    buffer_load_dwordx4 v[216:219], v248, s[48:51], s33 offen sc1
    buffer_load_dwordx4 v[220:223], v251, s[48:51], s33 offen sc1
    buffer_load_dwordx4 v[224:227], v252, s[48:51], s33 offen sc1
    s_waitcnt vmcnt(7) lgkmcnt(0)
    v_mfma_f32_16x16x32_bf16 v[4:7], v[164:167], v[196:199], v[4:7]
    buffer_load_dwordx4 v[228:231], v1, s[48:51], s34 offen sc1
    v_mfma_f32_16x16x32_bf16 v[8:11], v[168:171], v[196:199], v[8:11]
    ds_read_b64_tr_b16 v[180:181], v240 offset:0
    v_mfma_f32_16x16x32_bf16 v[12:15], v[172:175], v[196:199], v[12:15]
    ds_read_b64_tr_b16 v[184:185], v241 offset:0
    v_mfma_f32_16x16x32_bf16 v[16:19], v[176:179], v[196:199], v[16:19]
    ds_read_b64_tr_b16 v[188:189], v242 offset:0
    s_waitcnt vmcnt(7)
    v_mfma_f32_16x16x32_bf16 v[32:35], v[176:179], v[200:203], 0
    buffer_load_dwordx4 v[196:199], v248, s[48:51], s34 offen sc1
    v_mfma_f32_16x16x32_bf16 v[28:31], v[172:175], v[200:203], 0
    ds_read_b64_tr_b16 v[192:193], v243 offset:0
    v_mfma_f32_16x16x32_bf16 v[24:27], v[168:171], v[200:203], 0
    ds_read_b64_tr_b16 v[182:183], v240 offset:8192
    v_mfma_f32_16x16x32_bf16 v[20:23], v[164:167], v[200:203], 0
    ds_read_b64_tr_b16 v[186:187], v241 offset:8192
    s_waitcnt vmcnt(7)
    v_mfma_f32_16x16x32_bf16 v[36:39], v[164:167], v[204:207], 0
    buffer_load_dwordx4 v[200:203], v251, s[48:51], s34 offen sc1
    v_mfma_f32_16x16x32_bf16 v[40:43], v[168:171], v[204:207], 0
    ds_read_b64_tr_b16 v[190:191], v242 offset:8192
    v_mfma_f32_16x16x32_bf16 v[44:47], v[172:175], v[204:207], 0
    ds_read_b64_tr_b16 v[194:195], v243 offset:8192
    v_mfma_f32_16x16x32_bf16 v[48:51], v[176:179], v[204:207], 0
    s_waitcnt vmcnt(7)
    v_mfma_f32_16x16x32_bf16 v[64:67], v[176:179], v[208:211], 0
    buffer_load_dwordx4 v[204:207], v252, s[48:51], s34 offen sc1
    v_mfma_f32_16x16x32_bf16 v[60:63], v[172:175], v[208:211], 0
    v_mfma_f32_16x16x32_bf16 v[56:59], v[168:171], v[208:211], 0
    v_mfma_f32_16x16x32_bf16 v[52:55], v[164:167], v[208:211], 0
    s_waitcnt vmcnt(7) lgkmcnt(0)
    v_mfma_f32_16x16x32_bf16 v[4:7], v[180:183], v[212:215], v[4:7]
    buffer_load_dwordx4 v[208:211], v1, s[48:51], s35 offen sc1
    v_mfma_f32_16x16x32_bf16 v[8:11], v[184:187], v[212:215], v[8:11]
    ds_read_b64_tr_b16 v[164:165], v236 offset:0
    v_mfma_f32_16x16x32_bf16 v[12:15], v[188:191], v[212:215], v[12:15]
    ds_read_b64_tr_b16 v[168:169], v237 offset:0
    v_mfma_f32_16x16x32_bf16 v[16:19], v[192:195], v[212:215], v[16:19]
    ds_read_b64_tr_b16 v[172:173], v238 offset:0
    s_waitcnt vmcnt(7)
    v_mfma_f32_16x16x32_bf16 v[32:35], v[192:195], v[216:219], v[32:35]
    buffer_load_dwordx4 v[212:215], v248, s[48:51], s35 offen sc1
    v_mfma_f32_16x16x32_bf16 v[28:31], v[188:191], v[216:219], v[28:31]
    ds_read_b64_tr_b16 v[176:177], v239 offset:0
    v_mfma_f32_16x16x32_bf16 v[24:27], v[184:187], v[216:219], v[24:27]
    ds_read_b64_tr_b16 v[166:167], v236 offset:8192
    v_mfma_f32_16x16x32_bf16 v[20:23], v[180:183], v[216:219], v[20:23]
    ds_read_b64_tr_b16 v[170:171], v237 offset:8192
    s_waitcnt vmcnt(7)
    v_mfma_f32_16x16x32_bf16 v[36:39], v[180:183], v[220:223], v[36:39]
    buffer_load_dwordx4 v[216:219], v251, s[48:51], s35 offen sc1
    v_mfma_f32_16x16x32_bf16 v[40:43], v[184:187], v[220:223], v[40:43]
    ds_read_b64_tr_b16 v[174:175], v238 offset:8192
    v_mfma_f32_16x16x32_bf16 v[44:47], v[188:191], v[220:223], v[44:47]
    ds_read_b64_tr_b16 v[178:179], v239 offset:8192
    v_mfma_f32_16x16x32_bf16 v[48:51], v[192:195], v[220:223], v[48:51]
    s_waitcnt vmcnt(7)
    v_mfma_f32_16x16x32_bf16 v[64:67], v[192:195], v[224:227], v[64:67]
    buffer_load_dwordx4 v[220:223], v252, s[48:51], s35 offen sc1
    v_mfma_f32_16x16x32_bf16 v[60:63], v[188:191], v[224:227], v[60:63]
    v_mfma_f32_16x16x32_bf16 v[56:59], v[184:187], v[224:227], v[56:59]
    v_mfma_f32_16x16x32_bf16 v[52:55], v[180:183], v[224:227], v[52:55]
    s_waitcnt vmcnt(7) lgkmcnt(0)
    v_mfma_f32_16x16x32_bf16 v[4:7], v[164:167], v[228:231], v[4:7]
    buffer_load_dwordx4 v[224:227], v1, s[48:51], s36 offen sc1
    v_mfma_f32_16x16x32_bf16 v[8:11], v[168:171], v[228:231], v[8:11]
    ds_read_b64_tr_b16 v[180:181], v236 offset:16384
    v_mfma_f32_16x16x32_bf16 v[12:15], v[172:175], v[228:231], v[12:15]
    ds_read_b64_tr_b16 v[184:185], v237 offset:16384
    v_mfma_f32_16x16x32_bf16 v[16:19], v[176:179], v[228:231], v[16:19]
    ds_read_b64_tr_b16 v[188:189], v238 offset:16384
    s_waitcnt vmcnt(7)
    v_mfma_f32_16x16x32_bf16 v[32:35], v[176:179], v[196:199], v[32:35]
    buffer_load_dwordx4 v[228:231], v248, s[48:51], s36 offen sc1
    v_mfma_f32_16x16x32_bf16 v[28:31], v[172:175], v[196:199], v[28:31]
    ds_read_b64_tr_b16 v[192:193], v239 offset:16384
    v_mfma_f32_16x16x32_bf16 v[24:27], v[168:171], v[196:199], v[24:27]
    ds_read_b64_tr_b16 v[182:183], v240 offset:49152
    v_mfma_f32_16x16x32_bf16 v[20:23], v[164:167], v[196:199], v[20:23]
    ds_read_b64_tr_b16 v[186:187], v241 offset:49152
    s_waitcnt vmcnt(7)
    v_mfma_f32_16x16x32_bf16 v[36:39], v[164:167], v[200:203], v[36:39]
    buffer_load_dwordx4 v[196:199], v251, s[48:51], s36 offen sc1
    v_mfma_f32_16x16x32_bf16 v[40:43], v[168:171], v[200:203], v[40:43]
    ds_read_b64_tr_b16 v[190:191], v242 offset:49152
    v_mfma_f32_16x16x32_bf16 v[44:47], v[172:175], v[200:203], v[44:47]
    ds_read_b64_tr_b16 v[194:195], v243 offset:49152
    v_mfma_f32_16x16x32_bf16 v[48:51], v[176:179], v[200:203], v[48:51]
    s_waitcnt vmcnt(7)
    v_mfma_f32_16x16x32_bf16 v[64:67], v[176:179], v[204:207], v[64:67]
    buffer_load_dwordx4 v[200:203], v252, s[48:51], s36 offen sc1
    v_mfma_f32_16x16x32_bf16 v[60:63], v[172:175], v[204:207], v[60:63]
    v_mfma_f32_16x16x32_bf16 v[56:59], v[168:171], v[204:207], v[56:59]
    v_mfma_f32_16x16x32_bf16 v[52:55], v[164:167], v[204:207], v[52:55]
    s_waitcnt vmcnt(7) lgkmcnt(0)
    v_mfma_f32_16x16x32_bf16 v[4:7], v[180:183], v[208:211], v[4:7]
    buffer_load_dwordx4 v[204:207], v1, s[48:51], s37 offen sc1
    v_mfma_f32_16x16x32_bf16 v[8:11], v[184:187], v[208:211], v[8:11]
    ds_read_b64_tr_b16 v[164:165], v240 offset:57344
    v_mfma_f32_16x16x32_bf16 v[12:15], v[188:191], v[208:211], v[12:15]
    ds_read_b64_tr_b16 v[168:169], v241 offset:57344
    v_mfma_f32_16x16x32_bf16 v[16:19], v[192:195], v[208:211], v[16:19]
    ds_read_b64_tr_b16 v[172:173], v242 offset:57344
    s_waitcnt vmcnt(7)
    v_mfma_f32_16x16x32_bf16 v[32:35], v[192:195], v[212:215], v[32:35]
    buffer_load_dwordx4 v[208:211], v248, s[48:51], s37 offen sc1
    v_mfma_f32_16x16x32_bf16 v[28:31], v[188:191], v[212:215], v[28:31]
    ds_read_b64_tr_b16 v[176:177], v243 offset:57344
    v_mfma_f32_16x16x32_bf16 v[24:27], v[184:187], v[212:215], v[24:27]
    ds_read_b64_tr_b16 v[166:167], v240 offset:32768
    v_mfma_f32_16x16x32_bf16 v[20:23], v[180:183], v[212:215], v[20:23]
    ds_read_b64_tr_b16 v[170:171], v241 offset:32768
    s_waitcnt vmcnt(7)
    v_mfma_f32_16x16x32_bf16 v[36:39], v[180:183], v[216:219], v[36:39]
    buffer_load_dwordx4 v[212:215], v251, s[48:51], s37 offen sc1
    v_mfma_f32_16x16x32_bf16 v[40:43], v[184:187], v[216:219], v[40:43]
    ds_read_b64_tr_b16 v[174:175], v242 offset:32768
    v_mfma_f32_16x16x32_bf16 v[44:47], v[188:191], v[216:219], v[44:47]
    ds_read_b64_tr_b16 v[178:179], v243 offset:32768
    v_mfma_f32_16x16x32_bf16 v[48:51], v[192:195], v[216:219], v[48:51]
    s_waitcnt vmcnt(7)
    v_mfma_f32_16x16x32_bf16 v[64:67], v[192:195], v[220:223], v[64:67]
    buffer_load_dwordx4 v[216:219], v252, s[48:51], s37 offen sc1
    v_mfma_f32_16x16x32_bf16 v[60:63], v[188:191], v[220:223], v[60:63]
    v_mfma_f32_16x16x32_bf16 v[56:59], v[184:187], v[220:223], v[56:59]
    v_mfma_f32_16x16x32_bf16 v[52:55], v[180:183], v[220:223], v[52:55]
    s_waitcnt vmcnt(7) lgkmcnt(0)
    v_mfma_f32_16x16x32_bf16 v[4:7], v[164:167], v[224:227], v[4:7]
    buffer_load_dwordx4 v[220:223], v1, s[48:51], s38 offen sc1
    v_mfma_f32_16x16x32_bf16 v[8:11], v[168:171], v[224:227], v[8:11]
    ds_read_b64_tr_b16 v[180:181], v240 offset:40960
    v_mfma_f32_16x16x32_bf16 v[12:15], v[172:175], v[224:227], v[12:15]
    ds_read_b64_tr_b16 v[184:185], v241 offset:40960
    v_mfma_f32_16x16x32_bf16 v[16:19], v[176:179], v[224:227], v[16:19]
    ds_read_b64_tr_b16 v[188:189], v242 offset:40960
    s_waitcnt vmcnt(7)
    v_mfma_f32_16x16x32_bf16 v[32:35], v[176:179], v[228:231], v[32:35]
    buffer_load_dwordx4 v[224:227], v248, s[48:51], s38 offen sc1
    v_mfma_f32_16x16x32_bf16 v[28:31], v[172:175], v[228:231], v[28:31]
    ds_read_b64_tr_b16 v[192:193], v243 offset:40960
    v_mfma_f32_16x16x32_bf16 v[24:27], v[168:171], v[228:231], v[24:27]
    ds_read_b64_tr_b16 v[182:183], v236 offset:49152
    v_mfma_f32_16x16x32_bf16 v[20:23], v[164:167], v[228:231], v[20:23]
    ds_read_b64_tr_b16 v[186:187], v237 offset:49152
    s_waitcnt vmcnt(7)
    v_mfma_f32_16x16x32_bf16 v[36:39], v[164:167], v[196:199], v[36:39]
    buffer_load_dwordx4 v[228:231], v251, s[48:51], s38 offen sc1
    v_mfma_f32_16x16x32_bf16 v[40:43], v[168:171], v[196:199], v[40:43]
    ds_read_b64_tr_b16 v[190:191], v238 offset:49152
    v_mfma_f32_16x16x32_bf16 v[44:47], v[172:175], v[196:199], v[44:47]
    ds_read_b64_tr_b16 v[194:195], v239 offset:49152
    v_mfma_f32_16x16x32_bf16 v[48:51], v[176:179], v[196:199], v[48:51]
    s_waitcnt vmcnt(7)
    v_mfma_f32_16x16x32_bf16 v[64:67], v[176:179], v[200:203], v[64:67]
    buffer_load_dwordx4 v[196:199], v252, s[48:51], s38 offen sc1
    v_mfma_f32_16x16x32_bf16 v[60:63], v[172:175], v[200:203], v[60:63]
    v_mfma_f32_16x16x32_bf16 v[56:59], v[168:171], v[200:203], v[56:59]
    v_mfma_f32_16x16x32_bf16 v[52:55], v[164:167], v[200:203], v[52:55]
    s_waitcnt vmcnt(7) lgkmcnt(0)
    v_mfma_f32_16x16x32_bf16 v[4:7], v[180:183], v[204:207], v[4:7]
    buffer_load_dwordx4 v[200:203], v1, s[48:51], s39 offen sc1
    v_mfma_f32_16x16x32_bf16 v[8:11], v[184:187], v[204:207], v[8:11]
    ds_read_b64_tr_b16 v[164:165], v236 offset:57344
    v_mfma_f32_16x16x32_bf16 v[12:15], v[188:191], v[204:207], v[12:15]
    ds_read_b64_tr_b16 v[168:169], v237 offset:57344
    v_mfma_f32_16x16x32_bf16 v[16:19], v[192:195], v[204:207], v[16:19]
    ds_read_b64_tr_b16 v[172:173], v238 offset:57344
    s_waitcnt vmcnt(7)
    v_mfma_f32_16x16x32_bf16 v[32:35], v[192:195], v[208:211], v[32:35]
    buffer_load_dwordx4 v[204:207], v248, s[48:51], s39 offen sc1
    v_mfma_f32_16x16x32_bf16 v[28:31], v[188:191], v[208:211], v[28:31]
    ds_read_b64_tr_b16 v[176:177], v239 offset:57344
    v_mfma_f32_16x16x32_bf16 v[24:27], v[184:187], v[208:211], v[24:27]
    ds_read_b64_tr_b16 v[166:167], v240 offset:16384
    v_mfma_f32_16x16x32_bf16 v[20:23], v[180:183], v[208:211], v[20:23]
    ds_read_b64_tr_b16 v[170:171], v241 offset:16384
    s_waitcnt vmcnt(7)
    v_mfma_f32_16x16x32_bf16 v[36:39], v[180:183], v[212:215], v[36:39]
    buffer_load_dwordx4 v[208:211], v251, s[48:51], s39 offen sc1
    v_mfma_f32_16x16x32_bf16 v[40:43], v[184:187], v[212:215], v[40:43]
    ds_read_b64_tr_b16 v[174:175], v242 offset:16384
    v_mfma_f32_16x16x32_bf16 v[44:47], v[188:191], v[212:215], v[44:47]
    ds_read_b64_tr_b16 v[178:179], v243 offset:16384
    v_mfma_f32_16x16x32_bf16 v[48:51], v[192:195], v[212:215], v[48:51]
    s_waitcnt vmcnt(7)
    v_mfma_f32_16x16x32_bf16 v[64:67], v[192:195], v[216:219], v[64:67]
    buffer_load_dwordx4 v[212:215], v252, s[48:51], s39 offen sc1
    v_mfma_f32_16x16x32_bf16 v[60:63], v[188:191], v[216:219], v[60:63]
    v_mfma_f32_16x16x32_bf16 v[56:59], v[184:187], v[216:219], v[56:59]
    v_mfma_f32_16x16x32_bf16 v[52:55], v[180:183], v[216:219], v[52:55]
    s_waitcnt vmcnt(7) lgkmcnt(0)
    v_mfma_f32_16x16x32_bf16 v[4:7], v[164:167], v[220:223], v[4:7]
    buffer_load_dwordx4 v[216:219], v1, s[48:51], s88 offen sc1
    v_mfma_f32_16x16x32_bf16 v[8:11], v[168:171], v[220:223], v[8:11]
    ds_read_b64_tr_b16 v[180:181], v240 offset:24576
    v_mfma_f32_16x16x32_bf16 v[12:15], v[172:175], v[220:223], v[12:15]
    ds_read_b64_tr_b16 v[184:185], v241 offset:24576
    v_mfma_f32_16x16x32_bf16 v[16:19], v[176:179], v[220:223], v[16:19]
    ds_read_b64_tr_b16 v[188:189], v242 offset:24576
    s_waitcnt vmcnt(7)
    v_mfma_f32_16x16x32_bf16 v[32:35], v[176:179], v[224:227], v[32:35]
    buffer_load_dwordx4 v[220:223], v248, s[48:51], s88 offen sc1
    v_mfma_f32_16x16x32_bf16 v[28:31], v[172:175], v[224:227], v[28:31]
    ds_read_b64_tr_b16 v[192:193], v243 offset:24576
    v_mfma_f32_16x16x32_bf16 v[24:27], v[168:171], v[224:227], v[24:27]
    ds_read_b64_tr_b16 v[182:183], v236 offset:24576
    v_mfma_f32_16x16x32_bf16 v[20:23], v[164:167], v[224:227], v[20:23]
    ds_read_b64_tr_b16 v[186:187], v237 offset:24576
    s_waitcnt vmcnt(7)
    v_mfma_f32_16x16x32_bf16 v[36:39], v[164:167], v[228:231], v[36:39]
    buffer_load_dwordx4 v[224:227], v251, s[48:51], s88 offen sc1
    v_mfma_f32_16x16x32_bf16 v[40:43], v[168:171], v[228:231], v[40:43]
    ds_read_b64_tr_b16 v[190:191], v238 offset:24576
    v_mfma_f32_16x16x32_bf16 v[44:47], v[172:175], v[228:231], v[44:47]
    ds_read_b64_tr_b16 v[194:195], v239 offset:24576
    v_mfma_f32_16x16x32_bf16 v[48:51], v[176:179], v[228:231], v[48:51]
    s_waitcnt vmcnt(7)
    v_mfma_f32_16x16x32_bf16 v[64:67], v[176:179], v[196:199], v[64:67]
    buffer_load_dwordx4 v[228:231], v252, s[48:51], s88 offen sc1
    v_mfma_f32_16x16x32_bf16 v[60:63], v[172:175], v[196:199], v[60:63]
    v_mfma_f32_16x16x32_bf16 v[56:59], v[168:171], v[196:199], v[56:59]
    v_mfma_f32_16x16x32_bf16 v[52:55], v[164:167], v[196:199], v[52:55]
    s_waitcnt vmcnt(7)
    v_mfma_f32_16x16x32_bf16 v[4:7], v[68:71], v[200:203], v[4:7]
    buffer_load_dwordx4 v[196:199], v1, s[48:51], s85 offen sc1
    v_mfma_f32_16x16x32_bf16 v[8:11], v[72:75], v[200:203], v[8:11]
    ds_read_b64_tr_b16 v[164:165], v236 offset:32768
    v_mfma_f32_16x16x32_bf16 v[12:15], v[76:79], v[200:203], v[12:15]
    ds_read_b64_tr_b16 v[168:169], v237 offset:32768
    v_mfma_f32_16x16x32_bf16 v[16:19], v[80:83], v[200:203], v[16:19]
    ds_read_b64_tr_b16 v[172:173], v238 offset:32768
    s_waitcnt vmcnt(7)
    v_mfma_f32_16x16x32_bf16 v[32:35], v[80:83], v[204:207], v[32:35]
    buffer_load_dwordx4 v[200:203], v248, s[48:51], s85 offen sc1
    v_mfma_f32_16x16x32_bf16 v[28:31], v[76:79], v[204:207], v[28:31]
    ds_read_b64_tr_b16 v[176:177], v239 offset:32768
    v_mfma_f32_16x16x32_bf16 v[24:27], v[72:75], v[204:207], v[24:27]
    ds_read_b64_tr_b16 v[166:167], v236 offset:40960
    v_mfma_f32_16x16x32_bf16 v[20:23], v[68:71], v[204:207], v[20:23]
    ds_read_b64_tr_b16 v[170:171], v237 offset:40960
    s_load_dwordx8 s[64:71], s[94:95], 32 glc
    s_waitcnt vmcnt(7)
    v_mfma_f32_16x16x32_bf16 v[36:39], v[68:71], v[208:211], v[36:39]
    buffer_load_dwordx4 v[204:207], v251, s[48:51], s85 offen sc1
    v_mfma_f32_16x16x32_bf16 v[40:43], v[72:75], v[208:211], v[40:43]
    ds_read_b64_tr_b16 v[174:175], v238 offset:40960
    v_mfma_f32_16x16x32_bf16 v[44:47], v[76:79], v[208:211], v[44:47]
    ds_read_b64_tr_b16 v[178:179], v239 offset:40960
    v_mfma_f32_16x16x32_bf16 v[48:51], v[80:83], v[208:211], v[48:51]
    s_waitcnt vmcnt(7)
    v_mfma_f32_16x16x32_bf16 v[64:67], v[80:83], v[212:215], v[64:67]
    buffer_load_dwordx4 v[208:211], v252, s[48:51], s85 offen sc1
    v_mfma_f32_16x16x32_bf16 v[60:63], v[76:79], v[212:215], v[60:63]
    v_mfma_f32_16x16x32_bf16 v[56:59], v[72:75], v[212:215], v[56:59]
    v_mfma_f32_16x16x32_bf16 v[52:55], v[68:71], v[212:215], v[52:55]
    s_waitcnt vmcnt(7)
    v_mfma_f32_16x16x32_bf16 v[4:7], v[84:87], v[216:219], v[4:7]
    buffer_load_dwordx4 v[212:215], v1, s[48:51], s86 offen sc1
    v_mfma_f32_16x16x32_bf16 v[8:11], v[88:91], v[216:219], v[8:11]
    v_mfma_f32_16x16x32_bf16 v[12:15], v[92:95], v[216:219], v[12:15]
    v_mfma_f32_16x16x32_bf16 v[16:19], v[96:99], v[216:219], v[16:19]
    s_waitcnt vmcnt(7)
    v_mfma_f32_16x16x32_bf16 v[32:35], v[96:99], v[220:223], v[32:35]
    buffer_load_dwordx4 v[216:219], v248, s[48:51], s86 offen sc1
    v_mfma_f32_16x16x32_bf16 v[28:31], v[92:95], v[220:223], v[28:31]
    v_mfma_f32_16x16x32_bf16 v[24:27], v[88:91], v[220:223], v[24:27]
    v_mfma_f32_16x16x32_bf16 v[20:23], v[84:87], v[220:223], v[20:23]
    s_waitcnt vmcnt(7)
    v_mfma_f32_16x16x32_bf16 v[36:39], v[84:87], v[224:227], v[36:39]
    buffer_load_dwordx4 v[220:223], v251, s[48:51], s86 offen sc1
    v_mfma_f32_16x16x32_bf16 v[40:43], v[88:91], v[224:227], v[40:43]
    v_mfma_f32_16x16x32_bf16 v[44:47], v[92:95], v[224:227], v[44:47]
    v_mfma_f32_16x16x32_bf16 v[48:51], v[96:99], v[224:227], v[48:51]
    s_waitcnt vmcnt(7)
    v_mfma_f32_16x16x32_bf16 v[64:67], v[96:99], v[228:231], v[64:67]
    buffer_load_dwordx4 v[224:227], v252, s[48:51], s86 offen sc1
    v_mfma_f32_16x16x32_bf16 v[60:63], v[92:95], v[228:231], v[60:63]
    v_mfma_f32_16x16x32_bf16 v[56:59], v[88:91], v[228:231], v[56:59]
    v_mfma_f32_16x16x32_bf16 v[52:55], v[84:87], v[228:231], v[52:55]
    s_waitcnt lgkmcnt(0)
    s_xor_b64 s[64:65], s[64:65], s[60:61]
    s_xor_b64 s[66:67], s[66:67], s[60:61]
    s_xor_b64 s[68:69], s[68:69], s[60:61]
    s_xor_b64 s[70:71], s[70:71], s[60:61]
    s_or_b64 s[64:65], s[64:65], s[68:69]
    s_or_b64 s[66:67], s[66:67], s[70:71]
    s_or_b64 s[64:65], s[64:65], s[66:67]
    s_cbranch_scc0 L_flok_28
    s_mov_b32 s80, 200000
L_fl_27:
    s_load_dwordx8 s[64:71], s[94:95], 32 glc
    s_sub_u32 s80, s80, 1
    s_waitcnt lgkmcnt(0)
    s_cbranch_scc1 L_flok_28
    s_xor_b64 s[64:65], s[64:65], s[60:61]
    s_xor_b64 s[66:67], s[66:67], s[60:61]
    s_xor_b64 s[68:69], s[68:69], s[60:61]
    s_xor_b64 s[70:71], s[70:71], s[60:61]
    s_or_b64 s[64:65], s[64:65], s[68:69]
    s_or_b64 s[66:67], s[66:67], s[70:71]
    s_or_b64 s[64:65], s[64:65], s[66:67]
    s_cbranch_scc1 L_fl_27
L_flok_28:
    s_waitcnt vmcnt(7)
    v_mfma_f32_16x16x32_bf16 v[4:7], v[100:103], v[196:199], v[4:7]
    buffer_load_dwordx4 v[228:231], v248, s[52:55], s89 offen sc1
    v_mfma_f32_16x16x32_bf16 v[8:11], v[104:107], v[196:199], v[8:11]
    v_mfma_f32_16x16x32_bf16 v[12:15], v[108:111], v[196:199], v[12:15]
    v_mfma_f32_16x16x32_bf16 v[16:19], v[112:115], v[196:199], v[16:19]
    s_waitcnt vmcnt(7)
    v_mfma_f32_16x16x32_bf16 v[32:35], v[112:115], v[200:203], v[32:35]
    buffer_load_dwordx4 v[196:199], v248, s[52:55], s90 offen sc1
    v_mfma_f32_16x16x32_bf16 v[28:31], v[108:111], v[200:203], v[28:31]
    v_mfma_f32_16x16x32_bf16 v[24:27], v[104:107], v[200:203], v[24:27]
    v_mfma_f32_16x16x32_bf16 v[20:23], v[100:103], v[200:203], v[20:23]
    s_waitcnt vmcnt(7)
    v_mfma_f32_16x16x32_bf16 v[36:39], v[100:103], v[204:207], v[36:39]
    buffer_load_dwordx4 v[200:203], v248, s[52:55], s84 offen sc1
    v_mfma_f32_16x16x32_bf16 v[40:43], v[104:107], v[204:207], v[40:43]
    v_mfma_f32_16x16x32_bf16 v[44:47], v[108:111], v[204:207], v[44:47]
    v_mfma_f32_16x16x32_bf16 v[48:51], v[112:115], v[204:207], v[48:51]
    s_waitcnt vmcnt(7)
    v_mfma_f32_16x16x32_bf16 v[64:67], v[112:115], v[208:211], v[64:67]
    buffer_load_dwordx4 v[204:207], v248, s[52:55], s91 offen sc1
    v_mfma_f32_16x16x32_bf16 v[60:63], v[108:111], v[208:211], v[60:63]
    v_mfma_f32_16x16x32_bf16 v[56:59], v[104:107], v[208:211], v[56:59]
    v_mfma_f32_16x16x32_bf16 v[52:55], v[100:103], v[208:211], v[52:55]
    s_waitcnt vmcnt(7)
    v_mfma_f32_16x16x32_bf16 v[4:7], v[116:119], v[212:215], v[4:7]
    buffer_load_dwordx4 v[208:211], v251, s[52:55], s89 offen sc1
    v_mfma_f32_16x16x32_bf16 v[8:11], v[120:123], v[212:215], v[8:11]
    v_mfma_f32_16x16x32_bf16 v[12:15], v[124:127], v[212:215], v[12:15]
    v_mfma_f32_16x16x32_bf16 v[16:19], v[128:131], v[212:215], v[16:19]
    s_waitcnt vmcnt(7)
    v_mfma_f32_16x16x32_bf16 v[32:35], v[128:131], v[216:219], v[32:35]
    buffer_load_dwordx4 v[212:215], v251, s[52:55], s90 offen sc1
    v_mfma_f32_16x16x32_bf16 v[28:31], v[124:127], v[216:219], v[28:31]
    v_mfma_f32_16x16x32_bf16 v[24:27], v[120:123], v[216:219], v[24:27]
    v_mfma_f32_16x16x32_bf16 v[20:23], v[116:119], v[216:219], v[20:23]
    s_waitcnt vmcnt(7)
    v_mfma_f32_16x16x32_bf16 v[36:39], v[116:119], v[220:223], v[36:39]
    buffer_load_dwordx4 v[216:219], v251, s[52:55], s84 offen sc1
    v_mfma_f32_16x16x32_bf16 v[40:43], v[120:123], v[220:223], v[40:43]
    v_mfma_f32_16x16x32_bf16 v[44:47], v[124:127], v[220:223], v[44:47]
    v_mfma_f32_16x16x32_bf16 v[48:51], v[128:131], v[220:223], v[48:51]
    s_waitcnt vmcnt(7)
    v_mfma_f32_16x16x32_bf16 v[64:67], v[128:131], v[224:227], v[64:67]
    buffer_load_dwordx4 v[220:223], v251, s[52:55], s91 offen sc1
    v_mfma_f32_16x16x32_bf16 v[60:63], v[124:127], v[224:227], v[60:63]
    v_mfma_f32_16x16x32_bf16 v[56:59], v[120:123], v[224:227], v[56:59]
    v_mfma_f32_16x16x32_bf16 v[52:55], v[116:119], v[224:227], v[52:55]
    s_waitcnt vmcnt(7) lgkmcnt(0)
    v_mfma_f32_16x16x32_bf16 v[20:23], v[132:135], v[228:231], v[20:23]
    buffer_load_dwordx4 v[224:227], v252, s[52:55], s89 offen sc1
    v_mfma_f32_16x16x32_bf16 v[24:27], v[136:139], v[228:231], v[24:27]
    v_xor_b32 v237, 2048, v249
    v_mfma_f32_16x16x32_bf16 v[28:31], v[140:143], v[228:231], v[28:31]
    v_xor_b32 v238, 4096, v249
    v_mfma_f32_16x16x32_bf16 v[32:35], v[144:147], v[228:231], v[32:35]
    v_xor_b32 v239, 6144, v249
    s_waitcnt vmcnt(7)
    v_mfma_f32_16x16x32_bf16 v[32:35], v[160:163], v[196:199], v[32:35]
    buffer_load_dwordx4 v[228:231], v252, s[52:55], s90 offen sc1
    v_mfma_f32_16x16x32_bf16 v[28:31], v[156:159], v[196:199], v[28:31]
    v_xor_b32_e64 v241, 32, v250
    v_mfma_f32_16x16x32_bf16 v[24:27], v[152:155], v[196:199], v[24:27]
    v_xor_b32_e64 v242, 64, v250
    v_mfma_f32_16x16x32_bf16 v[20:23], v[148:151], v[196:199], v[20:23]
    v_xor_b32_e64 v243, 32, v242
    s_waitcnt vmcnt(7)
    v_mfma_f32_16x16x32_bf16 v[20:23], v[180:183], v[200:203], v[20:23]
    buffer_load_dwordx4 v[196:199], v252, s[52:55], s84 offen sc1
    v_mfma_f32_16x16x32_bf16 v[24:27], v[184:187], v[200:203], v[24:27]
    v_mfma_f32_16x16x32_bf16 v[28:31], v[188:191], v[200:203], v[28:31]
    v_mfma_f32_16x16x32_bf16 v[32:35], v[192:195], v[200:203], v[32:35]
    s_waitcnt vmcnt(7)
    v_mfma_f32_16x16x32_bf16 v[32:35], v[176:179], v[204:207], v[32:35]
    buffer_load_dwordx4 v[200:203], v252, s[52:55], s91 offen sc1
    v_mfma_f32_16x16x32_bf16 v[28:31], v[172:175], v[204:207], v[28:31]
    v_mfma_f32_16x16x32_bf16 v[24:27], v[168:171], v[204:207], v[24:27]
    v_mfma_f32_16x16x32_bf16 v[20:23], v[164:167], v[204:207], v[20:23]
    s_waitcnt vmcnt(7)
    v_mfma_f32_16x16x32_bf16 v[36:39], v[132:135], v[208:211], v[36:39]
    buffer_load_dwordx4 v[204:207], v1, s[52:55], s89 offen sc1
    v_mfma_f32_16x16x32_bf16 v[40:43], v[136:139], v[208:211], v[40:43]
    v_mfma_f32_16x16x32_bf16 v[44:47], v[140:143], v[208:211], v[44:47]
    ds_write_b128 v249, v[32:35] offset:9216
    v_mfma_f32_16x16x32_bf16 v[48:51], v[144:147], v[208:211], v[48:51]
    s_waitcnt vmcnt(7)
    v_mfma_f32_16x16x32_bf16 v[48:51], v[160:163], v[212:215], v[48:51]
    buffer_load_dwordx4 v[208:211], v1, s[52:55], s90 offen sc1
    v_mfma_f32_16x16x32_bf16 v[44:47], v[156:159], v[212:215], v[44:47]
    ds_write_b128 v249, v[28:31] offset:8192
    v_mfma_f32_16x16x32_bf16 v[40:43], v[152:155], v[212:215], v[40:43]
    ds_write_b128 v249, v[24:27] offset:1024
    v_mfma_f32_16x16x32_bf16 v[36:39], v[148:151], v[212:215], v[36:39]
    s_waitcnt vmcnt(7)
    v_mfma_f32_16x16x32_bf16 v[36:39], v[180:183], v[216:219], v[36:39]
    buffer_load_dwordx4 v[212:215], v1, s[52:55], s84 offen sc1
    v_mfma_f32_16x16x32_bf16 v[40:43], v[184:187], v[216:219], v[40:43]
    v_mfma_f32_16x16x32_bf16 v[44:47], v[188:191], v[216:219], v[44:47]
    ds_write_b128 v249, v[20:23] offset:0
    v_mfma_f32_16x16x32_bf16 v[48:51], v[192:195], v[216:219], v[48:51]
    s_waitcnt vmcnt(7)
    v_mfma_f32_16x16x32_bf16 v[48:51], v[176:179], v[220:223], v[48:51]
    buffer_load_dwordx4 v[216:219], v1, s[52:55], s91 offen sc1
    v_mfma_f32_16x16x32_bf16 v[44:47], v[172:175], v[220:223], v[44:47]
    v_mfma_f32_16x16x32_bf16 v[40:43], v[168:171], v[220:223], v[40:43]
    v_mfma_f32_16x16x32_bf16 v[36:39], v[164:167], v[220:223], v[36:39]
    s_waitcnt vmcnt(7)
    v_mfma_f32_16x16x32_bf16 v[52:55], v[132:135], v[224:227], v[52:55]
    v_mfma_f32_16x16x32_bf16 v[56:59], v[136:139], v[224:227], v[56:59]
    v_mfma_f32_16x16x32_bf16 v[60:63], v[140:143], v[224:227], v[60:63]
    ds_write_b128 v249, v[48:51] offset:25600
    v_mfma_f32_16x16x32_bf16 v[64:67], v[144:147], v[224:227], v[64:67]
    s_waitcnt vmcnt(6)
    v_mfma_f32_16x16x32_bf16 v[64:67], v[160:163], v[228:231], v[64:67]
    v_mfma_f32_16x16x32_bf16 v[60:63], v[156:159], v[228:231], v[60:63]
    ds_write_b128 v249, v[44:47] offset:24576
    v_mfma_f32_16x16x32_bf16 v[56:59], v[152:155], v[228:231], v[56:59]
    ds_write_b128 v249, v[40:43] offset:17408
    v_mfma_f32_16x16x32_bf16 v[52:55], v[148:151], v[228:231], v[52:55]
    s_waitcnt vmcnt(5)
    v_mfma_f32_16x16x32_bf16 v[52:55], v[180:183], v[196:199], v[52:55]
    v_mfma_f32_16x16x32_bf16 v[56:59], v[184:187], v[196:199], v[56:59]
    v_mfma_f32_16x16x32_bf16 v[60:63], v[188:191], v[196:199], v[60:63]
    ds_write_b128 v249, v[36:39] offset:16384
    v_mfma_f32_16x16x32_bf16 v[64:67], v[192:195], v[196:199], v[64:67]
    s_waitcnt vmcnt(4)
    v_mfma_f32_16x16x32_bf16 v[64:67], v[176:179], v[200:203], v[64:67]
    v_mfma_f32_16x16x32_bf16 v[60:63], v[172:175], v[200:203], v[60:63]
    v_mfma_f32_16x16x32_bf16 v[56:59], v[168:171], v[200:203], v[56:59]
    v_mfma_f32_16x16x32_bf16 v[52:55], v[164:167], v[200:203], v[52:55]
    s_waitcnt vmcnt(3)
    v_mfma_f32_16x16x32_bf16 v[4:7], v[132:135], v[204:207], v[4:7]
    v_mfma_f32_16x16x32_bf16 v[8:11], v[136:139], v[204:207], v[8:11]
    s_nop 1
    ds_write_b128 v249, v[64:67] offset:41984
    v_mfma_f32_16x16x32_bf16 v[12:15], v[140:143], v[204:207], v[12:15]
    ds_write_b128 v249, v[60:63] offset:40960
    v_mfma_f32_16x16x32_bf16 v[16:19], v[144:147], v[204:207], v[16:19]
    s_waitcnt vmcnt(2)
    v_mfma_f32_16x16x32_bf16 v[16:19], v[160:163], v[208:211], v[16:19]
    v_mfma_f32_16x16x32_bf16 v[12:15], v[156:159], v[208:211], v[12:15]
    ds_write_b128 v249, v[56:59] offset:33792
    v_mfma_f32_16x16x32_bf16 v[8:11], v[152:155], v[208:211], v[8:11]
    ds_write_b128 v249, v[52:55] offset:32768
    v_mfma_f32_16x16x32_bf16 v[4:7], v[148:151], v[208:211], v[4:7]
    s_waitcnt lgkmcnt(0)
    s_barrier
    ds_read_b128 v[96:99], v237 offset:9216
    ds_read_b128 v[112:115], v238 offset:25600
    ds_read_b128 v[128:131], v239 offset:41984
    ds_read_b128 v[92:95], v237 offset:8192
    s_waitcnt vmcnt(1)
    v_mfma_f32_16x16x32_bf16 v[4:7], v[180:183], v[212:215], v[4:7]
    v_mfma_f32_16x16x32_bf16 v[8:11], v[184:187], v[212:215], v[8:11]
    ds_read_b128 v[108:111], v238 offset:24576
    ds_read_b128 v[124:127], v239 offset:40960
    v_mfma_f32_16x16x32_bf16 v[12:15], v[188:191], v[212:215], v[12:15]
    ds_read_b128 v[88:91], v237 offset:1024
    v_mfma_f32_16x16x32_bf16 v[16:19], v[192:195], v[212:215], v[16:19]
    ds_read_b128 v[104:107], v238 offset:17408
    s_waitcnt vmcnt(0)
    v_mfma_f32_16x16x32_bf16 v[16:19], v[176:179], v[216:219], v[16:19]
    v_mfma_f32_16x16x32_bf16 v[12:15], v[172:175], v[216:219], v[12:15]
    ds_read_b128 v[120:123], v239 offset:33792
    ds_read_b128 v[84:87], v237 offset:0
    v_mfma_f32_16x16x32_bf16 v[8:11], v[168:171], v[216:219], v[8:11]
    ds_read_b128 v[100:103], v238 offset:16384
    v_mfma_f32_16x16x32_bf16 v[4:7], v[164:167], v[216:219], v[4:7]
    ds_read_b128 v[116:119], v239 offset:32768
    s_waitcnt lgkmcnt(9)
    v_pk_add_f32 v[96:97], v[96:97], v[112:113]
    v_pk_add_f32 v[98:99], v[98:99], v[114:115]
    v_pk_add_f32 v[16:17], v[16:17], v[128:129]
    v_pk_add_f32 v[18:19], v[18:19], v[130:131]
    v_pk_add_f32 v[16:17], v[16:17], v[96:97]
    v_pk_add_f32 v[18:19], v[18:19], v[98:99]
    v_cvt_pk_bf16_f32 v74, v16, v17
    v_cvt_pk_bf16_f32 v75, v18, v19
    ds_write_b64 v243, v[74:75] offset:49152
    s_waitcnt lgkmcnt(7)
    v_pk_add_f32 v[92:93], v[92:93], v[108:109]
    v_pk_add_f32 v[94:95], v[94:95], v[110:111]
    v_pk_add_f32 v[12:13], v[12:13], v[124:125]
    v_pk_add_f32 v[14:15], v[14:15], v[126:127]
    v_pk_add_f32 v[12:13], v[12:13], v[92:93]
    v_pk_add_f32 v[14:15], v[14:15], v[94:95]
    v_cvt_pk_bf16_f32 v72, v12, v13
    v_cvt_pk_bf16_f32 v73, v14, v15
    ds_write_b64 v242, v[72:73] offset:49152
    s_waitcnt lgkmcnt(5)
    v_pk_add_f32 v[88:89], v[88:89], v[104:105]
    v_pk_add_f32 v[90:91], v[90:91], v[106:107]
    v_pk_add_f32 v[8:9], v[8:9], v[120:121]
    v_pk_add_f32 v[10:11], v[10:11], v[122:123]
    v_pk_add_f32 v[8:9], v[8:9], v[88:89]
    v_pk_add_f32 v[10:11], v[10:11], v[90:91]
    v_cvt_pk_bf16_f32 v70, v8, v9
    v_cvt_pk_bf16_f32 v71, v10, v11
    ds_write_b64 v241, v[70:71] offset:49152
    s_waitcnt lgkmcnt(3)
    v_pk_add_f32 v[84:85], v[84:85], v[100:101]
    v_pk_add_f32 v[86:87], v[86:87], v[102:103]
    v_pk_add_f32 v[4:5], v[4:5], v[116:117]
    v_pk_add_f32 v[6:7], v[6:7], v[118:119]
    v_pk_add_f32 v[4:5], v[4:5], v[84:85]
    v_pk_add_f32 v[6:7], v[6:7], v[86:87]
    v_cvt_pk_bf16_f32 v68, v4, v5
    v_cvt_pk_bf16_f32 v69, v6, v7
    ds_write_b64 v250, v[68:69] offset:49152
    ds_read_b128 v[76:79], v246 offset:49152
    ds_read_b128 v[80:83], v246 offset:50176
    s_movk_i32 s82, 0x2000
    s_waitcnt lgkmcnt(1)
    buffer_store_dwordx4 v[76:79], v2, s[56:59], 0 offen
    s_waitcnt lgkmcnt(0)
    buffer_store_dwordx4 v[80:83], v2, s[56:59], s82 offen
L_anchor_la:
    s_endpgm
L_gat_wait_a:
    s_mov_b32 s81, 200000
L_gat_lp_a:
    s_mov_b32 exec_hi, 0
    buffer_load_dwordx4 v[52:55], v59, s[72:75], 0 offen sc1
    s_mov_b32 exec_hi, -1
    s_movk_i32 s82, 0
    buffer_load_dwordx4 v[36:39], v58, s[72:75], s82 offen sc1
    s_movk_i32 s82, 4096
    buffer_load_dwordx4 v[40:43], v58, s[72:75], s82 offen sc1
    s_waitcnt vmcnt(0)
    s_sub_u32 s81, s81, 1
    s_cbranch_scc1 L_gat_ok_a
    v_xor_b32 v62, s60, v55
    v_xor_b32 v39, s60, v39
    v_xor_b32 v43, s60, v43
    v_or3_b32 v62, v62, v39, v43
    v_cmp_ne_u32 vcc, 0, v62
    s_nop 0
    s_cmp_lg_u64 vcc, 0
    s_cbranch_scc1 L_gat_lp_a
    s_branch L_gat_ok_a
L_tag_wait_a:
    s_mov_b32 s80, 200000
    s_mov_b64 exec, 1
L_tag_lp_a:
    buffer_load_dword v248, off, s[68:71], 0 sc1
    s_waitcnt vmcnt(0)
    v_readfirstlane_b32 s60, v248
    s_sub_u32 s80, s80, 1
    s_cbranch_scc1 L_tag_out_a
    s_cmp_eq_u32 s60, 0
    s_cbranch_scc1 L_tag_lp_a
L_tag_out_a:
    s_mov_b64 exec, -1
    s_branch L_tag_ok_a
    .p2align 3
    .fill 722, 4, 0xbf810000
L_C:
    s_lshr_b32 s84, s31, 1
    s_and_b32 s85, s31, 1
    s_lshl2_add_u32 s46, s27, s31
    s_xor_b32 s49, s46, 0
    s_and_b32 s80, s26, 7
    s_lshl4_add_u32 s80, s49, s80
    s_lshl_b32 s80, s80, 9
    s_add_u32 s80, s80, 11337728
    s_add_u32 s44, s24, s80
    s_addc_u32 s45, s25, 0
    s_lshl_b32 s47, s85, 1
    s_add_u32 s48, s47, s84
    s_cmp_eq_u32 s28, 0
    s_cbranch_scc0 L_nopre
    s_load_dword s65, s[44:45], 0 glc
    s_load_dword s65, s[44:45], 128 glc
    s_mov_b32 s47, s31
    s_mov_b32 s48, s31
    s_mov_b32 s84, 0
L_nopre:
    s_mov_b32 s86, 0xffff0000
    s_mov_b32 s88, 0x358637bd
    s_mov_b32 s90, 0x3fb8aa3b
    s_mov_b32 s89, 0x358637bd
    s_mov_b32 s91, 0x3fb8aa3b
    v_lshrrev_b32 v241, 4, v0
    v_lshlrev_b32 v252, 4, v241
    v_bfe_u32 v242, v0, 1, 3
    v_xor_b32 v242, v242, v241
    s_lshl_b32 s80, s84, 13
    v_lshl_add_u32 v242, v242, 4, s80
    v_and_b32 v243, 15, v0
    v_lshl_add_u32 v244, v243, 7, v242
    v_xor_b32 v245, 64, v244
    v_lshrrev_b32 v242, 5, v0
    v_mul_u32_u24 v242, 6144, v242
    v_bfe_u32 v243, v0, 4, 1
    v_lshl_add_u32 v242, v243, 10, v242
    v_bfe_u32 v243, v0, 2, 2
    v_lshl_add_u32 v242, v243, 7, v242
    v_bfe_u32 v243, v0, 3, 2
    v_xor_b32 v243, s47, v243
    v_lshl_add_u32 v242, v243, 5, v242
    v_and_b32 v243, 3, v0
    v_lshl_add_u32 v242, v243, 3, v242
    v_add_u32 v246, 65536, v242
    v_xor_b32 v247, 32, v246
    v_add_u32 v248, 49152, v246
    v_add_u32 v249, 49152, v247
    s_and_b32 s80, s26, 1
    s_lshl1_add_u32 s48, s80, s85
    s_xor_b32 s80, s48, s47
    s_lshl_b32 s80, s80, 5
    v_xor_b32 v232, s80, v246
    s_lshl_b32 s80, s48, 6
    s_add_u32 s80, s80, 149504
    v_and_b32 v243, 15, v0
    v_lshl_add_u32 v243, v243, 2, s80
    v_lshl_add_u32 v233, v241, 8, v243
    v_mov_b32 v236, 0x3f803f80
    v_mov_b32 v237, 0x3f803f80
    v_mov_b32 v238, 0x3f803f80
    v_mov_b32 v239, 0x3f803f80
    v_mov_b32 v2, 1
    v_mov_b32 v251, 151552
    s_lshl_b32 s80, s31, 2
    v_add_u32 v1, s80, v251
    v_lshl_add_u32 v242, v0, 2, v251
    v_mov_b32 v243, 0
    ds_write_b32 v242, v243
    s_mov_b32 s34, 11894784
    s_mov_b32 s35, 0x20000
    s_mov_b64 s[32:33], s[24:25]
    s_lshl1_add_u32 s80, s26, s84
    s_mul_i32 s92, s80, 327680
    s_lshr_b32 s81, s27, 1
    s_lshl_b32 s80, s80, 5
    s_add_u32 s80, s80, s81
    s_lshl_b32 s80, s80, 9
    s_and_b32 s81, s27, 1
    s_lshl1_add_u32 s81, s81, s85
    s_lshr_b32 s93, s81, 2
    s_lshl_b32 s93, s93, 5
    s_and_b32 s43, s81, 3
    s_add_u32 s93, s93, s43
    s_lshl_b32 s93, s93, 2
    s_add_u32 s93, s93, s80
    s_add_u32 s93, s93, 10813440
    s_lshl3_add_u32 s80, s2, s3
    s_cmp_eq_u32 s80, 8
    s_cbranch_scc0 L_notag
    s_mov_b32 s80, 10813440
    s_load_dword s64, s[24:25], s80 glc
    s_mov_b32 s40, s22
    s_mov_b32 s41, s23
    s_mov_b32 s42, 256
    s_mov_b32 s43, 0x20000
    s_waitcnt lgkmcnt(0)
    s_mul_i32 s64, s64, 0x9e3779b1
    s_add_u32 s64, s64, 0x7f4a7c15
    s_or_b32 s64, s64, 1
    v_mov_b32 v241, s64
    s_mov_b64 exec, 1
    buffer_store_dword v241, off, s[40:43], 0 sc1
    s_mov_b64 exec, -1
    s_waitcnt vmcnt(1)
    s_branch L_tagged
L_notag:
    s_waitcnt vmcnt(0)
L_tagged:
    v_lshlrev_b32 v156, 16, v144
    v_and_b32 v157, s86, v144
    v_add_f32 v152, v156, v157
    v_mul_f32 v153, v156, v156
    v_mul_f32 v154, v157, v157
    v_lshlrev_b32 v156, 16, v145
    v_and_b32 v157, s86, v145
    v_add_f32 v152, v152, v156
    v_fmac_f32 v153, v156, v156
    v_add_f32 v152, v152, v157
    v_fmac_f32 v154, v157, v157
    v_lshlrev_b32 v156, 16, v146
    v_and_b32 v157, s86, v146
    v_add_f32 v152, v152, v156
    v_fmac_f32 v153, v156, v156
    v_add_f32 v152, v152, v157
    v_fmac_f32 v154, v157, v157
    v_lshlrev_b32 v156, 16, v147
    v_and_b32 v157, s86, v147
    v_add_f32 v152, v152, v156
    v_fmac_f32 v153, v156, v156
    v_add_f32 v152, v152, v157
    v_fmac_f32 v154, v157, v157
    v_lshlrev_b32 v156, 16, v148
    v_and_b32 v157, s86, v148
    v_add_f32 v152, v152, v156
    v_fmac_f32 v153, v156, v156
    v_add_f32 v152, v152, v157
    v_fmac_f32 v154, v157, v157
    v_lshlrev_b32 v156, 16, v149
    v_and_b32 v157, s86, v149
    v_add_f32 v152, v152, v156
    v_fmac_f32 v153, v156, v156
    v_add_f32 v152, v152, v157
    v_fmac_f32 v154, v157, v157
    v_lshlrev_b32 v156, 16, v150
    v_and_b32 v157, s86, v150
    v_add_f32 v152, v152, v156
    v_fmac_f32 v153, v156, v156
    v_add_f32 v152, v152, v157
    v_fmac_f32 v154, v157, v157
    v_lshlrev_b32 v156, 16, v151
    v_and_b32 v157, s86, v151
    v_add_f32 v152, v152, v156
    v_fmac_f32 v153, v156, v156
    v_add_f32 v152, v152, v157
    v_fmac_f32 v154, v157, v157
    v_add_f32 v153, v153, v154
    v_add_f32_dpp v152, v152, v152 row_ror:8 row_mask:0xf bank_mask:0xf
    s_nop 0
    v_add_f32_dpp v153, v153, v153 row_ror:8 row_mask:0xf bank_mask:0xf
    v_add_f32_dpp v152, v152, v152 row_ror:4 row_mask:0xf bank_mask:0xf
    s_nop 0
    v_add_f32_dpp v153, v153, v153 row_ror:4 row_mask:0xf bank_mask:0xf
    v_add_f32_dpp v152, v152, v152 row_ror:2 row_mask:0xf bank_mask:0xf
    s_nop 0
    v_add_f32_dpp v153, v153, v153 row_ror:2 row_mask:0xf bank_mask:0xf
    v_add_f32_dpp v152, v152, v152 row_ror:1 row_mask:0xf bank_mask:0xf
    s_nop 0
    v_add_f32_dpp v153, v153, v153 row_ror:1 row_mask:0xf bank_mask:0xf
    v_mov_b32 v154, v152
    v_mov_b32 v155, v153
    s_nop 0
    v_permlane16_swap_b32 v152, v154
    v_permlane16_swap_b32 v153, v155
    v_add_f32 v152, v152, v154
    v_add_f32 v153, v153, v155
    v_mul_f32 v152, 0xbb000000, v152
    v_mul_f32 v153, 0x3b000000, v153
    v_fma_f32 v153, -v152, v152, v153
    v_max_f32 v153, 0, v153
    v_cvt_pk_bf16_f32 v156, v152, v153
    v_and_b32 v153, s86, v156
    v_add_f32 v153, 0x3727c5ac, v153
    v_cvt_pk_bf16_f32 v153, v153, v153
    v_and_b32 v153, s86, v153
    v_sqrt_f32 v153, v153
    v_lshlrev_b32 v156, 16, v156
    v_cvt_pk_bf16_f32 v153, v153, v153
    v_and_b32 v153, s86, v153
    v_rcp_f32 v152, v153
    s_lshl_b32 s80, s31, 3
    s_add_u32 s80, s80, 150528
    v_lshrrev_b32 v157, 3, v0
    v_add_u32 v157, s80, v157
    v_mul_f32 v153, v152, v156
    s_mov_b32 exec_lo, 1
    s_mov_b32 exec_hi, 1
    ds_write2_b32 v157, v152, v153 offset0:0 offset1:64
    s_mov_b64 exec, -1
    s_cmp_eq_u32 s28, 0
    s_cbranch_scc1 L_attn
    s_add_u32 s80, s83, s85
    s_mul_i32 s81, s80, 5120
    s_add_u32 s92, s92, s81
    s_lshl_b32 s80, s85, 6
    s_add_u32 s80, s80, 152576
    v_lshrrev_b32 v240, 1, v252
    v_add_u32 v240, s80, v240
    s_waitcnt lgkmcnt(0)
    s_barrier
    ds_read_b128 v[100:103], v244 offset:0
    ds_read_b64_tr_b16 v[116:117], v246 offset:0
    ds_read_b64_tr_b16 v[118:119], v246 offset:512
    ds_read_b128 v[104:107], v244 offset:2048
    ds_read_b128 v[108:111], v244 offset:4096
    ds_read_b128 v[112:115], v244 offset:6144
    ds_read_b64_tr_b16 v[120:121], v247 offset:0
    ds_read_b64_tr_b16 v[122:123], v247 offset:512
    ds_read_b64_tr_b16 v[124:125], v246 offset:2048
    ds_read_b64_tr_b16 v[126:127], v246 offset:2560
    ds_read_b64_tr_b16 v[128:129], v247 offset:2048
    ds_read_b64_tr_b16 v[130:131], v247 offset:2560
    ds_read_b64_tr_b16 v[132:133], v246 offset:4096
    ds_read_b64_tr_b16 v[134:135], v246 offset:4608
    ds_read_b64_tr_b16 v[136:137], v247 offset:4096
    ds_read_b64_tr_b16 v[138:139], v247 offset:4608
    s_waitcnt lgkmcnt(0)
    s_nop 0
    v_mfma_f32_16x16x32_bf16 v[4:7], v[116:119], v[100:103], 0
    ds_read_b64_tr_b16 v[188:189], v232 offset:0
    v_mfma_f32_16x16x32_bf16 v[8:11], v[116:119], v[104:107], 0
    ds_read_b64_tr_b16 v[190:191], v232 offset:512
    v_mfma_f32_16x16x32_bf16 v[12:15], v[116:119], v[108:111], 0
    ds_read_b64_tr_b16 v[192:193], v232 offset:2048
    v_mfma_f32_16x16x32_bf16 v[16:19], v[116:119], v[112:115], 0
    ds_read_b64_tr_b16 v[194:195], v232 offset:2560
    v_mfma_f32_16x16x32_bf16 v[32:35], v[120:123], v[112:115], 0
    ds_read_b64_tr_b16 v[196:197], v232 offset:4096
    v_mfma_f32_16x16x32_bf16 v[28:31], v[120:123], v[108:111], 0
    ds_read_b64_tr_b16 v[198:199], v232 offset:4608
    v_mfma_f32_16x16x32_bf16 v[24:27], v[120:123], v[104:107], 0
    ds_read_b64_tr_b16 v[200:201], v232 offset:12288
    v_mfma_f32_16x16x32_bf16 v[20:23], v[120:123], v[100:103], 0
    ds_read_b64_tr_b16 v[202:203], v232 offset:12800
    v_mfma_f32_16x16x32_bf16 v[36:39], v[124:127], v[100:103], 0
    ds_read_b64_tr_b16 v[204:205], v232 offset:14336
    v_mfma_f32_16x16x32_bf16 v[40:43], v[124:127], v[104:107], 0
    ds_read_b64_tr_b16 v[206:207], v232 offset:14848
    v_mfma_f32_16x16x32_bf16 v[44:47], v[124:127], v[108:111], 0
    ds_read_b64_tr_b16 v[208:209], v232 offset:16384
    v_mfma_f32_16x16x32_bf16 v[48:51], v[124:127], v[112:115], 0
    ds_read_b64_tr_b16 v[210:211], v232 offset:16896
    v_mfma_f32_16x16x32_bf16 v[64:67], v[128:131], v[112:115], 0
    v_mfma_f32_16x16x32_bf16 v[60:63], v[128:131], v[108:111], 0
    v_mfma_f32_16x16x32_bf16 v[56:59], v[128:131], v[104:107], 0
    v_mfma_f32_16x16x32_bf16 v[52:55], v[128:131], v[100:103], 0
    v_mfma_f32_16x16x32_bf16 v[68:71], v[132:135], v[100:103], 0
    ds_read_b128 v[140:143], v245 offset:0
    ds_read_b64_tr_b16 v[156:157], v246 offset:12288
    v_mfma_f32_16x16x32_bf16 v[72:75], v[132:135], v[104:107], 0
    ds_read_b64_tr_b16 v[158:159], v246 offset:12800
    ds_read_b128 v[144:147], v245 offset:2048
    v_mfma_f32_16x16x32_bf16 v[76:79], v[132:135], v[108:111], 0
    ds_read_b128 v[148:151], v245 offset:4096
    ds_read_b128 v[152:155], v245 offset:6144
    v_mfma_f32_16x16x32_bf16 v[80:83], v[132:135], v[112:115], 0
    ds_read_b64_tr_b16 v[160:161], v247 offset:12288
    ds_read_b64_tr_b16 v[162:163], v247 offset:12800
    v_mfma_f32_16x16x32_bf16 v[96:99], v[136:139], v[112:115], 0
    ds_read_b64_tr_b16 v[164:165], v246 offset:14336
    ds_read_b64_tr_b16 v[166:167], v246 offset:14848
    v_mfma_f32_16x16x32_bf16 v[92:95], v[136:139], v[108:111], 0
    ds_read_b64_tr_b16 v[168:169], v247 offset:14336
    ds_read_b64_tr_b16 v[170:171], v247 offset:14848
    v_mfma_f32_16x16x32_bf16 v[88:91], v[136:139], v[104:107], 0
    ds_read_b64_tr_b16 v[172:173], v246 offset:16384
    ds_read_b64_tr_b16 v[174:175], v246 offset:16896
    v_mfma_f32_16x16x32_bf16 v[84:87], v[136:139], v[100:103], 0
    ds_read_b64_tr_b16 v[176:177], v247 offset:16384
    ds_read_b64_tr_b16 v[178:179], v247 offset:16896
    s_waitcnt lgkmcnt(0)
    s_barrier
    v_mfma_f32_16x16x32_bf16 v[4:7], v[156:159], v[140:143], v[4:7]
    v_mfma_f32_16x16x32_bf16 v[212:215], v[236:239], v[188:191], 0
    v_mfma_f32_16x16x32_bf16 v[8:11], v[156:159], v[144:147], v[8:11]
    v_mfma_f32_16x16x32_bf16 v[216:219], v[236:239], v[192:195], 0
    v_mfma_f32_16x16x32_bf16 v[12:15], v[156:159], v[148:151], v[12:15]
    v_mfma_f32_16x16x32_bf16 v[220:223], v[236:239], v[196:199], 0
    v_mfma_f32_16x16x32_bf16 v[16:19], v[156:159], v[152:155], v[16:19]
    v_mfma_f32_16x16x32_bf16 v[212:215], v[236:239], v[200:203], v[212:215]
    v_mfma_f32_16x16x32_bf16 v[32:35], v[160:163], v[152:155], v[32:35]
    v_mfma_f32_16x16x32_bf16 v[216:219], v[236:239], v[204:207], v[216:219]
    v_mfma_f32_16x16x32_bf16 v[28:31], v[160:163], v[148:151], v[28:31]
    v_mfma_f32_16x16x32_bf16 v[220:223], v[236:239], v[208:211], v[220:223]
    v_mfma_f32_16x16x32_bf16 v[24:27], v[160:163], v[144:147], v[24:27]
    v_mfma_f32_16x16x32_bf16 v[20:23], v[160:163], v[140:143], v[20:23]
    v_mfma_f32_16x16x32_bf16 v[36:39], v[164:167], v[140:143], v[36:39]
    v_mfma_f32_16x16x32_bf16 v[40:43], v[164:167], v[144:147], v[40:43]
    v_mfma_f32_16x16x32_bf16 v[44:47], v[164:167], v[148:151], v[44:47]
    v_mfma_f32_16x16x32_bf16 v[48:51], v[164:167], v[152:155], v[48:51]
    v_mfma_f32_16x16x32_bf16 v[64:67], v[168:171], v[152:155], v[64:67]
    v_mfma_f32_16x16x32_bf16 v[60:63], v[168:171], v[148:151], v[60:63]
    v_mfma_f32_16x16x32_bf16 v[56:59], v[168:171], v[144:147], v[56:59]
    s_mov_b32 exec_lo, 0xffff0000
    v_mov_b32 v212, v216
    s_mov_b32 exec_lo, 0
    v_mov_b32 v212, v220
    s_mov_b32 exec_lo, -1
    s_mov_b32 exec_hi, 0xffff
    ds_write_b32 v233, v212
    s_mov_b32 exec_hi, -1
    s_nop 0
    v_mfma_f32_16x16x32_bf16 v[52:55], v[168:171], v[140:143], v[52:55]
    v_mfma_f32_16x16x32_bf16 v[68:71], v[172:175], v[140:143], v[68:71]
    ds_read_b128 v[100:103], v244 offset:16384
    ds_read_b64_tr_b16 v[116:117], v246 offset:24576
    v_mfma_f32_16x16x32_bf16 v[72:75], v[172:175], v[144:147], v[72:75]
    ds_read_b64_tr_b16 v[118:119], v246 offset:25088
    ds_read_b128 v[104:107], v244 offset:18432
    v_mfma_f32_16x16x32_bf16 v[76:79], v[172:175], v[148:151], v[76:79]
    ds_read_b128 v[108:111], v244 offset:20480
    ds_read_b128 v[112:115], v244 offset:22528
    v_mfma_f32_16x16x32_bf16 v[80:83], v[172:175], v[152:155], v[80:83]
    ds_read_b64_tr_b16 v[120:121], v247 offset:24576
    ds_read_b64_tr_b16 v[122:123], v247 offset:25088
    v_mfma_f32_16x16x32_bf16 v[96:99], v[176:179], v[152:155], v[96:99]
    ds_read_b64_tr_b16 v[124:125], v246 offset:26624
    ds_read_b64_tr_b16 v[126:127], v246 offset:27136
    v_mfma_f32_16x16x32_bf16 v[92:95], v[176:179], v[148:151], v[92:95]
    ds_read_b64_tr_b16 v[128:129], v247 offset:26624
    ds_read_b64_tr_b16 v[130:131], v247 offset:27136
    v_mfma_f32_16x16x32_bf16 v[88:91], v[176:179], v[144:147], v[88:91]
    ds_read_b64_tr_b16 v[132:133], v246 offset:28672
    ds_read_b64_tr_b16 v[134:135], v246 offset:29184
    v_mfma_f32_16x16x32_bf16 v[84:87], v[176:179], v[140:143], v[84:87]
    ds_read_b64_tr_b16 v[136:137], v247 offset:28672
    ds_read_b64_tr_b16 v[138:139], v247 offset:29184
    s_waitcnt lgkmcnt(0)
    s_nop 0
    v_mfma_f32_16x16x32_bf16 v[4:7], v[116:119], v[100:103], v[4:7]
    v_mfma_f32_16x16x32_bf16 v[8:11], v[116:119], v[104:107], v[8:11]
    v_mfma_f32_16x16x32_bf16 v[12:15], v[116:119], v[108:111], v[12:15]
    v_mfma_f32_16x16x32_bf16 v[16:19], v[116:119], v[112:115], v[16:19]
    v_mfma_f32_16x16x32_bf16 v[32:35], v[120:123], v[112:115], v[32:35]
    v_mfma_f32_16x16x32_bf16 v[28:31], v[120:123], v[108:111], v[28:31]
    v_mfma_f32_16x16x32_bf16 v[24:27], v[120:123], v[104:107], v[24:27]
    v_mfma_f32_16x16x32_bf16 v[20:23], v[120:123], v[100:103], v[20:23]
    v_mfma_f32_16x16x32_bf16 v[36:39], v[124:127], v[100:103], v[36:39]
    v_mfma_f32_16x16x32_bf16 v[40:43], v[124:127], v[104:107], v[40:43]
    v_mfma_f32_16x16x32_bf16 v[44:47], v[124:127], v[108:111], v[44:47]
    v_mfma_f32_16x16x32_bf16 v[48:51], v[124:127], v[112:115], v[48:51]
    v_mfma_f32_16x16x32_bf16 v[64:67], v[128:131], v[112:115], v[64:67]
    v_mfma_f32_16x16x32_bf16 v[60:63], v[128:131], v[108:111], v[60:63]
    v_mfma_f32_16x16x32_bf16 v[56:59], v[128:131], v[104:107], v[56:59]
    v_mfma_f32_16x16x32_bf16 v[52:55], v[128:131], v[100:103], v[52:55]
    v_mfma_f32_16x16x32_bf16 v[68:71], v[132:135], v[100:103], v[68:71]
    ds_read_b128 v[140:143], v245 offset:16384
    ds_read_b64_tr_b16 v[156:157], v246 offset:36864
    v_mfma_f32_16x16x32_bf16 v[72:75], v[132:135], v[104:107], v[72:75]
    ds_read_b64_tr_b16 v[158:159], v246 offset:37376
    ds_read_b128 v[144:147], v245 offset:18432
    v_mfma_f32_16x16x32_bf16 v[76:79], v[132:135], v[108:111], v[76:79]
    ds_read_b128 v[148:151], v245 offset:20480
    ds_read_b128 v[152:155], v245 offset:22528
    v_mfma_f32_16x16x32_bf16 v[80:83], v[132:135], v[112:115], v[80:83]
    ds_read_b64_tr_b16 v[160:161], v247 offset:36864
    ds_read_b64_tr_b16 v[162:163], v247 offset:37376
    v_mfma_f32_16x16x32_bf16 v[96:99], v[136:139], v[112:115], v[96:99]
    ds_read_b64_tr_b16 v[164:165], v246 offset:38912
    ds_read_b64_tr_b16 v[166:167], v246 offset:39424
    v_mfma_f32_16x16x32_bf16 v[92:95], v[136:139], v[108:111], v[92:95]
    ds_read_b64_tr_b16 v[168:169], v247 offset:38912
    ds_read_b64_tr_b16 v[170:171], v247 offset:39424
    v_mfma_f32_16x16x32_bf16 v[88:91], v[136:139], v[104:107], v[88:91]
    ds_read_b64_tr_b16 v[172:173], v246 offset:40960
    ds_read_b64_tr_b16 v[174:175], v246 offset:41472
    v_mfma_f32_16x16x32_bf16 v[84:87], v[136:139], v[100:103], v[84:87]
    ds_read_b64_tr_b16 v[176:177], v247 offset:40960
    ds_read_b64_tr_b16 v[178:179], v247 offset:41472
    s_waitcnt lgkmcnt(0)
    s_barrier
    v_mfma_f32_16x16x32_bf16 v[4:7], v[156:159], v[140:143], v[4:7]
    v_mfma_f32_16x16x32_bf16 v[8:11], v[156:159], v[144:147], v[8:11]
    ds_read_b64 v[224:225], v240 offset:0
    v_mfma_f32_16x16x32_bf16 v[12:15], v[156:159], v[148:151], v[12:15]
    ds_read_b64 v[226:227], v240 offset:32
    v_mfma_f32_16x16x32_bf16 v[16:19], v[156:159], v[152:155], v[16:19]
    ds_read_b64 v[228:229], v240 offset:128
    v_mfma_f32_16x16x32_bf16 v[32:35], v[160:163], v[152:155], v[32:35]
    ds_read_b64 v[230:231], v240 offset:160
    v_mfma_f32_16x16x32_bf16 v[28:31], v[160:163], v[148:151], v[28:31]
    ds_read_b64 v[232:233], v240 offset:256
    v_mfma_f32_16x16x32_bf16 v[24:27], v[160:163], v[144:147], v[24:27]
    ds_read_b64 v[234:235], v240 offset:288
    v_mfma_f32_16x16x32_bf16 v[20:23], v[160:163], v[140:143], v[20:23]
    v_mfma_f32_16x16x32_bf16 v[36:39], v[164:167], v[140:143], v[36:39]
    v_mfma_f32_16x16x32_bf16 v[40:43], v[164:167], v[144:147], v[40:43]
    v_mfma_f32_16x16x32_bf16 v[44:47], v[164:167], v[148:151], v[44:47]
    v_mfma_f32_16x16x32_bf16 v[48:51], v[164:167], v[152:155], v[48:51]
    v_mfma_f32_16x16x32_bf16 v[64:67], v[168:171], v[152:155], v[64:67]
    v_mfma_f32_16x16x32_bf16 v[60:63], v[168:171], v[148:151], v[60:63]
    v_mfma_f32_16x16x32_bf16 v[56:59], v[168:171], v[144:147], v[56:59]
    v_mfma_f32_16x16x32_bf16 v[52:55], v[168:171], v[140:143], v[52:55]
    v_mfma_f32_16x16x32_bf16 v[68:71], v[172:175], v[140:143], v[68:71]
    ds_read_b128 v[100:103], v244 offset:32768
    ds_read_b64_tr_b16 v[116:117], v248 offset:0
    v_mfma_f32_16x16x32_bf16 v[72:75], v[172:175], v[144:147], v[72:75]
    ds_read_b64_tr_b16 v[118:119], v248 offset:512
    ds_read_b128 v[104:107], v244 offset:34816
    v_mfma_f32_16x16x32_bf16 v[76:79], v[172:175], v[148:151], v[76:79]
    ds_read_b128 v[108:111], v244 offset:36864
    ds_read_b128 v[112:115], v244 offset:38912
    v_mfma_f32_16x16x32_bf16 v[80:83], v[172:175], v[152:155], v[80:83]
    ds_read_b64_tr_b16 v[120:121], v249 offset:0
    ds_read_b64_tr_b16 v[122:123], v249 offset:512
    v_mfma_f32_16x16x32_bf16 v[96:99], v[176:179], v[152:155], v[96:99]
    ds_read_b64_tr_b16 v[124:125], v248 offset:2048
    ds_read_b64_tr_b16 v[126:127], v248 offset:2560
    v_mfma_f32_16x16x32_bf16 v[92:95], v[176:179], v[148:151], v[92:95]
    ds_read_b64_tr_b16 v[128:129], v249 offset:2048
    ds_read_b64_tr_b16 v[130:131], v249 offset:2560
    v_mfma_f32_16x16x32_bf16 v[88:91], v[176:179], v[144:147], v[88:91]
    ds_read_b64_tr_b16 v[132:133], v248 offset:4096
    ds_read_b64_tr_b16 v[134:135], v248 offset:4608
    v_mfma_f32_16x16x32_bf16 v[84:87], v[176:179], v[140:143], v[84:87]
    ds_read_b64_tr_b16 v[136:137], v249 offset:4096
    ds_read_b64_tr_b16 v[138:139], v249 offset:4608
    s_waitcnt lgkmcnt(0) vmcnt(0)
    s_nop 0
    v_mfma_f32_16x16x32_bf16 v[4:7], v[116:119], v[100:103], v[4:7]
    v_mfma_f32_16x16x32_bf16 v[8:11], v[116:119], v[104:107], v[8:11]
    v_lshlrev_b32 v212, 16, v224
    v_and_b32 v213, s86, v224
    v_mfma_f32_16x16x32_bf16 v[12:15], v[116:119], v[108:111], v[12:15]
    v_lshlrev_b32 v214, 16, v225
    v_and_b32 v215, s86, v225
    v_mfma_f32_16x16x32_bf16 v[16:19], v[116:119], v[112:115], v[16:19]
    v_lshlrev_b32 v216, 16, v226
    v_and_b32 v217, s86, v226
    v_mfma_f32_16x16x32_bf16 v[32:35], v[120:123], v[112:115], v[32:35]
    v_lshlrev_b32 v218, 16, v227
    v_and_b32 v219, s86, v227
    v_mfma_f32_16x16x32_bf16 v[28:31], v[120:123], v[108:111], v[28:31]
    v_lshlrev_b32 v220, 16, v228
    v_and_b32 v221, s86, v228
    v_mfma_f32_16x16x32_bf16 v[24:27], v[120:123], v[104:107], v[24:27]
    v_lshlrev_b32 v222, 16, v229
    v_and_b32 v223, s86, v229
    v_mfma_f32_16x16x32_bf16 v[20:23], v[120:123], v[100:103], v[20:23]
    v_mfma_f32_16x16x32_bf16 v[36:39], v[124:127], v[100:103], v[36:39]
    v_mfma_f32_16x16x32_bf16 v[40:43], v[124:127], v[104:107], v[40:43]
    v_mfma_f32_16x16x32_bf16 v[44:47], v[124:127], v[108:111], v[44:47]
    v_mfma_f32_16x16x32_bf16 v[48:51], v[124:127], v[112:115], v[48:51]
    v_mfma_f32_16x16x32_bf16 v[64:67], v[128:131], v[112:115], v[64:67]
    v_mfma_f32_16x16x32_bf16 v[60:63], v[128:131], v[108:111], v[60:63]
    v_mfma_f32_16x16x32_bf16 v[56:59], v[128:131], v[104:107], v[56:59]
    v_mfma_f32_16x16x32_bf16 v[52:55], v[128:131], v[100:103], v[52:55]
    v_mfma_f32_16x16x32_bf16 v[68:71], v[132:135], v[100:103], v[68:71]
    ds_read_b128 v[140:143], v245 offset:32768
    ds_read_b64_tr_b16 v[156:157], v248 offset:12288
    v_mfma_f32_16x16x32_bf16 v[72:75], v[132:135], v[104:107], v[72:75]
    ds_read_b64_tr_b16 v[158:159], v248 offset:12800
    ds_read_b128 v[144:147], v245 offset:34816
    v_mfma_f32_16x16x32_bf16 v[76:79], v[132:135], v[108:111], v[76:79]
    ds_read_b128 v[148:151], v245 offset:36864
    ds_read_b128 v[152:155], v245 offset:38912
    v_mfma_f32_16x16x32_bf16 v[80:83], v[132:135], v[112:115], v[80:83]
    ds_read_b64_tr_b16 v[160:161], v249 offset:12288
    ds_read_b64_tr_b16 v[162:163], v249 offset:12800
    v_mfma_f32_16x16x32_bf16 v[96:99], v[136:139], v[112:115], v[96:99]
    ds_read_b64_tr_b16 v[164:165], v248 offset:14336
    ds_read_b64_tr_b16 v[166:167], v248 offset:14848
    v_mfma_f32_16x16x32_bf16 v[92:95], v[136:139], v[108:111], v[92:95]
    ds_read_b64_tr_b16 v[168:169], v249 offset:14336
    ds_read_b64_tr_b16 v[170:171], v249 offset:14848
    v_mfma_f32_16x16x32_bf16 v[88:91], v[136:139], v[104:107], v[88:91]
    ds_read_b64_tr_b16 v[172:173], v248 offset:16384
    ds_read_b64_tr_b16 v[174:175], v248 offset:16896
    v_mfma_f32_16x16x32_bf16 v[84:87], v[136:139], v[100:103], v[84:87]
    ds_read_b64_tr_b16 v[176:177], v249 offset:16384
    ds_read_b64_tr_b16 v[178:179], v249 offset:16896
    s_waitcnt lgkmcnt(0)
    s_barrier
    v_mfma_f32_16x16x32_bf16 v[4:7], v[156:159], v[140:143], v[4:7]
    v_mfma_f32_16x16x32_bf16 v[8:11], v[156:159], v[144:147], v[8:11]
    v_lshlrev_b32 v224, 16, v230
    v_and_b32 v225, s86, v230
    v_mfma_f32_16x16x32_bf16 v[12:15], v[156:159], v[148:151], v[12:15]
    v_lshlrev_b32 v226, 16, v231
    v_and_b32 v227, s86, v231
    v_mfma_f32_16x16x32_bf16 v[16:19], v[156:159], v[152:155], v[16:19]
    v_lshlrev_b32 v228, 16, v232
    v_and_b32 v229, s86, v232
    v_mfma_f32_16x16x32_bf16 v[32:35], v[160:163], v[152:155], v[32:35]
    v_lshlrev_b32 v230, 16, v233
    v_and_b32 v231, s86, v233
    v_mfma_f32_16x16x32_bf16 v[28:31], v[160:163], v[148:151], v[28:31]
    v_lshlrev_b32 v232, 16, v234
    v_and_b32 v233, s86, v234
    v_mfma_f32_16x16x32_bf16 v[24:27], v[160:163], v[144:147], v[24:27]
    v_lshlrev_b32 v234, 16, v235
    v_and_b32 v235, s86, v235
    v_mfma_f32_16x16x32_bf16 v[20:23], v[160:163], v[140:143], v[20:23]
    v_mfma_f32_16x16x32_bf16 v[36:39], v[164:167], v[140:143], v[36:39]
    v_mfma_f32_16x16x32_bf16 v[40:43], v[164:167], v[144:147], v[40:43]
    v_mfma_f32_16x16x32_bf16 v[44:47], v[164:167], v[148:151], v[44:47]
    v_mfma_f32_16x16x32_bf16 v[48:51], v[164:167], v[152:155], v[48:51]
    v_mfma_f32_16x16x32_bf16 v[64:67], v[168:171], v[152:155], v[64:67]
    v_mfma_f32_16x16x32_bf16 v[60:63], v[168:171], v[148:151], v[60:63]
    v_mfma_f32_16x16x32_bf16 v[56:59], v[168:171], v[144:147], v[56:59]
    v_mfma_f32_16x16x32_bf16 v[52:55], v[168:171], v[140:143], v[52:55]
    v_mfma_f32_16x16x32_bf16 v[68:71], v[172:175], v[140:143], v[68:71]
    ds_read_b128 v[100:103], v244 offset:0
    ds_read_b64_tr_b16 v[116:117], v246 offset:0
    v_mfma_f32_16x16x32_bf16 v[72:75], v[172:175], v[144:147], v[72:75]
    ds_read_b64_tr_b16 v[118:119], v246 offset:512
    ds_read_b128 v[104:107], v244 offset:2048
    v_mfma_f32_16x16x32_bf16 v[76:79], v[172:175], v[148:151], v[76:79]
    ds_read_b128 v[108:111], v244 offset:4096
    ds_read_b128 v[112:115], v244 offset:6144
    v_mfma_f32_16x16x32_bf16 v[80:83], v[172:175], v[152:155], v[80:83]
    ds_read_b64_tr_b16 v[120:121], v247 offset:0
    ds_read_b64_tr_b16 v[122:123], v247 offset:512
    v_mfma_f32_16x16x32_bf16 v[96:99], v[176:179], v[152:155], v[96:99]
    ds_read_b64_tr_b16 v[124:125], v246 offset:2048
    ds_read_b64_tr_b16 v[126:127], v246 offset:2560
    v_mfma_f32_16x16x32_bf16 v[92:95], v[176:179], v[148:151], v[92:95]
    ds_read_b64_tr_b16 v[128:129], v247 offset:2048
    ds_read_b64_tr_b16 v[130:131], v247 offset:2560
    v_mfma_f32_16x16x32_bf16 v[88:91], v[176:179], v[144:147], v[88:91]
    ds_read_b64_tr_b16 v[132:133], v246 offset:4096
    ds_read_b64_tr_b16 v[134:135], v246 offset:4608
    v_mfma_f32_16x16x32_bf16 v[84:87], v[176:179], v[140:143], v[84:87]
    ds_read_b64_tr_b16 v[136:137], v247 offset:4096
    ds_read_b64_tr_b16 v[138:139], v247 offset:4608
    s_waitcnt lgkmcnt(0)
    s_nop 0
    v_mfma_f32_16x16x32_bf16 v[4:7], v[116:119], v[100:103], v[4:7]
    ds_read_b128 v[140:143], v245 offset:0
    v_mfma_f32_16x16x32_bf16 v[8:11], v[116:119], v[104:107], v[8:11]
    ds_read_b64_tr_b16 v[156:157], v246 offset:12288
    v_mfma_f32_16x16x32_bf16 v[12:15], v[116:119], v[108:111], v[12:15]
    ds_read_b64_tr_b16 v[158:159], v246 offset:12800
    v_mfma_f32_16x16x32_bf16 v[16:19], v[116:119], v[112:115], v[16:19]
    ds_read_b128 v[144:147], v245 offset:2048
    v_mfma_f32_16x16x32_bf16 v[32:35], v[120:123], v[112:115], v[32:35]
    ds_read_b128 v[148:151], v245 offset:4096
    v_mfma_f32_16x16x32_bf16 v[28:31], v[120:123], v[108:111], v[28:31]
    ds_read_b128 v[152:155], v245 offset:6144
    v_mfma_f32_16x16x32_bf16 v[24:27], v[120:123], v[104:107], v[24:27]
    ds_read_b64_tr_b16 v[160:161], v247 offset:12288
    v_mfma_f32_16x16x32_bf16 v[20:23], v[120:123], v[100:103], v[20:23]
    ds_read_b64_tr_b16 v[162:163], v247 offset:12800
    v_mfma_f32_16x16x32_bf16 v[36:39], v[124:127], v[100:103], v[36:39]
    ds_read_b64_tr_b16 v[164:165], v246 offset:14336
    v_mfma_f32_16x16x32_bf16 v[40:43], v[124:127], v[104:107], v[40:43]
    ds_read_b64_tr_b16 v[166:167], v246 offset:14848
    v_mfma_f32_16x16x32_bf16 v[44:47], v[124:127], v[108:111], v[44:47]
    ds_read_b64_tr_b16 v[168:169], v247 offset:14336
    v_mfma_f32_16x16x32_bf16 v[48:51], v[124:127], v[112:115], v[48:51]
    ds_read_b64_tr_b16 v[170:171], v247 offset:14848
    v_mfma_f32_16x16x32_bf16 v[64:67], v[128:131], v[112:115], v[64:67]
    ds_read_b64_tr_b16 v[172:173], v246 offset:16384
    v_mfma_f32_16x16x32_bf16 v[60:63], v[128:131], v[108:111], v[60:63]
    ds_read_b64_tr_b16 v[174:175], v246 offset:16896
    v_mfma_f32_16x16x32_bf16 v[56:59], v[128:131], v[104:107], v[56:59]
    ds_read_b64_tr_b16 v[176:177], v247 offset:16384
    v_mfma_f32_16x16x32_bf16 v[52:55], v[128:131], v[100:103], v[52:55]
    ds_read_b64_tr_b16 v[178:179], v247 offset:16896
    v_mfma_f32_16x16x32_bf16 v[68:71], v[132:135], v[100:103], v[68:71]
    v_mfma_f32_16x16x32_bf16 v[72:75], v[132:135], v[104:107], v[72:75]
    v_mfma_f32_16x16x32_bf16 v[76:79], v[132:135], v[108:111], v[76:79]
    v_mfma_f32_16x16x32_bf16 v[80:83], v[132:135], v[112:115], v[80:83]
    v_mfma_f32_16x16x32_bf16 v[96:99], v[136:139], v[112:115], v[96:99]
    v_mfma_f32_16x16x32_bf16 v[92:95], v[136:139], v[108:111], v[92:95]
    v_mfma_f32_16x16x32_bf16 v[88:91], v[136:139], v[104:107], v[88:91]
    v_mfma_f32_16x16x32_bf16 v[84:87], v[136:139], v[100:103], v[84:87]
    s_waitcnt lgkmcnt(0)
    s_barrier
    v_mfma_f32_16x16x32_bf16 v[4:7], v[156:159], v[140:143], v[4:7]
    ds_read_b128 v[100:103], v244 offset:16384
    v_mfma_f32_16x16x32_bf16 v[8:11], v[156:159], v[144:147], v[8:11]
    ds_read_b64_tr_b16 v[116:117], v246 offset:24576
    v_mfma_f32_16x16x32_bf16 v[12:15], v[156:159], v[148:151], v[12:15]
    ds_read_b64_tr_b16 v[118:119], v246 offset:25088
    v_mfma_f32_16x16x32_bf16 v[16:19], v[156:159], v[152:155], v[16:19]
    ds_read_b128 v[104:107], v244 offset:18432
    v_mfma_f32_16x16x32_bf16 v[32:35], v[160:163], v[152:155], v[32:35]
    ds_read_b128 v[108:111], v244 offset:20480
    v_mfma_f32_16x16x32_bf16 v[28:31], v[160:163], v[148:151], v[28:31]
    ds_read_b128 v[112:115], v244 offset:22528
    v_mfma_f32_16x16x32_bf16 v[24:27], v[160:163], v[144:147], v[24:27]
    ds_read_b64_tr_b16 v[120:121], v247 offset:24576
    v_mfma_f32_16x16x32_bf16 v[20:23], v[160:163], v[140:143], v[20:23]
    ds_read_b64_tr_b16 v[122:123], v247 offset:25088
    v_mfma_f32_16x16x32_bf16 v[36:39], v[164:167], v[140:143], v[36:39]
    ds_read_b64_tr_b16 v[124:125], v246 offset:26624
    v_mfma_f32_16x16x32_bf16 v[40:43], v[164:167], v[144:147], v[40:43]
    ds_read_b64_tr_b16 v[126:127], v246 offset:27136
    v_mfma_f32_16x16x32_bf16 v[44:47], v[164:167], v[148:151], v[44:47]
    ds_read_b64_tr_b16 v[128:129], v247 offset:26624
    v_mfma_f32_16x16x32_bf16 v[48:51], v[164:167], v[152:155], v[48:51]
    ds_read_b64_tr_b16 v[130:131], v247 offset:27136
    v_mfma_f32_16x16x32_bf16 v[64:67], v[168:171], v[152:155], v[64:67]
    ds_read_b64_tr_b16 v[132:133], v246 offset:28672
    v_mfma_f32_16x16x32_bf16 v[60:63], v[168:171], v[148:151], v[60:63]
    ds_read_b64_tr_b16 v[134:135], v246 offset:29184
    v_mfma_f32_16x16x32_bf16 v[56:59], v[168:171], v[144:147], v[56:59]
    ds_read_b64_tr_b16 v[136:137], v247 offset:28672
    v_mfma_f32_16x16x32_bf16 v[52:55], v[168:171], v[140:143], v[52:55]
    ds_read_b64_tr_b16 v[138:139], v247 offset:29184
    v_mfma_f32_16x16x32_bf16 v[68:71], v[172:175], v[140:143], v[68:71]
    v_mfma_f32_16x16x32_bf16 v[72:75], v[172:175], v[144:147], v[72:75]
    v_mfma_f32_16x16x32_bf16 v[76:79], v[172:175], v[148:151], v[76:79]
    v_mfma_f32_16x16x32_bf16 v[80:83], v[172:175], v[152:155], v[80:83]
    v_mfma_f32_16x16x32_bf16 v[96:99], v[176:179], v[152:155], v[96:99]
    v_mfma_f32_16x16x32_bf16 v[92:95], v[176:179], v[148:151], v[92:95]
    v_mfma_f32_16x16x32_bf16 v[88:91], v[176:179], v[144:147], v[88:91]
    v_mfma_f32_16x16x32_bf16 v[84:87], v[176:179], v[140:143], v[84:87]
    s_waitcnt lgkmcnt(0)
    s_nop 0
    v_mfma_f32_16x16x32_bf16 v[4:7], v[116:119], v[100:103], v[4:7]
    ds_read_b128 v[140:143], v245 offset:16384
    v_mfma_f32_16x16x32_bf16 v[8:11], v[116:119], v[104:107], v[8:11]
    ds_read_b64_tr_b16 v[156:157], v246 offset:36864
    v_mfma_f32_16x16x32_bf16 v[12:15], v[116:119], v[108:111], v[12:15]
    ds_read_b64_tr_b16 v[158:159], v246 offset:37376
    v_mfma_f32_16x16x32_bf16 v[16:19], v[116:119], v[112:115], v[16:19]
    ds_read_b128 v[144:147], v245 offset:18432
    v_mfma_f32_16x16x32_bf16 v[32:35], v[120:123], v[112:115], v[32:35]
    ds_read_b128 v[148:151], v245 offset:20480
    v_mfma_f32_16x16x32_bf16 v[28:31], v[120:123], v[108:111], v[28:31]
    ds_read_b128 v[152:155], v245 offset:22528
    v_mfma_f32_16x16x32_bf16 v[24:27], v[120:123], v[104:107], v[24:27]
    ds_read_b64_tr_b16 v[160:161], v247 offset:36864
    v_mfma_f32_16x16x32_bf16 v[20:23], v[120:123], v[100:103], v[20:23]
    ds_read_b64_tr_b16 v[162:163], v247 offset:37376
    v_mfma_f32_16x16x32_bf16 v[36:39], v[124:127], v[100:103], v[36:39]
    ds_read_b64_tr_b16 v[164:165], v246 offset:38912
    v_mfma_f32_16x16x32_bf16 v[40:43], v[124:127], v[104:107], v[40:43]
    ds_read_b64_tr_b16 v[166:167], v246 offset:39424
    v_mfma_f32_16x16x32_bf16 v[44:47], v[124:127], v[108:111], v[44:47]
    ds_read_b64_tr_b16 v[168:169], v247 offset:38912
    v_mfma_f32_16x16x32_bf16 v[48:51], v[124:127], v[112:115], v[48:51]
    ds_read_b64_tr_b16 v[170:171], v247 offset:39424
    v_mfma_f32_16x16x32_bf16 v[64:67], v[128:131], v[112:115], v[64:67]
    ds_read_b64_tr_b16 v[172:173], v246 offset:40960
    v_mfma_f32_16x16x32_bf16 v[60:63], v[128:131], v[108:111], v[60:63]
    ds_read_b64_tr_b16 v[174:175], v246 offset:41472
    v_mfma_f32_16x16x32_bf16 v[56:59], v[128:131], v[104:107], v[56:59]
    ds_read_b64_tr_b16 v[176:177], v247 offset:40960
    v_mfma_f32_16x16x32_bf16 v[52:55], v[128:131], v[100:103], v[52:55]
    ds_read_b64_tr_b16 v[178:179], v247 offset:41472
    v_mfma_f32_16x16x32_bf16 v[68:71], v[132:135], v[100:103], v[68:71]
    v_mfma_f32_16x16x32_bf16 v[72:75], v[132:135], v[104:107], v[72:75]
    v_mfma_f32_16x16x32_bf16 v[76:79], v[132:135], v[108:111], v[76:79]
    v_mfma_f32_16x16x32_bf16 v[80:83], v[132:135], v[112:115], v[80:83]
    v_mfma_f32_16x16x32_bf16 v[96:99], v[136:139], v[112:115], v[96:99]
    v_mfma_f32_16x16x32_bf16 v[92:95], v[136:139], v[108:111], v[92:95]
    v_mfma_f32_16x16x32_bf16 v[88:91], v[136:139], v[104:107], v[88:91]
    v_mfma_f32_16x16x32_bf16 v[84:87], v[136:139], v[100:103], v[84:87]
    s_waitcnt lgkmcnt(0)
    s_barrier
    v_mfma_f32_16x16x32_bf16 v[4:7], v[156:159], v[140:143], v[4:7]
    ds_read_b128 v[100:103], v244 offset:32768
    v_mfma_f32_16x16x32_bf16 v[8:11], v[156:159], v[144:147], v[8:11]
    ds_read_b64_tr_b16 v[116:117], v248 offset:0
    v_mfma_f32_16x16x32_bf16 v[12:15], v[156:159], v[148:151], v[12:15]
    ds_read_b64_tr_b16 v[118:119], v248 offset:512
    v_mfma_f32_16x16x32_bf16 v[16:19], v[156:159], v[152:155], v[16:19]
    ds_read_b128 v[104:107], v244 offset:34816
    v_mfma_f32_16x16x32_bf16 v[32:35], v[160:163], v[152:155], v[32:35]
    ds_read_b128 v[108:111], v244 offset:36864
    v_mfma_f32_16x16x32_bf16 v[28:31], v[160:163], v[148:151], v[28:31]
    ds_read_b128 v[112:115], v244 offset:38912
    v_mfma_f32_16x16x32_bf16 v[24:27], v[160:163], v[144:147], v[24:27]
    ds_read_b64_tr_b16 v[120:121], v249 offset:0
    v_mfma_f32_16x16x32_bf16 v[20:23], v[160:163], v[140:143], v[20:23]
    ds_read_b64_tr_b16 v[122:123], v249 offset:512
    v_mfma_f32_16x16x32_bf16 v[36:39], v[164:167], v[140:143], v[36:39]
    ds_read_b64_tr_b16 v[124:125], v248 offset:2048
    v_mfma_f32_16x16x32_bf16 v[40:43], v[164:167], v[144:147], v[40:43]
    ds_read_b64_tr_b16 v[126:127], v248 offset:2560
    v_mfma_f32_16x16x32_bf16 v[44:47], v[164:167], v[148:151], v[44:47]
    ds_read_b64_tr_b16 v[128:129], v249 offset:2048
    v_mfma_f32_16x16x32_bf16 v[48:51], v[164:167], v[152:155], v[48:51]
    ds_read_b64_tr_b16 v[130:131], v249 offset:2560
    v_mfma_f32_16x16x32_bf16 v[64:67], v[168:171], v[152:155], v[64:67]
    ds_read_b64_tr_b16 v[132:133], v248 offset:4096
    v_mfma_f32_16x16x32_bf16 v[60:63], v[168:171], v[148:151], v[60:63]
    ds_read_b64_tr_b16 v[134:135], v248 offset:4608
    v_mfma_f32_16x16x32_bf16 v[56:59], v[168:171], v[144:147], v[56:59]
    ds_read_b64_tr_b16 v[136:137], v249 offset:4096
    v_mfma_f32_16x16x32_bf16 v[52:55], v[168:171], v[140:143], v[52:55]
    ds_read_b64_tr_b16 v[138:139], v249 offset:4608
    v_mfma_f32_16x16x32_bf16 v[68:71], v[172:175], v[140:143], v[68:71]
    v_mfma_f32_16x16x32_bf16 v[72:75], v[172:175], v[144:147], v[72:75]
    v_mfma_f32_16x16x32_bf16 v[76:79], v[172:175], v[148:151], v[76:79]
    v_mfma_f32_16x16x32_bf16 v[80:83], v[172:175], v[152:155], v[80:83]
    v_mfma_f32_16x16x32_bf16 v[96:99], v[176:179], v[152:155], v[96:99]
    v_mfma_f32_16x16x32_bf16 v[92:95], v[176:179], v[148:151], v[92:95]
    v_mfma_f32_16x16x32_bf16 v[88:91], v[176:179], v[144:147], v[88:91]
    v_mfma_f32_16x16x32_bf16 v[84:87], v[176:179], v[140:143], v[84:87]
    s_waitcnt lgkmcnt(0)
    s_nop 0
    v_mfma_f32_16x16x32_bf16 v[4:7], v[116:119], v[100:103], v[4:7]
    ds_read_b128 v[140:143], v245 offset:32768
    v_mfma_f32_16x16x32_bf16 v[8:11], v[116:119], v[104:107], v[8:11]
    ds_read_b64_tr_b16 v[156:157], v248 offset:12288
    v_mfma_f32_16x16x32_bf16 v[12:15], v[116:119], v[108:111], v[12:15]
    ds_read_b64_tr_b16 v[158:159], v248 offset:12800
    v_mfma_f32_16x16x32_bf16 v[16:19], v[116:119], v[112:115], v[16:19]
    ds_read_b128 v[144:147], v245 offset:34816
    v_mfma_f32_16x16x32_bf16 v[32:35], v[120:123], v[112:115], v[32:35]
    ds_read_b128 v[148:151], v245 offset:36864
    v_mfma_f32_16x16x32_bf16 v[28:31], v[120:123], v[108:111], v[28:31]
    ds_read_b128 v[152:155], v245 offset:38912
    v_mfma_f32_16x16x32_bf16 v[24:27], v[120:123], v[104:107], v[24:27]
    ds_read_b64_tr_b16 v[160:161], v249 offset:12288
    v_mfma_f32_16x16x32_bf16 v[20:23], v[120:123], v[100:103], v[20:23]
    ds_read_b64_tr_b16 v[162:163], v249 offset:12800
    v_mfma_f32_16x16x32_bf16 v[36:39], v[124:127], v[100:103], v[36:39]
    ds_read_b64_tr_b16 v[164:165], v248 offset:14336
    v_mfma_f32_16x16x32_bf16 v[40:43], v[124:127], v[104:107], v[40:43]
    ds_read_b64_tr_b16 v[166:167], v248 offset:14848
    v_mfma_f32_16x16x32_bf16 v[44:47], v[124:127], v[108:111], v[44:47]
    ds_read_b64_tr_b16 v[168:169], v249 offset:14336
    v_mfma_f32_16x16x32_bf16 v[48:51], v[124:127], v[112:115], v[48:51]
    ds_read_b64_tr_b16 v[170:171], v249 offset:14848
    v_mfma_f32_16x16x32_bf16 v[64:67], v[128:131], v[112:115], v[64:67]
    ds_read_b64_tr_b16 v[172:173], v248 offset:16384
    v_mfma_f32_16x16x32_bf16 v[60:63], v[128:131], v[108:111], v[60:63]
    ds_read_b64_tr_b16 v[174:175], v248 offset:16896
    v_mfma_f32_16x16x32_bf16 v[56:59], v[128:131], v[104:107], v[56:59]
    ds_read_b64_tr_b16 v[176:177], v249 offset:16384
    v_mfma_f32_16x16x32_bf16 v[52:55], v[128:131], v[100:103], v[52:55]
    ds_read_b64_tr_b16 v[178:179], v249 offset:16896
    v_mfma_f32_16x16x32_bf16 v[68:71], v[132:135], v[100:103], v[68:71]
    v_mfma_f32_16x16x32_bf16 v[72:75], v[132:135], v[104:107], v[72:75]
    v_mfma_f32_16x16x32_bf16 v[76:79], v[132:135], v[108:111], v[76:79]
    v_mfma_f32_16x16x32_bf16 v[80:83], v[132:135], v[112:115], v[80:83]
    v_mfma_f32_16x16x32_bf16 v[96:99], v[136:139], v[112:115], v[96:99]
    v_mfma_f32_16x16x32_bf16 v[92:95], v[136:139], v[108:111], v[92:95]
    v_mfma_f32_16x16x32_bf16 v[88:91], v[136:139], v[104:107], v[88:91]
    v_mfma_f32_16x16x32_bf16 v[84:87], v[136:139], v[100:103], v[84:87]
    s_waitcnt lgkmcnt(0)
L_anchor_cm:
    s_barrier
    v_mfma_f32_16x16x32_bf16 v[4:7], v[156:159], v[140:143], v[4:7]
    ds_read_b128 v[100:103], v244 offset:0
    v_mfma_f32_16x16x32_bf16 v[8:11], v[156:159], v[144:147], v[8:11]
    ds_read_b64_tr_b16 v[116:117], v246 offset:0
    v_mfma_f32_16x16x32_bf16 v[12:15], v[156:159], v[148:151], v[12:15]
    ds_read_b64_tr_b16 v[118:119], v246 offset:512
    v_mfma_f32_16x16x32_bf16 v[16:19], v[156:159], v[152:155], v[16:19]
    ds_read_b128 v[104:107], v244 offset:2048
    v_mfma_f32_16x16x32_bf16 v[32:35], v[160:163], v[152:155], v[32:35]
    ds_read_b128 v[108:111], v244 offset:4096
    v_mfma_f32_16x16x32_bf16 v[28:31], v[160:163], v[148:151], v[28:31]
    ds_read_b128 v[112:115], v244 offset:6144
    v_mfma_f32_16x16x32_bf16 v[24:27], v[160:163], v[144:147], v[24:27]
    ds_read_b64_tr_b16 v[120:121], v247 offset:0
    v_mfma_f32_16x16x32_bf16 v[20:23], v[160:163], v[140:143], v[20:23]
    ds_read_b64_tr_b16 v[122:123], v247 offset:512
    v_mfma_f32_16x16x32_bf16 v[36:39], v[164:167], v[140:143], v[36:39]
    ds_read_b64_tr_b16 v[124:125], v246 offset:2048
    v_mfma_f32_16x16x32_bf16 v[40:43], v[164:167], v[144:147], v[40:43]
    ds_read_b64_tr_b16 v[126:127], v246 offset:2560
    v_mfma_f32_16x16x32_bf16 v[44:47], v[164:167], v[148:151], v[44:47]
    ds_read_b64_tr_b16 v[128:129], v247 offset:2048
    v_mfma_f32_16x16x32_bf16 v[48:51], v[164:167], v[152:155], v[48:51]
    ds_read_b64_tr_b16 v[130:131], v247 offset:2560
    v_mfma_f32_16x16x32_bf16 v[64:67], v[168:171], v[152:155], v[64:67]
    ds_read_b64_tr_b16 v[132:133], v246 offset:4096
    v_mfma_f32_16x16x32_bf16 v[60:63], v[168:171], v[148:151], v[60:63]
    ds_read_b64_tr_b16 v[134:135], v246 offset:4608
    v_mfma_f32_16x16x32_bf16 v[56:59], v[168:171], v[144:147], v[56:59]
    ds_read_b64_tr_b16 v[136:137], v247 offset:4096
    v_mfma_f32_16x16x32_bf16 v[52:55], v[168:171], v[140:143], v[52:55]
    ds_read_b64_tr_b16 v[138:139], v247 offset:4608
    v_mfma_f32_16x16x32_bf16 v[68:71], v[172:175], v[140:143], v[68:71]
    v_mfma_f32_16x16x32_bf16 v[72:75], v[172:175], v[144:147], v[72:75]
    v_mfma_f32_16x16x32_bf16 v[76:79], v[172:175], v[148:151], v[76:79]
    v_mfma_f32_16x16x32_bf16 v[80:83], v[172:175], v[152:155], v[80:83]
    v_mfma_f32_16x16x32_bf16 v[96:99], v[176:179], v[152:155], v[96:99]
    v_mfma_f32_16x16x32_bf16 v[92:95], v[176:179], v[148:151], v[92:95]
    v_mfma_f32_16x16x32_bf16 v[88:91], v[176:179], v[144:147], v[88:91]
    v_mfma_f32_16x16x32_bf16 v[84:87], v[176:179], v[140:143], v[84:87]
    s_waitcnt lgkmcnt(0)
    s_nop 0
    v_mfma_f32_16x16x32_bf16 v[4:7], v[116:119], v[100:103], v[4:7]
    ds_read_b128 v[140:143], v245 offset:0
    v_mfma_f32_16x16x32_bf16 v[8:11], v[116:119], v[104:107], v[8:11]
    ds_read_b64_tr_b16 v[156:157], v246 offset:12288
    v_mfma_f32_16x16x32_bf16 v[12:15], v[116:119], v[108:111], v[12:15]
    ds_read_b64_tr_b16 v[158:159], v246 offset:12800
    v_mfma_f32_16x16x32_bf16 v[16:19], v[116:119], v[112:115], v[16:19]
    ds_read_b128 v[144:147], v245 offset:2048
    v_mfma_f32_16x16x32_bf16 v[32:35], v[120:123], v[112:115], v[32:35]
    ds_read_b128 v[148:151], v245 offset:4096
    v_mfma_f32_16x16x32_bf16 v[28:31], v[120:123], v[108:111], v[28:31]
    ds_read_b128 v[152:155], v245 offset:6144
    v_mfma_f32_16x16x32_bf16 v[24:27], v[120:123], v[104:107], v[24:27]
    ds_read_b64_tr_b16 v[160:161], v247 offset:12288
    v_mfma_f32_16x16x32_bf16 v[20:23], v[120:123], v[100:103], v[20:23]
    ds_read_b64_tr_b16 v[162:163], v247 offset:12800
    v_mfma_f32_16x16x32_bf16 v[36:39], v[124:127], v[100:103], v[36:39]
    ds_read_b64_tr_b16 v[164:165], v246 offset:14336
    v_mfma_f32_16x16x32_bf16 v[40:43], v[124:127], v[104:107], v[40:43]
    ds_read_b64_tr_b16 v[166:167], v246 offset:14848
    v_mfma_f32_16x16x32_bf16 v[44:47], v[124:127], v[108:111], v[44:47]
    ds_read_b64_tr_b16 v[168:169], v247 offset:14336
    v_mfma_f32_16x16x32_bf16 v[48:51], v[124:127], v[112:115], v[48:51]
    ds_read_b64_tr_b16 v[170:171], v247 offset:14848
    v_mfma_f32_16x16x32_bf16 v[64:67], v[128:131], v[112:115], v[64:67]
    ds_read_b64_tr_b16 v[172:173], v246 offset:16384
    v_mfma_f32_16x16x32_bf16 v[60:63], v[128:131], v[108:111], v[60:63]
    ds_read_b64_tr_b16 v[174:175], v246 offset:16896
    v_mfma_f32_16x16x32_bf16 v[56:59], v[128:131], v[104:107], v[56:59]
    ds_read_b64_tr_b16 v[176:177], v247 offset:16384
    v_mfma_f32_16x16x32_bf16 v[52:55], v[128:131], v[100:103], v[52:55]
    ds_read_b64_tr_b16 v[178:179], v247 offset:16896
    v_mfma_f32_16x16x32_bf16 v[68:71], v[132:135], v[100:103], v[68:71]
    v_mfma_f32_16x16x32_bf16 v[72:75], v[132:135], v[104:107], v[72:75]
    v_mfma_f32_16x16x32_bf16 v[76:79], v[132:135], v[108:111], v[76:79]
    v_mfma_f32_16x16x32_bf16 v[80:83], v[132:135], v[112:115], v[80:83]
    v_mfma_f32_16x16x32_bf16 v[96:99], v[136:139], v[112:115], v[96:99]
    v_mfma_f32_16x16x32_bf16 v[92:95], v[136:139], v[108:111], v[92:95]
    v_mfma_f32_16x16x32_bf16 v[88:91], v[136:139], v[104:107], v[88:91]
    v_mfma_f32_16x16x32_bf16 v[84:87], v[136:139], v[100:103], v[84:87]
    s_waitcnt lgkmcnt(0)
    s_barrier
    v_mfma_f32_16x16x32_bf16 v[4:7], v[156:159], v[140:143], v[4:7]
    ds_read_b128 v[100:103], v244 offset:16384
    v_mfma_f32_16x16x32_bf16 v[8:11], v[156:159], v[144:147], v[8:11]
    ds_read_b64_tr_b16 v[116:117], v246 offset:24576
    v_mfma_f32_16x16x32_bf16 v[12:15], v[156:159], v[148:151], v[12:15]
    ds_read_b64_tr_b16 v[118:119], v246 offset:25088
    v_mfma_f32_16x16x32_bf16 v[16:19], v[156:159], v[152:155], v[16:19]
    ds_read_b128 v[104:107], v244 offset:18432
    v_mfma_f32_16x16x32_bf16 v[32:35], v[160:163], v[152:155], v[32:35]
    ds_read_b128 v[108:111], v244 offset:20480
    v_mfma_f32_16x16x32_bf16 v[28:31], v[160:163], v[148:151], v[28:31]
    ds_read_b128 v[112:115], v244 offset:22528
    v_mfma_f32_16x16x32_bf16 v[24:27], v[160:163], v[144:147], v[24:27]
    ds_read_b64_tr_b16 v[120:121], v247 offset:24576
    v_mfma_f32_16x16x32_bf16 v[20:23], v[160:163], v[140:143], v[20:23]
    ds_read_b64_tr_b16 v[122:123], v247 offset:25088
    v_mfma_f32_16x16x32_bf16 v[36:39], v[164:167], v[140:143], v[36:39]
    ds_read_b64_tr_b16 v[124:125], v246 offset:26624
    v_mfma_f32_16x16x32_bf16 v[40:43], v[164:167], v[144:147], v[40:43]
    ds_read_b64_tr_b16 v[126:127], v246 offset:27136
    v_mfma_f32_16x16x32_bf16 v[44:47], v[164:167], v[148:151], v[44:47]
    ds_read_b64_tr_b16 v[128:129], v247 offset:26624
    v_mfma_f32_16x16x32_bf16 v[48:51], v[164:167], v[152:155], v[48:51]
    ds_read_b64_tr_b16 v[130:131], v247 offset:27136
    v_mfma_f32_16x16x32_bf16 v[64:67], v[168:171], v[152:155], v[64:67]
    ds_read_b64_tr_b16 v[132:133], v246 offset:28672
    v_mfma_f32_16x16x32_bf16 v[60:63], v[168:171], v[148:151], v[60:63]
    ds_read_b64_tr_b16 v[134:135], v246 offset:29184
    v_mfma_f32_16x16x32_bf16 v[56:59], v[168:171], v[144:147], v[56:59]
    ds_read_b64_tr_b16 v[136:137], v247 offset:28672
    v_mfma_f32_16x16x32_bf16 v[52:55], v[168:171], v[140:143], v[52:55]
    ds_read_b64_tr_b16 v[138:139], v247 offset:29184
    v_mfma_f32_16x16x32_bf16 v[68:71], v[172:175], v[140:143], v[68:71]
    s_lshl_b32 s80, s84, 8
    s_add_u32 s80, s80, 147456
    v_mfma_f32_16x16x32_bf16 v[72:75], v[172:175], v[144:147], v[72:75]
    v_and_b32 v243, 15, v0
    v_add_u32 v241, s80, v252
    v_mfma_f32_16x16x32_bf16 v[76:79], v[172:175], v[148:151], v[76:79]
    v_lshl_add_u32 v240, v243, 2, s80
    v_mfma_f32_16x16x32_bf16 v[80:83], v[172:175], v[152:155], v[80:83]
    v_mfma_f32_16x16x32_bf16 v[96:99], v[176:179], v[152:155], v[96:99]
    s_lshl_b32 s80, s47, 6
    s_add_u32 s80, s80, 148480
    v_mfma_f32_16x16x32_bf16 v[92:95], v[176:179], v[148:151], v[92:95]
    v_lshl_add_u32 v243, v243, 2, s80
    v_mfma_f32_16x16x32_bf16 v[88:91], v[176:179], v[144:147], v[88:91]
    v_add_u32_e64 v242, s80, v252
    v_mfma_f32_16x16x32_bf16 v[84:87], v[176:179], v[140:143], v[84:87]
    s_waitcnt lgkmcnt(0)
    s_nop 0
    v_mfma_f32_16x16x32_bf16 v[4:7], v[116:119], v[100:103], v[4:7]
    ds_read_b128 v[140:143], v245 offset:16384
    v_mfma_f32_16x16x32_bf16 v[8:11], v[116:119], v[104:107], v[8:11]
    ds_read_b64_tr_b16 v[156:157], v246 offset:36864
    v_mfma_f32_16x16x32_bf16 v[12:15], v[116:119], v[108:111], v[12:15]
    ds_read_b64_tr_b16 v[158:159], v246 offset:37376
    v_mfma_f32_16x16x32_bf16 v[16:19], v[116:119], v[112:115], v[16:19]
    ds_read_b128 v[144:147], v245 offset:18432
    v_mfma_f32_16x16x32_bf16 v[32:35], v[120:123], v[112:115], v[32:35]
    ds_read_b128 v[148:151], v245 offset:20480
    v_mfma_f32_16x16x32_bf16 v[28:31], v[120:123], v[108:111], v[28:31]
    ds_read_b128 v[152:155], v245 offset:22528
    v_mfma_f32_16x16x32_bf16 v[24:27], v[120:123], v[104:107], v[24:27]
    ds_read_b64_tr_b16 v[160:161], v247 offset:36864
    v_mfma_f32_16x16x32_bf16 v[20:23], v[120:123], v[100:103], v[20:23]
    ds_read_b64_tr_b16 v[162:163], v247 offset:37376
    v_mfma_f32_16x16x32_bf16 v[36:39], v[124:127], v[100:103], v[36:39]
    ds_read_b64_tr_b16 v[164:165], v246 offset:38912
    v_mfma_f32_16x16x32_bf16 v[40:43], v[124:127], v[104:107], v[40:43]
    ds_read_b64_tr_b16 v[166:167], v246 offset:39424
    v_mfma_f32_16x16x32_bf16 v[44:47], v[124:127], v[108:111], v[44:47]
    ds_read_b64_tr_b16 v[168:169], v247 offset:38912
    v_mfma_f32_16x16x32_bf16 v[48:51], v[124:127], v[112:115], v[48:51]
    ds_read_b64_tr_b16 v[170:171], v247 offset:39424
    v_mfma_f32_16x16x32_bf16 v[64:67], v[128:131], v[112:115], v[64:67]
    ds_read_b64_tr_b16 v[172:173], v246 offset:40960
    v_mfma_f32_16x16x32_bf16 v[60:63], v[128:131], v[108:111], v[60:63]
    ds_read_b64_tr_b16 v[174:175], v246 offset:41472
    v_mfma_f32_16x16x32_bf16 v[56:59], v[128:131], v[104:107], v[56:59]
    ds_read_b64_tr_b16 v[176:177], v247 offset:40960
    v_mfma_f32_16x16x32_bf16 v[52:55], v[128:131], v[100:103], v[52:55]
    ds_read_b64_tr_b16 v[178:179], v247 offset:41472
    v_mfma_f32_16x16x32_bf16 v[68:71], v[132:135], v[100:103], v[68:71]
    v_mfma_f32_16x16x32_bf16 v[72:75], v[132:135], v[104:107], v[72:75]
    v_mfma_f32_16x16x32_bf16 v[76:79], v[132:135], v[108:111], v[76:79]
    v_mfma_f32_16x16x32_bf16 v[80:83], v[132:135], v[112:115], v[80:83]
    v_mfma_f32_16x16x32_bf16 v[96:99], v[136:139], v[112:115], v[96:99]
    v_mfma_f32_16x16x32_bf16 v[92:95], v[136:139], v[108:111], v[92:95]
    v_mfma_f32_16x16x32_bf16 v[88:91], v[136:139], v[104:107], v[88:91]
    v_mfma_f32_16x16x32_bf16 v[84:87], v[136:139], v[100:103], v[84:87]
    s_waitcnt lgkmcnt(0)
    s_nop 0
    v_mfma_f32_16x16x32_bf16 v[4:7], v[156:159], v[140:143], v[4:7]
    ds_read_b32 v180, v240 offset:0
    v_mfma_f32_16x16x32_bf16 v[8:11], v[156:159], v[144:147], v[8:11]
    ds_read_b32 v132, v240 offset:512
    v_mfma_f32_16x16x32_bf16 v[12:15], v[156:159], v[148:151], v[12:15]
    ds_read_b32 v182, v240 offset:64
    v_mfma_f32_16x16x32_bf16 v[16:19], v[156:159], v[152:155], v[16:19]
    ds_read_b32 v134, v240 offset:576
    v_mfma_f32_16x16x32_bf16 v[32:35], v[160:163], v[152:155], v[32:35]
    ds_read_b32 v184, v240 offset:128
    v_mfma_f32_16x16x32_bf16 v[28:31], v[160:163], v[148:151], v[28:31]
    ds_read_b32 v136, v240 offset:640
    v_mfma_f32_16x16x32_bf16 v[24:27], v[160:163], v[144:147], v[24:27]
    ds_read_b32 v186, v240 offset:192
    v_mfma_f32_16x16x32_bf16 v[20:23], v[160:163], v[140:143], v[20:23]
    ds_read_b32 v138, v240 offset:704
    v_mfma_f32_16x16x32_bf16 v[36:39], v[164:167], v[140:143], v[36:39]
    ds_read_b128 v[188:191], v242 offset:0
    v_mfma_f32_16x16x32_bf16 v[40:43], v[164:167], v[144:147], v[40:43]
    ds_read_b128 v[192:195], v242 offset:64
    v_mfma_f32_16x16x32_bf16 v[44:47], v[164:167], v[148:151], v[44:47]
    ds_read_b128 v[196:199], v242 offset:512
    v_mfma_f32_16x16x32_bf16 v[48:51], v[164:167], v[152:155], v[48:51]
    ds_read_b128 v[200:203], v242 offset:576
    v_mfma_f32_16x16x32_bf16 v[64:67], v[168:171], v[152:155], v[64:67]
    ds_read_b128 v[204:207], v242 offset:256
    v_mfma_f32_16x16x32_bf16 v[60:63], v[168:171], v[148:151], v[60:63]
    ds_read_b128 v[208:211], v242 offset:320
    v_mfma_f32_16x16x32_bf16 v[56:59], v[168:171], v[144:147], v[56:59]
    ds_read_b32 v3, v243 offset:768
    v_mfma_f32_16x16x32_bf16 v[52:55], v[168:171], v[140:143], v[52:55]
    v_mov_b32 v246, v250
    v_lshrrev_b32 v244, 7, v246
    v_mfma_f32_16x16x32_bf16 v[68:71], v[172:175], v[140:143], v[68:71]
    v_cmp_eq_u32 vcc, 3, v244
    v_mfma_f32_16x16x32_bf16 v[72:75], v[172:175], v[144:147], v[72:75]
    v_add_u32 v244, 4224, v246
    v_mfma_f32_16x16x32_bf16 v[76:79], v[172:175], v[148:151], v[76:79]
    v_cndmask_b32 v246, v246, v244, vcc
    v_mfma_f32_16x16x32_bf16 v[80:83], v[172:175], v[152:155], v[80:83]
    v_cndmask_b32_e64 v244, 8, 1, vcc
    v_mfma_f32_16x16x32_bf16 v[96:99], v[176:179], v[152:155], v[96:99]
    v_lshlrev_b32 v244, 7, v244
    v_mfma_f32_16x16x32_bf16 v[92:95], v[176:179], v[148:151], v[92:95]
    v_add_u32 v247, v246, v244
    v_mfma_f32_16x16x32_bf16 v[88:91], v[176:179], v[144:147], v[88:91]
    v_add_u32 v248, v247, v244
    v_mfma_f32_16x16x32_bf16 v[84:87], v[176:179], v[140:143], v[84:87]
    v_add_u32 v249, v248, v244
    s_waitcnt lgkmcnt(0)
    v_pk_fma_f32 v[100:101], v[188:189], v[132:133], v[212:213] op_sel_hi:[1,0,1]
    v_pk_fma_f32 v[102:103], v[190:191], v[132:133], v[214:215] op_sel_hi:[1,0,1]
    v_pk_fma_f32 v[104:105], v[192:193], v[132:133], v[216:217] op_sel_hi:[1,0,1]
    v_pk_fma_f32 v[106:107], v[194:195], v[132:133], v[218:219] op_sel_hi:[1,0,1]
    v_pk_fma_f32 v[100:101], v[4:5], v[180:181], v[100:101] op_sel_hi:[1,0,1]
    v_pk_fma_f32 v[102:103], v[6:7], v[180:181], v[102:103] op_sel_hi:[1,0,1]
    v_pk_fma_f32 v[104:105], v[20:21], v[180:181], v[104:105] op_sel_hi:[1,0,1]
    v_pk_fma_f32 v[106:107], v[22:23], v[180:181], v[106:107] op_sel_hi:[1,0,1]
    v_max_f32 v100, 0, v100
    v_max_f32 v101, 0, v101
    v_max_f32 v102, 0, v102
    v_max_f32 v103, 0, v103
    v_max_f32 v104, 0, v104
    v_max_f32 v105, 0, v105
    v_max_f32 v106, 0, v106
    v_max_f32_e64 v107, 0, v107
    v_pk_mul_f32 v[100:101], v[100:101], v[100:101]
    v_pk_mul_f32 v[102:103], v[102:103], v[102:103]
    v_pk_mul_f32 v[104:105], v[104:105], v[104:105]
    v_pk_mul_f32 v[106:107], v[106:107], v[106:107]
    v_cvt_pk_bf16_f32 v116, v100, v101
    v_cvt_pk_bf16_f32 v117, v102, v103
    v_cvt_pk_bf16_f32 v118, v104, v105
    v_cvt_pk_bf16_f32 v119, v106, v107
    buffer_store_dwordx4 v[116:119], v246, s[32:35], s92 offen sc1
    v_pk_fma_f32 v[108:109], v[188:189], v[134:135], v[212:213] op_sel_hi:[1,0,1]
    v_pk_fma_f32 v[110:111], v[190:191], v[134:135], v[214:215] op_sel_hi:[1,0,1]
    v_pk_fma_f32 v[112:113], v[192:193], v[134:135], v[216:217] op_sel_hi:[1,0,1]
    v_pk_fma_f32 v[114:115], v[194:195], v[134:135], v[218:219] op_sel_hi:[1,0,1]
    v_pk_fma_f32 v[108:109], v[8:9], v[182:183], v[108:109] op_sel_hi:[1,0,1]
    v_pk_fma_f32 v[110:111], v[10:11], v[182:183], v[110:111] op_sel_hi:[1,0,1]
    v_pk_fma_f32 v[112:113], v[24:25], v[182:183], v[112:113] op_sel_hi:[1,0,1]
    v_pk_fma_f32 v[114:115], v[26:27], v[182:183], v[114:115] op_sel_hi:[1,0,1]
    v_max_f32 v108, 0, v108
    v_max_f32 v109, 0, v109
    v_max_f32 v110, 0, v110
    v_max_f32 v111, 0, v111
    v_max_f32 v112, 0, v112
    v_max_f32 v113, 0, v113
    v_max_f32 v114, 0, v114
    v_max_f32 v115, 0, v115
    v_pk_mul_f32 v[108:109], v[108:109], v[108:109]
    v_pk_mul_f32 v[110:111], v[110:111], v[110:111]
    v_pk_mul_f32 v[112:113], v[112:113], v[112:113]
    v_pk_mul_f32 v[114:115], v[114:115], v[114:115]
    v_cvt_pk_bf16_f32 v120, v108, v109
    v_cvt_pk_bf16_f32 v121, v110, v111
    v_cvt_pk_bf16_f32 v122, v112, v113
    v_cvt_pk_bf16_f32 v123, v114, v115
    buffer_store_dwordx4 v[120:123], v247, s[32:35], s92 offen sc1
    v_pk_fma_f32 v[100:101], v[188:189], v[136:137], v[212:213] op_sel_hi:[1,0,1]
    v_pk_fma_f32 v[102:103], v[190:191], v[136:137], v[214:215] op_sel_hi:[1,0,1]
    v_pk_fma_f32 v[104:105], v[192:193], v[136:137], v[216:217] op_sel_hi:[1,0,1]
    v_pk_fma_f32 v[106:107], v[194:195], v[136:137], v[218:219] op_sel_hi:[1,0,1]
    v_pk_fma_f32 v[100:101], v[12:13], v[184:185], v[100:101] op_sel_hi:[1,0,1]
    v_pk_fma_f32 v[102:103], v[14:15], v[184:185], v[102:103] op_sel_hi:[1,0,1]
    v_pk_fma_f32 v[104:105], v[28:29], v[184:185], v[104:105] op_sel_hi:[1,0,1]
    v_pk_fma_f32 v[106:107], v[30:31], v[184:185], v[106:107] op_sel_hi:[1,0,1]
    v_max_f32 v100, 0, v100
    v_max_f32 v101, 0, v101
    v_max_f32 v102, 0, v102
    v_max_f32 v103, 0, v103
    v_max_f32 v104, 0, v104
    v_max_f32 v105, 0, v105
    v_max_f32 v106, 0, v106
    v_max_f32 v107, 0, v107
    v_pk_mul_f32 v[100:101], v[100:101], v[100:101]
    v_pk_mul_f32 v[102:103], v[102:103], v[102:103]
    v_pk_mul_f32 v[104:105], v[104:105], v[104:105]
    v_pk_mul_f32 v[106:107], v[106:107], v[106:107]
    v_cvt_pk_bf16_f32 v124, v100, v101
    v_cvt_pk_bf16_f32 v125, v102, v103
    v_cvt_pk_bf16_f32 v126, v104, v105
    v_cvt_pk_bf16_f32 v127, v106, v107
    buffer_store_dwordx4 v[124:127], v248, s[32:35], s92 offen sc1
    v_pk_fma_f32 v[108:109], v[188:189], v[138:139], v[212:213] op_sel_hi:[1,0,1]
    v_pk_fma_f32 v[110:111], v[190:191], v[138:139], v[214:215] op_sel_hi:[1,0,1]
    v_pk_fma_f32 v[112:113], v[192:193], v[138:139], v[216:217] op_sel_hi:[1,0,1]
    v_pk_fma_f32 v[114:115], v[194:195], v[138:139], v[218:219] op_sel_hi:[1,0,1]
    v_pk_fma_f32 v[108:109], v[16:17], v[186:187], v[108:109] op_sel_hi:[1,0,1]
    v_pk_fma_f32 v[110:111], v[18:19], v[186:187], v[110:111] op_sel_hi:[1,0,1]
    v_pk_fma_f32 v[112:113], v[32:33], v[186:187], v[112:113] op_sel_hi:[1,0,1]
    v_pk_fma_f32 v[114:115], v[34:35], v[186:187], v[114:115] op_sel_hi:[1,0,1]
    v_max_f32 v108, 0, v108
    v_max_f32 v109, 0, v109
    v_max_f32 v110, 0, v110
    v_max_f32 v111, 0, v111
    v_max_f32 v112, 0, v112
    v_max_f32 v113, 0, v113
    v_max_f32 v114, 0, v114
    v_max_f32 v115, 0, v115
    v_pk_mul_f32 v[108:109], v[108:109], v[108:109]
    v_pk_mul_f32 v[110:111], v[110:111], v[110:111]
    v_pk_mul_f32 v[112:113], v[112:113], v[112:113]
    v_pk_mul_f32 v[114:115], v[114:115], v[114:115]
    v_cvt_pk_bf16_f32 v128, v108, v109
    v_cvt_pk_bf16_f32 v129, v110, v111
    v_cvt_pk_bf16_f32 v130, v112, v113
    v_cvt_pk_bf16_f32 v131, v114, v115
    buffer_store_dwordx4 v[128:131], v249, s[32:35], s92 offen sc1
    s_add_u32 s92, s92, 10240
    v_pk_fma_f32 v[100:101], v[196:197], v[132:133], v[220:221] op_sel_hi:[1,0,1]
    v_pk_fma_f32 v[102:103], v[198:199], v[132:133], v[222:223] op_sel_hi:[1,0,1]
    v_pk_fma_f32 v[104:105], v[200:201], v[132:133], v[224:225] op_sel_hi:[1,0,1]
    v_pk_fma_f32 v[106:107], v[202:203], v[132:133], v[226:227] op_sel_hi:[1,0,1]
    v_pk_fma_f32 v[100:101], v[36:37], v[180:181], v[100:101] op_sel_hi:[1,0,1]
    v_pk_fma_f32 v[102:103], v[38:39], v[180:181], v[102:103] op_sel_hi:[1,0,1]
    v_pk_fma_f32 v[104:105], v[52:53], v[180:181], v[104:105] op_sel_hi:[1,0,1]
    v_pk_fma_f32 v[106:107], v[54:55], v[180:181], v[106:107] op_sel_hi:[1,0,1]
    v_max_f32 v100, 0, v100
    v_max_f32 v101, 0, v101
    v_max_f32 v102, 0, v102
    v_max_f32 v103, 0, v103
    v_max_f32 v104, 0, v104
    v_max_f32 v105, 0, v105
    v_max_f32 v106, 0, v106
    v_max_f32 v107, 0, v107
    v_pk_mul_f32 v[100:101], v[100:101], v[100:101]
    v_pk_mul_f32 v[102:103], v[102:103], v[102:103]
    v_pk_mul_f32 v[104:105], v[104:105], v[104:105]
    v_pk_mul_f32 v[106:107], v[106:107], v[106:107]
    v_cvt_pk_bf16_f32 v116, v100, v101
    v_cvt_pk_bf16_f32 v117, v102, v103
    v_cvt_pk_bf16_f32 v118, v104, v105
    v_cvt_pk_bf16_f32 v119, v106, v107
    buffer_store_dwordx4 v[116:119], v246, s[32:35], s92 offen sc1
    v_pk_fma_f32 v[108:109], v[196:197], v[134:135], v[220:221] op_sel_hi:[1,0,1]
    v_pk_fma_f32 v[110:111], v[198:199], v[134:135], v[222:223] op_sel_hi:[1,0,1]
    v_pk_fma_f32 v[112:113], v[200:201], v[134:135], v[224:225] op_sel_hi:[1,0,1]
    v_pk_fma_f32 v[114:115], v[202:203], v[134:135], v[226:227] op_sel_hi:[1,0,1]
    v_pk_fma_f32 v[108:109], v[40:41], v[182:183], v[108:109] op_sel_hi:[1,0,1]
    v_pk_fma_f32 v[110:111], v[42:43], v[182:183], v[110:111] op_sel_hi:[1,0,1]
    v_pk_fma_f32 v[112:113], v[56:57], v[182:183], v[112:113] op_sel_hi:[1,0,1]
    v_pk_fma_f32 v[114:115], v[58:59], v[182:183], v[114:115] op_sel_hi:[1,0,1]
    v_max_f32 v108, 0, v108
    v_max_f32 v109, 0, v109
    v_max_f32 v110, 0, v110
    v_max_f32 v111, 0, v111
    v_max_f32 v112, 0, v112
    v_max_f32 v113, 0, v113
    v_max_f32 v114, 0, v114
    v_max_f32 v115, 0, v115
    v_pk_mul_f32 v[108:109], v[108:109], v[108:109]
    v_pk_mul_f32 v[110:111], v[110:111], v[110:111]
    v_pk_mul_f32 v[112:113], v[112:113], v[112:113]
    v_pk_mul_f32 v[114:115], v[114:115], v[114:115]
    v_cvt_pk_bf16_f32 v120, v108, v109
    v_cvt_pk_bf16_f32 v121, v110, v111
    v_cvt_pk_bf16_f32 v122, v112, v113
    v_cvt_pk_bf16_f32 v123, v114, v115
    s_waitcnt vmcnt(4)
    buffer_store_dwordx4 v[120:123], v247, s[32:35], s92 offen sc1
    v_pk_fma_f32 v[100:101], v[196:197], v[136:137], v[220:221] op_sel_hi:[1,0,1]
    v_pk_fma_f32 v[102:103], v[198:199], v[136:137], v[222:223] op_sel_hi:[1,0,1]
    v_pk_fma_f32 v[104:105], v[200:201], v[136:137], v[224:225] op_sel_hi:[1,0,1]
    v_pk_fma_f32 v[106:107], v[202:203], v[136:137], v[226:227] op_sel_hi:[1,0,1]
    v_pk_fma_f32 v[100:101], v[44:45], v[184:185], v[100:101] op_sel_hi:[1,0,1]
    v_pk_fma_f32 v[102:103], v[46:47], v[184:185], v[102:103] op_sel_hi:[1,0,1]
    v_pk_fma_f32 v[104:105], v[60:61], v[184:185], v[104:105] op_sel_hi:[1,0,1]
    v_pk_fma_f32 v[106:107], v[62:63], v[184:185], v[106:107] op_sel_hi:[1,0,1]
    v_max_f32 v100, 0, v100
    v_max_f32 v101, 0, v101
    v_max_f32 v102, 0, v102
    v_max_f32 v103, 0, v103
    v_max_f32 v104, 0, v104
    v_max_f32 v105, 0, v105
    v_max_f32 v106, 0, v106
    v_max_f32 v107, 0, v107
    v_pk_mul_f32 v[100:101], v[100:101], v[100:101]
    v_pk_mul_f32 v[102:103], v[102:103], v[102:103]
    v_pk_mul_f32 v[104:105], v[104:105], v[104:105]
    v_pk_mul_f32 v[106:107], v[106:107], v[106:107]
    v_cvt_pk_bf16_f32 v124, v100, v101
    v_cvt_pk_bf16_f32 v125, v102, v103
    v_cvt_pk_bf16_f32 v126, v104, v105
    v_cvt_pk_bf16_f32 v127, v106, v107
    s_waitcnt vmcnt(4)
    buffer_store_dwordx4 v[124:127], v248, s[32:35], s92 offen sc1
    v_pk_fma_f32 v[108:109], v[196:197], v[138:139], v[220:221] op_sel_hi:[1,0,1]
    v_pk_fma_f32 v[110:111], v[198:199], v[138:139], v[222:223] op_sel_hi:[1,0,1]
    v_pk_fma_f32 v[112:113], v[200:201], v[138:139], v[224:225] op_sel_hi:[1,0,1]
    v_pk_fma_f32 v[114:115], v[202:203], v[138:139], v[226:227] op_sel_hi:[1,0,1]
    v_pk_fma_f32 v[108:109], v[48:49], v[186:187], v[108:109] op_sel_hi:[1,0,1]
    v_pk_fma_f32 v[110:111], v[50:51], v[186:187], v[110:111] op_sel_hi:[1,0,1]
    v_pk_fma_f32 v[112:113], v[64:65], v[186:187], v[112:113] op_sel_hi:[1,0,1]
    v_pk_fma_f32 v[114:115], v[66:67], v[186:187], v[114:115] op_sel_hi:[1,0,1]
    v_max_f32 v108, 0, v108
    v_max_f32 v109, 0, v109
    v_max_f32 v110, 0, v110
    v_max_f32 v111, 0, v111
    v_max_f32 v112, 0, v112
    v_max_f32 v113, 0, v113
    v_max_f32 v114, 0, v114
    v_max_f32 v115, 0, v115
    v_pk_mul_f32 v[108:109], v[108:109], v[108:109]
    v_pk_mul_f32 v[110:111], v[110:111], v[110:111]
    v_pk_mul_f32 v[112:113], v[112:113], v[112:113]
    v_pk_mul_f32 v[114:115], v[114:115], v[114:115]
    v_cvt_pk_bf16_f32 v128, v108, v109
    v_cvt_pk_bf16_f32 v129, v110, v111
    v_cvt_pk_bf16_f32 v130, v112, v113
    v_cvt_pk_bf16_f32 v131, v114, v115
    s_waitcnt vmcnt(4)
    buffer_store_dwordx4 v[128:131], v249, s[32:35], s92 offen sc1
    s_add_u32 s92, s92, 10240
    s_bitcmp1_b32 0xea, s27
    s_cselect_b32 s80, s85, 0
    s_cmp_eq_u32 s80, 1
    s_cbranch_scc1 L_mlp_done
    v_pk_fma_f32 v[100:101], v[204:205], v[132:133], v[228:229] op_sel_hi:[1,0,1]
    v_pk_fma_f32 v[102:103], v[206:207], v[132:133], v[230:231] op_sel_hi:[1,0,1]
    v_pk_fma_f32 v[104:105], v[208:209], v[132:133], v[232:233] op_sel_hi:[1,0,1]
    v_pk_fma_f32 v[106:107], v[210:211], v[132:133], v[234:235] op_sel_hi:[1,0,1]
    v_pk_fma_f32 v[100:101], v[68:69], v[180:181], v[100:101] op_sel_hi:[1,0,1]
    v_pk_fma_f32 v[102:103], v[70:71], v[180:181], v[102:103] op_sel_hi:[1,0,1]
    v_pk_fma_f32 v[104:105], v[84:85], v[180:181], v[104:105] op_sel_hi:[1,0,1]
    v_pk_fma_f32 v[106:107], v[86:87], v[180:181], v[106:107] op_sel_hi:[1,0,1]
    v_max_f32 v100, 0, v100
    v_max_f32 v101, 0, v101
    v_max_f32 v102, 0, v102
    v_max_f32 v103, 0, v103
    v_max_f32 v104, 0, v104
    v_max_f32 v105, 0, v105
    v_max_f32 v106, 0, v106
    v_max_f32 v107, 0, v107
    v_pk_mul_f32 v[100:101], v[100:101], v[100:101]
    v_pk_mul_f32 v[102:103], v[102:103], v[102:103]
    v_pk_mul_f32 v[104:105], v[104:105], v[104:105]
    v_pk_mul_f32 v[106:107], v[106:107], v[106:107]
    v_cvt_pk_bf16_f32 v116, v100, v101
    v_cvt_pk_bf16_f32 v117, v102, v103
    v_cvt_pk_bf16_f32 v118, v104, v105
    v_cvt_pk_bf16_f32 v119, v106, v107
    s_waitcnt vmcnt(4)
    buffer_store_dwordx4 v[116:119], v246, s[32:35], s92 offen sc1
    v_pk_fma_f32 v[108:109], v[204:205], v[134:135], v[228:229] op_sel_hi:[1,0,1]
    v_pk_fma_f32 v[110:111], v[206:207], v[134:135], v[230:231] op_sel_hi:[1,0,1]
    v_pk_fma_f32 v[112:113], v[208:209], v[134:135], v[232:233] op_sel_hi:[1,0,1]
    v_pk_fma_f32 v[114:115], v[210:211], v[134:135], v[234:235] op_sel_hi:[1,0,1]
    v_pk_fma_f32 v[108:109], v[72:73], v[182:183], v[108:109] op_sel_hi:[1,0,1]
    v_pk_fma_f32 v[110:111], v[74:75], v[182:183], v[110:111] op_sel_hi:[1,0,1]
    v_pk_fma_f32 v[112:113], v[88:89], v[182:183], v[112:113] op_sel_hi:[1,0,1]
    v_pk_fma_f32 v[114:115], v[90:91], v[182:183], v[114:115] op_sel_hi:[1,0,1]
    v_max_f32 v108, 0, v108
    v_max_f32 v109, 0, v109
    v_max_f32 v110, 0, v110
    v_max_f32 v111, 0, v111
    v_max_f32 v112, 0, v112
    v_max_f32 v113, 0, v113
    v_max_f32 v114, 0, v114
    v_max_f32 v115, 0, v115
    v_pk_mul_f32 v[108:109], v[108:109], v[108:109]
    v_pk_mul_f32 v[110:111], v[110:111], v[110:111]
    v_pk_mul_f32 v[112:113], v[112:113], v[112:113]
    v_pk_mul_f32 v[114:115], v[114:115], v[114:115]
    v_cvt_pk_bf16_f32 v120, v108, v109
    v_cvt_pk_bf16_f32 v121, v110, v111
    v_cvt_pk_bf16_f32 v122, v112, v113
    v_cvt_pk_bf16_f32 v123, v114, v115
    s_waitcnt vmcnt(4)
    buffer_store_dwordx4 v[120:123], v247, s[32:35], s92 offen sc1
    v_pk_fma_f32 v[100:101], v[204:205], v[136:137], v[228:229] op_sel_hi:[1,0,1]
    v_pk_fma_f32 v[102:103], v[206:207], v[136:137], v[230:231] op_sel_hi:[1,0,1]
    v_pk_fma_f32 v[104:105], v[208:209], v[136:137], v[232:233] op_sel_hi:[1,0,1]
    v_pk_fma_f32 v[106:107], v[210:211], v[136:137], v[234:235] op_sel_hi:[1,0,1]
    v_pk_fma_f32 v[100:101], v[76:77], v[184:185], v[100:101] op_sel_hi:[1,0,1]
    v_pk_fma_f32 v[102:103], v[78:79], v[184:185], v[102:103] op_sel_hi:[1,0,1]
    v_pk_fma_f32 v[104:105], v[92:93], v[184:185], v[104:105] op_sel_hi:[1,0,1]
    v_pk_fma_f32 v[106:107], v[94:95], v[184:185], v[106:107] op_sel_hi:[1,0,1]
    v_max_f32 v100, 0, v100
    v_max_f32 v101, 0, v101
    v_max_f32 v102, 0, v102
    v_max_f32 v103, 0, v103
    v_max_f32 v104, 0, v104
    v_max_f32 v105, 0, v105
    v_max_f32 v106, 0, v106
    v_max_f32 v107, 0, v107
    v_pk_mul_f32 v[100:101], v[100:101], v[100:101]
    v_pk_mul_f32 v[102:103], v[102:103], v[102:103]
    v_pk_mul_f32 v[104:105], v[104:105], v[104:105]
    v_pk_mul_f32 v[106:107], v[106:107], v[106:107]
    v_cvt_pk_bf16_f32 v124, v100, v101
    v_cvt_pk_bf16_f32 v125, v102, v103
    v_cvt_pk_bf16_f32 v126, v104, v105
    v_cvt_pk_bf16_f32 v127, v106, v107
    s_waitcnt vmcnt(4)
    buffer_store_dwordx4 v[124:127], v248, s[32:35], s92 offen sc1
    v_pk_fma_f32 v[108:109], v[204:205], v[138:139], v[228:229] op_sel_hi:[1,0,1]
    v_pk_fma_f32 v[110:111], v[206:207], v[138:139], v[230:231] op_sel_hi:[1,0,1]
    v_pk_fma_f32 v[112:113], v[208:209], v[138:139], v[232:233] op_sel_hi:[1,0,1]
    v_pk_fma_f32 v[114:115], v[210:211], v[138:139], v[234:235] op_sel_hi:[1,0,1]
    v_pk_fma_f32 v[108:109], v[80:81], v[186:187], v[108:109] op_sel_hi:[1,0,1]
    v_pk_fma_f32 v[110:111], v[82:83], v[186:187], v[110:111] op_sel_hi:[1,0,1]
    v_pk_fma_f32 v[112:113], v[96:97], v[186:187], v[112:113] op_sel_hi:[1,0,1]
    v_pk_fma_f32 v[114:115], v[98:99], v[186:187], v[114:115] op_sel_hi:[1,0,1]
    v_max_f32 v108, 0, v108
    v_max_f32 v109, 0, v109
    v_max_f32 v110, 0, v110
    v_max_f32 v111, 0, v111
    v_max_f32 v112, 0, v112
    v_max_f32 v113, 0, v113
    v_max_f32 v114, 0, v114
    v_max_f32 v115, 0, v115
    v_pk_mul_f32 v[108:109], v[108:109], v[108:109]
    v_pk_mul_f32 v[110:111], v[110:111], v[110:111]
    v_pk_mul_f32 v[112:113], v[112:113], v[112:113]
    v_pk_mul_f32 v[114:115], v[114:115], v[114:115]
    v_cvt_pk_bf16_f32 v128, v108, v109
    v_cvt_pk_bf16_f32 v129, v110, v111
    v_cvt_pk_bf16_f32 v130, v112, v113
    v_cvt_pk_bf16_f32 v131, v114, v115
    s_waitcnt vmcnt(4)
    buffer_store_dwordx4 v[128:131], v249, s[32:35], s92 offen sc1
    s_add_u32 s92, s92, 10240
L_mlp_done:
    ds_write_b32 v1, v2 offset:48
    v_readfirstlane_b32 s87, v3
    s_add_u32 s94, s24, s93
    s_addc_u32 s95, s25, 0
    s_waitcnt vmcnt(0)
    s_atomic_swap s87, s[94:95], 0
    s_atomic_swap s87, s[94:95], 2048
    s_atomic_swap s87, s[94:95], 4096
    s_atomic_swap s87, s[94:95], 6144
    s_waitcnt lgkmcnt(0)
    s_endpgm
    .p2align 3
    .fill 138, 4, 0xbf810000
L_attn:
    s_waitcnt lgkmcnt(0)
    s_barrier
    ds_read_b128 v[100:103], v244 offset:0
    ds_read_b64_tr_b16 v[132:133], v246 offset:0
    ds_read_b64_tr_b16 v[134:135], v246 offset:512
    ds_read_b128 v[104:107], v244 offset:2048
    ds_read_b128 v[108:111], v244 offset:4096
    ds_read_b128 v[112:115], v244 offset:6144
    ds_read_b128 v[116:119], v244 offset:8192
    ds_read_b128 v[120:123], v244 offset:10240
    ds_read_b128 v[124:127], v244 offset:12288
    ds_read_b128 v[128:131], v244 offset:14336
    ds_read_b64_tr_b16 v[136:137], v246 offset:2048
    ds_read_b64_tr_b16 v[138:139], v246 offset:2560
    ds_read_b64_tr_b16 v[140:141], v246 offset:4096
    ds_read_b64_tr_b16 v[142:143], v246 offset:4608
    s_waitcnt lgkmcnt(0)
    s_nop 0
    v_mfma_f32_16x16x32_bf16 v[4:7], v[100:103], v[132:135], 0
    ds_read_b64_tr_b16 v[188:189], v232 offset:0
    v_mfma_f32_16x16x32_bf16 v[8:11], v[104:107], v[132:135], 0
    ds_read_b64_tr_b16 v[190:191], v232 offset:512
    v_mfma_f32_16x16x32_bf16 v[12:15], v[108:111], v[132:135], 0
    ds_read_b64_tr_b16 v[192:193], v232 offset:2048
    v_mfma_f32_16x16x32_bf16 v[16:19], v[112:115], v[132:135], 0
    ds_read_b64_tr_b16 v[194:195], v232 offset:2560
    v_mfma_f32_16x16x32_bf16 v[20:23], v[116:119], v[132:135], 0
    ds_read_b64_tr_b16 v[196:197], v232 offset:4096
    v_mfma_f32_16x16x32_bf16 v[24:27], v[120:123], v[132:135], 0
    ds_read_b64_tr_b16 v[198:199], v232 offset:4608
    v_mfma_f32_16x16x32_bf16 v[28:31], v[124:127], v[132:135], 0
    ds_read_b64_tr_b16 v[200:201], v232 offset:12288
    v_mfma_f32_16x16x32_bf16 v[32:35], v[128:131], v[132:135], 0
    ds_read_b64_tr_b16 v[202:203], v232 offset:12800
    v_mfma_f32_16x16x32_bf16 v[64:67], v[128:131], v[136:139], 0
    ds_read_b64_tr_b16 v[204:205], v232 offset:14336
    v_mfma_f32_16x16x32_bf16 v[60:63], v[124:127], v[136:139], 0
    ds_read_b64_tr_b16 v[206:207], v232 offset:14848
    v_mfma_f32_16x16x32_bf16 v[56:59], v[120:123], v[136:139], 0
    ds_read_b64_tr_b16 v[208:209], v232 offset:16384
    v_mfma_f32_16x16x32_bf16 v[52:55], v[116:119], v[136:139], 0
    ds_read_b64_tr_b16 v[210:211], v232 offset:16896
    v_mfma_f32_16x16x32_bf16 v[48:51], v[112:115], v[136:139], 0
    v_mfma_f32_16x16x32_bf16 v[44:47], v[108:111], v[136:139], 0
    v_mfma_f32_16x16x32_bf16 v[40:43], v[104:107], v[136:139], 0
    v_mfma_f32_16x16x32_bf16 v[36:39], v[100:103], v[136:139], 0
    v_mfma_f32_16x16x32_bf16 v[68:71], v[140:143], v[100:103], 0
    ds_read_b128 v[144:147], v245 offset:0
    ds_read_b64_tr_b16 v[176:177], v246 offset:12288
    v_mfma_f32_16x16x32_bf16 v[72:75], v[140:143], v[104:107], 0
    ds_read_b64_tr_b16 v[178:179], v246 offset:12800
    ds_read_b128 v[148:151], v245 offset:2048
    v_mfma_f32_16x16x32_bf16 v[76:79], v[140:143], v[108:111], 0
    ds_read_b128 v[152:155], v245 offset:4096
    ds_read_b128 v[156:159], v245 offset:6144
    v_mfma_f32_16x16x32_bf16 v[80:83], v[140:143], v[112:115], 0
    ds_read_b128 v[160:163], v245 offset:8192
    v_mfma_f32_16x16x32_bf16 v[84:87], v[140:143], v[116:119], 0
    ds_read_b128 v[164:167], v245 offset:10240
    ds_read_b128 v[168:171], v245 offset:12288
    v_mfma_f32_16x16x32_bf16 v[88:91], v[140:143], v[120:123], 0
    ds_read_b128 v[172:175], v245 offset:14336
    ds_read_b64_tr_b16 v[180:181], v246 offset:14336
    v_mfma_f32_16x16x32_bf16 v[92:95], v[140:143], v[124:127], 0
    ds_read_b64_tr_b16 v[182:183], v246 offset:14848
    ds_read_b64_tr_b16 v[184:185], v246 offset:16384
    v_mfma_f32_16x16x32_bf16 v[96:99], v[140:143], v[128:131], 0
    ds_read_b64_tr_b16 v[186:187], v246 offset:16896
    s_waitcnt lgkmcnt(0)
    s_barrier
    v_mfma_f32_16x16x32_bf16 v[4:7], v[144:147], v[176:179], v[4:7]
    v_mfma_f32_16x16x32_bf16 v[212:215], v[236:239], v[188:191], 0
    v_mfma_f32_16x16x32_bf16 v[8:11], v[148:151], v[176:179], v[8:11]
    v_mfma_f32_16x16x32_bf16 v[216:219], v[236:239], v[192:195], 0
    v_mfma_f32_16x16x32_bf16 v[12:15], v[152:155], v[176:179], v[12:15]
    v_mfma_f32_16x16x32_bf16 v[220:223], v[236:239], v[196:199], 0
    v_mfma_f32_16x16x32_bf16 v[16:19], v[156:159], v[176:179], v[16:19]
    v_mfma_f32_16x16x32_bf16 v[212:215], v[236:239], v[200:203], v[212:215]
    v_mfma_f32_16x16x32_bf16 v[20:23], v[160:163], v[176:179], v[20:23]
    v_mfma_f32_16x16x32_bf16 v[216:219], v[236:239], v[204:207], v[216:219]
    v_mfma_f32_16x16x32_bf16 v[24:27], v[164:167], v[176:179], v[24:27]
    v_mfma_f32_16x16x32_bf16 v[220:223], v[236:239], v[208:211], v[220:223]
    v_mfma_f32_16x16x32_bf16 v[28:31], v[168:171], v[176:179], v[28:31]
    v_mfma_f32_16x16x32_bf16 v[32:35], v[172:175], v[176:179], v[32:35]
    v_mfma_f32_16x16x32_bf16 v[64:67], v[172:175], v[180:183], v[64:67]
    v_mfma_f32_16x16x32_bf16 v[60:63], v[168:171], v[180:183], v[60:63]
    v_mfma_f32_16x16x32_bf16 v[56:59], v[164:167], v[180:183], v[56:59]
    v_mfma_f32_16x16x32_bf16 v[52:55], v[160:163], v[180:183], v[52:55]
    v_mfma_f32_16x16x32_bf16 v[48:51], v[156:159], v[180:183], v[48:51]
    v_mfma_f32_16x16x32_bf16 v[44:47], v[152:155], v[180:183], v[44:47]
    v_mfma_f32_16x16x32_bf16 v[40:43], v[148:151], v[180:183], v[40:43]
    s_mov_b32 exec_lo, 0xffff0000
    v_mov_b32 v212, v216
    s_mov_b32 exec_lo, 0
    v_mov_b32 v212, v220
    s_mov_b32 exec_lo, -1
    s_mov_b32 exec_hi, 0xffff
    ds_write_b32 v233, v212
    s_mov_b32 exec_hi, -1
    s_nop 0
    v_mfma_f32_16x16x32_bf16 v[36:39], v[144:147], v[180:183], v[36:39]
    v_mfma_f32_16x16x32_bf16 v[68:71], v[184:187], v[144:147], v[68:71]
    ds_read_b128 v[100:103], v244 offset:16384
    ds_read_b64_tr_b16 v[132:133], v246 offset:24576
    v_mfma_f32_16x16x32_bf16 v[72:75], v[184:187], v[148:151], v[72:75]
    ds_read_b64_tr_b16 v[134:135], v246 offset:25088
    ds_read_b128 v[104:107], v244 offset:18432
    v_mfma_f32_16x16x32_bf16 v[76:79], v[184:187], v[152:155], v[76:79]
    ds_read_b128 v[108:111], v244 offset:20480
    ds_read_b128 v[112:115], v244 offset:22528
    v_mfma_f32_16x16x32_bf16 v[80:83], v[184:187], v[156:159], v[80:83]
    ds_read_b128 v[116:119], v244 offset:24576
    v_mfma_f32_16x16x32_bf16 v[84:87], v[184:187], v[160:163], v[84:87]
    ds_read_b128 v[120:123], v244 offset:26624
    ds_read_b128 v[124:127], v244 offset:28672
    v_mfma_f32_16x16x32_bf16 v[88:91], v[184:187], v[164:167], v[88:91]
    ds_read_b128 v[128:131], v244 offset:30720
    ds_read_b64_tr_b16 v[136:137], v246 offset:26624
    v_mfma_f32_16x16x32_bf16 v[92:95], v[184:187], v[168:171], v[92:95]
    ds_read_b64_tr_b16 v[138:139], v246 offset:27136
    ds_read_b64_tr_b16 v[140:141], v246 offset:28672
    v_mfma_f32_16x16x32_bf16 v[96:99], v[184:187], v[172:175], v[96:99]
    ds_read_b64_tr_b16 v[142:143], v246 offset:29184
    s_waitcnt lgkmcnt(0)
    s_nop 0
    v_mfma_f32_16x16x32_bf16 v[4:7], v[100:103], v[132:135], v[4:7]
    v_mfma_f32_16x16x32_bf16 v[8:11], v[104:107], v[132:135], v[8:11]
    v_mfma_f32_16x16x32_bf16 v[12:15], v[108:111], v[132:135], v[12:15]
    v_mfma_f32_16x16x32_bf16 v[16:19], v[112:115], v[132:135], v[16:19]
    v_mfma_f32_16x16x32_bf16 v[20:23], v[116:119], v[132:135], v[20:23]
    v_mfma_f32_16x16x32_bf16 v[24:27], v[120:123], v[132:135], v[24:27]
    v_mfma_f32_16x16x32_bf16 v[28:31], v[124:127], v[132:135], v[28:31]
    v_mfma_f32_16x16x32_bf16 v[32:35], v[128:131], v[132:135], v[32:35]
    v_mfma_f32_16x16x32_bf16 v[64:67], v[128:131], v[136:139], v[64:67]
    v_mfma_f32_16x16x32_bf16 v[60:63], v[124:127], v[136:139], v[60:63]
    v_mfma_f32_16x16x32_bf16 v[56:59], v[120:123], v[136:139], v[56:59]
    v_mfma_f32_16x16x32_bf16 v[52:55], v[116:119], v[136:139], v[52:55]
    v_mfma_f32_16x16x32_bf16 v[48:51], v[112:115], v[136:139], v[48:51]
    v_mfma_f32_16x16x32_bf16 v[44:47], v[108:111], v[136:139], v[44:47]
    v_mfma_f32_16x16x32_bf16 v[40:43], v[104:107], v[136:139], v[40:43]
    v_mfma_f32_16x16x32_bf16 v[36:39], v[100:103], v[136:139], v[36:39]
    v_mfma_f32_16x16x32_bf16 v[68:71], v[140:143], v[100:103], v[68:71]
    ds_read_b128 v[144:147], v245 offset:16384
    ds_read_b64_tr_b16 v[176:177], v246 offset:36864
    v_mfma_f32_16x16x32_bf16 v[72:75], v[140:143], v[104:107], v[72:75]
    ds_read_b64_tr_b16 v[178:179], v246 offset:37376
    ds_read_b128 v[148:151], v245 offset:18432
    v_mfma_f32_16x16x32_bf16 v[76:79], v[140:143], v[108:111], v[76:79]
    ds_read_b128 v[152:155], v245 offset:20480
    ds_read_b128 v[156:159], v245 offset:22528
    v_mfma_f32_16x16x32_bf16 v[80:83], v[140:143], v[112:115], v[80:83]
    ds_read_b128 v[160:163], v245 offset:24576
    v_mfma_f32_16x16x32_bf16 v[84:87], v[140:143], v[116:119], v[84:87]
    ds_read_b128 v[164:167], v245 offset:26624
    ds_read_b128 v[168:171], v245 offset:28672
    v_mfma_f32_16x16x32_bf16 v[88:91], v[140:143], v[120:123], v[88:91]
    ds_read_b128 v[172:175], v245 offset:30720
    ds_read_b64_tr_b16 v[180:181], v246 offset:38912
    v_mfma_f32_16x16x32_bf16 v[92:95], v[140:143], v[124:127], v[92:95]
    ds_read_b64_tr_b16 v[182:183], v246 offset:39424
    ds_read_b64_tr_b16 v[184:185], v246 offset:40960
    v_mfma_f32_16x16x32_bf16 v[96:99], v[140:143], v[128:131], v[96:99]
    ds_read_b64_tr_b16 v[186:187], v246 offset:41472
    s_waitcnt lgkmcnt(0)
    s_barrier
    v_mfma_f32_16x16x32_bf16 v[4:7], v[144:147], v[176:179], v[4:7]
    v_mfma_f32_16x16x32_bf16 v[8:11], v[148:151], v[176:179], v[8:11]
    v_mfma_f32_16x16x32_bf16 v[12:15], v[152:155], v[176:179], v[12:15]
    v_mfma_f32_16x16x32_bf16 v[16:19], v[156:159], v[176:179], v[16:19]
    v_mfma_f32_16x16x32_bf16 v[20:23], v[160:163], v[176:179], v[20:23]
    v_mfma_f32_16x16x32_bf16 v[24:27], v[164:167], v[176:179], v[24:27]
    v_mfma_f32_16x16x32_bf16 v[28:31], v[168:171], v[176:179], v[28:31]
    v_mfma_f32_16x16x32_bf16 v[32:35], v[172:175], v[176:179], v[32:35]
    v_mfma_f32_16x16x32_bf16 v[64:67], v[172:175], v[180:183], v[64:67]
    v_mfma_f32_16x16x32_bf16 v[60:63], v[168:171], v[180:183], v[60:63]
    v_mfma_f32_16x16x32_bf16 v[56:59], v[164:167], v[180:183], v[56:59]
    v_mfma_f32_16x16x32_bf16 v[52:55], v[160:163], v[180:183], v[52:55]
    v_mfma_f32_16x16x32_bf16 v[48:51], v[156:159], v[180:183], v[48:51]
    v_mfma_f32_16x16x32_bf16 v[44:47], v[152:155], v[180:183], v[44:47]
    v_mfma_f32_16x16x32_bf16 v[40:43], v[148:151], v[180:183], v[40:43]
    v_mfma_f32_16x16x32_bf16 v[36:39], v[144:147], v[180:183], v[36:39]
    v_mfma_f32_16x16x32_bf16 v[68:71], v[184:187], v[144:147], v[68:71]
    ds_read_b128 v[100:103], v244 offset:32768
    ds_read_b64_tr_b16 v[132:133], v248 offset:0
    v_mfma_f32_16x16x32_bf16 v[72:75], v[184:187], v[148:151], v[72:75]
    ds_read_b64_tr_b16 v[134:135], v248 offset:512
    ds_read_b128 v[104:107], v244 offset:34816
    v_mfma_f32_16x16x32_bf16 v[76:79], v[184:187], v[152:155], v[76:79]
    ds_read_b128 v[108:111], v244 offset:36864
    ds_read_b128 v[112:115], v244 offset:38912
    v_mfma_f32_16x16x32_bf16 v[80:83], v[184:187], v[156:159], v[80:83]
    ds_read_b128 v[116:119], v244 offset:40960
    v_mfma_f32_16x16x32_bf16 v[84:87], v[184:187], v[160:163], v[84:87]
    ds_read_b128 v[120:123], v244 offset:43008
    ds_read_b128 v[124:127], v244 offset:45056
    v_mfma_f32_16x16x32_bf16 v[88:91], v[184:187], v[164:167], v[88:91]
    ds_read_b128 v[128:131], v244 offset:47104
    ds_read_b64_tr_b16 v[136:137], v248 offset:2048
    v_mfma_f32_16x16x32_bf16 v[92:95], v[184:187], v[168:171], v[92:95]
    ds_read_b64_tr_b16 v[138:139], v248 offset:2560
    ds_read_b64_tr_b16 v[140:141], v248 offset:4096
    v_mfma_f32_16x16x32_bf16 v[96:99], v[184:187], v[172:175], v[96:99]
    ds_read_b64_tr_b16 v[142:143], v248 offset:4608
    s_waitcnt lgkmcnt(0) vmcnt(0)
    s_nop 0
    v_mfma_f32_16x16x32_bf16 v[4:7], v[100:103], v[132:135], v[4:7]
    v_mfma_f32_16x16x32_bf16 v[8:11], v[104:107], v[132:135], v[8:11]
    v_mfma_f32_16x16x32_bf16 v[12:15], v[108:111], v[132:135], v[12:15]
    v_mfma_f32_16x16x32_bf16 v[16:19], v[112:115], v[132:135], v[16:19]
    v_mfma_f32_16x16x32_bf16 v[20:23], v[116:119], v[132:135], v[20:23]
    v_mfma_f32_16x16x32_bf16 v[24:27], v[120:123], v[132:135], v[24:27]
    v_mfma_f32_16x16x32_bf16 v[28:31], v[124:127], v[132:135], v[28:31]
    v_mfma_f32_16x16x32_bf16 v[32:35], v[128:131], v[132:135], v[32:35]
    v_mfma_f32_16x16x32_bf16 v[64:67], v[128:131], v[136:139], v[64:67]
    v_mfma_f32_16x16x32_bf16 v[60:63], v[124:127], v[136:139], v[60:63]
    v_mfma_f32_16x16x32_bf16 v[56:59], v[120:123], v[136:139], v[56:59]
    v_mfma_f32_16x16x32_bf16 v[52:55], v[116:119], v[136:139], v[52:55]
    v_mfma_f32_16x16x32_bf16 v[48:51], v[112:115], v[136:139], v[48:51]
    v_mfma_f32_16x16x32_bf16 v[44:47], v[108:111], v[136:139], v[44:47]
    v_mfma_f32_16x16x32_bf16 v[40:43], v[104:107], v[136:139], v[40:43]
    v_mfma_f32_16x16x32_bf16 v[36:39], v[100:103], v[136:139], v[36:39]
    v_mfma_f32_16x16x32_bf16 v[68:71], v[140:143], v[100:103], v[68:71]
    ds_read_b128 v[144:147], v245 offset:32768
    ds_read_b64_tr_b16 v[176:177], v248 offset:12288
    v_mfma_f32_16x16x32_bf16 v[72:75], v[140:143], v[104:107], v[72:75]
    ds_read_b64_tr_b16 v[178:179], v248 offset:12800
    ds_read_b128 v[148:151], v245 offset:34816
    v_mfma_f32_16x16x32_bf16 v[76:79], v[140:143], v[108:111], v[76:79]
    ds_read_b128 v[152:155], v245 offset:36864
    ds_read_b128 v[156:159], v245 offset:38912
    v_mfma_f32_16x16x32_bf16 v[80:83], v[140:143], v[112:115], v[80:83]
    ds_read_b128 v[160:163], v245 offset:40960
    v_mfma_f32_16x16x32_bf16 v[84:87], v[140:143], v[116:119], v[84:87]
    ds_read_b128 v[164:167], v245 offset:43008
    ds_read_b128 v[168:171], v245 offset:45056
    v_mfma_f32_16x16x32_bf16 v[88:91], v[140:143], v[120:123], v[88:91]
    ds_read_b128 v[172:175], v245 offset:47104
    ds_read_b64_tr_b16 v[180:181], v248 offset:14336
    v_mfma_f32_16x16x32_bf16 v[92:95], v[140:143], v[124:127], v[92:95]
    ds_read_b64_tr_b16 v[182:183], v248 offset:14848
    ds_read_b64_tr_b16 v[184:185], v248 offset:16384
    v_mfma_f32_16x16x32_bf16 v[96:99], v[140:143], v[128:131], v[96:99]
    ds_read_b64_tr_b16 v[186:187], v248 offset:16896
    s_waitcnt lgkmcnt(0)
    s_barrier
    v_mfma_f32_16x16x32_bf16 v[4:7], v[144:147], v[176:179], v[4:7]
    v_mfma_f32_16x16x32_bf16 v[8:11], v[148:151], v[176:179], v[8:11]
    v_mfma_f32_16x16x32_bf16 v[12:15], v[152:155], v[176:179], v[12:15]
    v_mfma_f32_16x16x32_bf16 v[16:19], v[156:159], v[176:179], v[16:19]
    v_mfma_f32_16x16x32_bf16 v[20:23], v[160:163], v[176:179], v[20:23]
    v_mfma_f32_16x16x32_bf16 v[24:27], v[164:167], v[176:179], v[24:27]
    v_mfma_f32_16x16x32_bf16 v[28:31], v[168:171], v[176:179], v[28:31]
    v_mfma_f32_16x16x32_bf16 v[32:35], v[172:175], v[176:179], v[32:35]
    v_mfma_f32_16x16x32_bf16 v[64:67], v[172:175], v[180:183], v[64:67]
    v_mfma_f32_16x16x32_bf16 v[60:63], v[168:171], v[180:183], v[60:63]
    v_mfma_f32_16x16x32_bf16 v[56:59], v[164:167], v[180:183], v[56:59]
    v_mfma_f32_16x16x32_bf16 v[52:55], v[160:163], v[180:183], v[52:55]
    v_mfma_f32_16x16x32_bf16 v[48:51], v[156:159], v[180:183], v[48:51]
    v_mfma_f32_16x16x32_bf16 v[44:47], v[152:155], v[180:183], v[44:47]
    v_mfma_f32_16x16x32_bf16 v[40:43], v[148:151], v[180:183], v[40:43]
    v_mfma_f32_16x16x32_bf16 v[36:39], v[144:147], v[180:183], v[36:39]
    v_mfma_f32_16x16x32_bf16 v[68:71], v[184:187], v[144:147], v[68:71]
    ds_read_b128 v[100:103], v244 offset:0
    ds_read_b64_tr_b16 v[132:133], v246 offset:0
    v_mfma_f32_16x16x32_bf16 v[72:75], v[184:187], v[148:151], v[72:75]
    ds_read_b64_tr_b16 v[134:135], v246 offset:512
    ds_read_b128 v[104:107], v244 offset:2048
    v_mfma_f32_16x16x32_bf16 v[76:79], v[184:187], v[152:155], v[76:79]
    ds_read_b128 v[108:111], v244 offset:4096
    ds_read_b128 v[112:115], v244 offset:6144
    v_mfma_f32_16x16x32_bf16 v[80:83], v[184:187], v[156:159], v[80:83]
    ds_read_b128 v[116:119], v244 offset:8192
    v_mfma_f32_16x16x32_bf16 v[84:87], v[184:187], v[160:163], v[84:87]
    ds_read_b128 v[120:123], v244 offset:10240
    ds_read_b128 v[124:127], v244 offset:12288
    v_mfma_f32_16x16x32_bf16 v[88:91], v[184:187], v[164:167], v[88:91]
    ds_read_b128 v[128:131], v244 offset:14336
    ds_read_b64_tr_b16 v[136:137], v246 offset:2048
    v_mfma_f32_16x16x32_bf16 v[92:95], v[184:187], v[168:171], v[92:95]
    ds_read_b64_tr_b16 v[138:139], v246 offset:2560
    ds_read_b64_tr_b16 v[140:141], v246 offset:4096
    v_mfma_f32_16x16x32_bf16 v[96:99], v[184:187], v[172:175], v[96:99]
    ds_read_b64_tr_b16 v[142:143], v246 offset:4608
    s_waitcnt lgkmcnt(0)
    s_nop 0
    v_mfma_f32_16x16x32_bf16 v[4:7], v[100:103], v[132:135], v[4:7]
    ds_read_b128 v[144:147], v245 offset:0
    v_mfma_f32_16x16x32_bf16 v[8:11], v[104:107], v[132:135], v[8:11]
    ds_read_b64_tr_b16 v[176:177], v246 offset:12288
    v_mfma_f32_16x16x32_bf16 v[12:15], v[108:111], v[132:135], v[12:15]
    ds_read_b64_tr_b16 v[178:179], v246 offset:12800
    v_mfma_f32_16x16x32_bf16 v[16:19], v[112:115], v[132:135], v[16:19]
    ds_read_b128 v[148:151], v245 offset:2048
    v_mfma_f32_16x16x32_bf16 v[20:23], v[116:119], v[132:135], v[20:23]
    ds_read_b128 v[152:155], v245 offset:4096
    v_mfma_f32_16x16x32_bf16 v[24:27], v[120:123], v[132:135], v[24:27]
    ds_read_b128 v[156:159], v245 offset:6144
    v_mfma_f32_16x16x32_bf16 v[28:31], v[124:127], v[132:135], v[28:31]
    ds_read_b128 v[160:163], v245 offset:8192
    v_mfma_f32_16x16x32_bf16 v[32:35], v[128:131], v[132:135], v[32:35]
    v_mfma_f32_16x16x32_bf16 v[64:67], v[128:131], v[136:139], v[64:67]
    ds_read_b128 v[164:167], v245 offset:10240
    v_mfma_f32_16x16x32_bf16 v[60:63], v[124:127], v[136:139], v[60:63]
    ds_read_b128 v[168:171], v245 offset:12288
    v_mfma_f32_16x16x32_bf16 v[56:59], v[120:123], v[136:139], v[56:59]
    ds_read_b128 v[172:175], v245 offset:14336
    v_mfma_f32_16x16x32_bf16 v[52:55], v[116:119], v[136:139], v[52:55]
    ds_read_b64_tr_b16 v[180:181], v246 offset:14336
    v_mfma_f32_16x16x32_bf16 v[48:51], v[112:115], v[136:139], v[48:51]
    ds_read_b64_tr_b16 v[182:183], v246 offset:14848
    v_mfma_f32_16x16x32_bf16 v[44:47], v[108:111], v[136:139], v[44:47]
    ds_read_b64_tr_b16 v[184:185], v246 offset:16384
    v_mfma_f32_16x16x32_bf16 v[40:43], v[104:107], v[136:139], v[40:43]
    ds_read_b64_tr_b16 v[186:187], v246 offset:16896
    v_mfma_f32_16x16x32_bf16 v[36:39], v[100:103], v[136:139], v[36:39]
    v_mfma_f32_16x16x32_bf16 v[68:71], v[140:143], v[100:103], v[68:71]
    v_mfma_f32_16x16x32_bf16 v[72:75], v[140:143], v[104:107], v[72:75]
    v_mfma_f32_16x16x32_bf16 v[76:79], v[140:143], v[108:111], v[76:79]
    v_mfma_f32_16x16x32_bf16 v[80:83], v[140:143], v[112:115], v[80:83]
    v_mfma_f32_16x16x32_bf16 v[84:87], v[140:143], v[116:119], v[84:87]
    v_mfma_f32_16x16x32_bf16 v[88:91], v[140:143], v[120:123], v[88:91]
    v_mfma_f32_16x16x32_bf16 v[92:95], v[140:143], v[124:127], v[92:95]
    v_mfma_f32_16x16x32_bf16 v[96:99], v[140:143], v[128:131], v[96:99]
    s_waitcnt lgkmcnt(0)
    s_barrier
    v_mfma_f32_16x16x32_bf16 v[4:7], v[144:147], v[176:179], v[4:7]
    ds_read_b128 v[100:103], v244 offset:16384
    v_mfma_f32_16x16x32_bf16 v[8:11], v[148:151], v[176:179], v[8:11]
    ds_read_b64_tr_b16 v[132:133], v246 offset:24576
    v_mfma_f32_16x16x32_bf16 v[12:15], v[152:155], v[176:179], v[12:15]
    ds_read_b64_tr_b16 v[134:135], v246 offset:25088
    v_mfma_f32_16x16x32_bf16 v[16:19], v[156:159], v[176:179], v[16:19]
    ds_read_b128 v[104:107], v244 offset:18432
    v_mfma_f32_16x16x32_bf16 v[20:23], v[160:163], v[176:179], v[20:23]
    ds_read_b128 v[108:111], v244 offset:20480
    v_mfma_f32_16x16x32_bf16 v[24:27], v[164:167], v[176:179], v[24:27]
    ds_read_b128 v[112:115], v244 offset:22528
    v_mfma_f32_16x16x32_bf16 v[28:31], v[168:171], v[176:179], v[28:31]
    ds_read_b128 v[116:119], v244 offset:24576
    v_mfma_f32_16x16x32_bf16 v[32:35], v[172:175], v[176:179], v[32:35]
    v_mfma_f32_16x16x32_bf16 v[64:67], v[172:175], v[180:183], v[64:67]
    ds_read_b128 v[120:123], v244 offset:26624
    v_mfma_f32_16x16x32_bf16 v[60:63], v[168:171], v[180:183], v[60:63]
    ds_read_b128 v[124:127], v244 offset:28672
    v_mfma_f32_16x16x32_bf16 v[56:59], v[164:167], v[180:183], v[56:59]
    ds_read_b128 v[128:131], v244 offset:30720
    v_mfma_f32_16x16x32_bf16 v[52:55], v[160:163], v[180:183], v[52:55]
    ds_read_b64_tr_b16 v[136:137], v246 offset:26624
    v_mfma_f32_16x16x32_bf16 v[48:51], v[156:159], v[180:183], v[48:51]
    ds_read_b64_tr_b16 v[138:139], v246 offset:27136
    v_mfma_f32_16x16x32_bf16 v[44:47], v[152:155], v[180:183], v[44:47]
    ds_read_b64_tr_b16 v[140:141], v246 offset:28672
    v_mfma_f32_16x16x32_bf16 v[40:43], v[148:151], v[180:183], v[40:43]
    ds_read_b64_tr_b16 v[142:143], v246 offset:29184
    v_mfma_f32_16x16x32_bf16 v[36:39], v[144:147], v[180:183], v[36:39]
    v_mfma_f32_16x16x32_bf16 v[68:71], v[184:187], v[144:147], v[68:71]
    v_mfma_f32_16x16x32_bf16 v[72:75], v[184:187], v[148:151], v[72:75]
    v_mfma_f32_16x16x32_bf16 v[76:79], v[184:187], v[152:155], v[76:79]
    v_mfma_f32_16x16x32_bf16 v[80:83], v[184:187], v[156:159], v[80:83]
    v_mfma_f32_16x16x32_bf16 v[84:87], v[184:187], v[160:163], v[84:87]
    v_mfma_f32_16x16x32_bf16 v[88:91], v[184:187], v[164:167], v[88:91]
    v_mfma_f32_16x16x32_bf16 v[92:95], v[184:187], v[168:171], v[92:95]
    v_mfma_f32_16x16x32_bf16 v[96:99], v[184:187], v[172:175], v[96:99]
    s_waitcnt lgkmcnt(0)
    s_nop 0
    v_mfma_f32_16x16x32_bf16 v[4:7], v[100:103], v[132:135], v[4:7]
    ds_read_b128 v[144:147], v245 offset:16384
    v_mfma_f32_16x16x32_bf16 v[8:11], v[104:107], v[132:135], v[8:11]
    ds_read_b64_tr_b16 v[176:177], v246 offset:36864
    v_mfma_f32_16x16x32_bf16 v[12:15], v[108:111], v[132:135], v[12:15]
    ds_read_b64_tr_b16 v[178:179], v246 offset:37376
    v_mfma_f32_16x16x32_bf16 v[16:19], v[112:115], v[132:135], v[16:19]
    ds_read_b128 v[148:151], v245 offset:18432
    v_mfma_f32_16x16x32_bf16 v[20:23], v[116:119], v[132:135], v[20:23]
    ds_read_b128 v[152:155], v245 offset:20480
    v_mfma_f32_16x16x32_bf16 v[24:27], v[120:123], v[132:135], v[24:27]
    ds_read_b128 v[156:159], v245 offset:22528
    v_mfma_f32_16x16x32_bf16 v[28:31], v[124:127], v[132:135], v[28:31]
    ds_read_b128 v[160:163], v245 offset:24576
    v_mfma_f32_16x16x32_bf16 v[32:35], v[128:131], v[132:135], v[32:35]
    v_mfma_f32_16x16x32_bf16 v[64:67], v[128:131], v[136:139], v[64:67]
    ds_read_b128 v[164:167], v245 offset:26624
    v_mfma_f32_16x16x32_bf16 v[60:63], v[124:127], v[136:139], v[60:63]
    ds_read_b128 v[168:171], v245 offset:28672
    v_mfma_f32_16x16x32_bf16 v[56:59], v[120:123], v[136:139], v[56:59]
    ds_read_b128 v[172:175], v245 offset:30720
    v_mfma_f32_16x16x32_bf16 v[52:55], v[116:119], v[136:139], v[52:55]
    ds_read_b64_tr_b16 v[180:181], v246 offset:38912
    v_mfma_f32_16x16x32_bf16 v[48:51], v[112:115], v[136:139], v[48:51]
    ds_read_b64_tr_b16 v[182:183], v246 offset:39424
    v_mfma_f32_16x16x32_bf16 v[44:47], v[108:111], v[136:139], v[44:47]
    ds_read_b64_tr_b16 v[184:185], v246 offset:40960
    v_mfma_f32_16x16x32_bf16 v[40:43], v[104:107], v[136:139], v[40:43]
    ds_read_b64_tr_b16 v[186:187], v246 offset:41472
    v_mfma_f32_16x16x32_bf16 v[36:39], v[100:103], v[136:139], v[36:39]
    v_mfma_f32_16x16x32_bf16 v[68:71], v[140:143], v[100:103], v[68:71]
    v_mfma_f32_16x16x32_bf16 v[72:75], v[140:143], v[104:107], v[72:75]
    v_mfma_f32_16x16x32_bf16 v[76:79], v[140:143], v[108:111], v[76:79]
    v_mfma_f32_16x16x32_bf16 v[80:83], v[140:143], v[112:115], v[80:83]
    v_mfma_f32_16x16x32_bf16 v[84:87], v[140:143], v[116:119], v[84:87]
    v_mfma_f32_16x16x32_bf16 v[88:91], v[140:143], v[120:123], v[88:91]
    v_mfma_f32_16x16x32_bf16 v[92:95], v[140:143], v[124:127], v[92:95]
    v_mfma_f32_16x16x32_bf16 v[96:99], v[140:143], v[128:131], v[96:99]
    s_waitcnt lgkmcnt(0)
    s_barrier
    v_mfma_f32_16x16x32_bf16 v[4:7], v[144:147], v[176:179], v[4:7]
    ds_read_b128 v[100:103], v244 offset:32768
    v_mfma_f32_16x16x32_bf16 v[8:11], v[148:151], v[176:179], v[8:11]
    ds_read_b64_tr_b16 v[132:133], v248 offset:0
    v_mfma_f32_16x16x32_bf16 v[12:15], v[152:155], v[176:179], v[12:15]
    ds_read_b64_tr_b16 v[134:135], v248 offset:512
    v_mfma_f32_16x16x32_bf16 v[16:19], v[156:159], v[176:179], v[16:19]
    ds_read_b128 v[104:107], v244 offset:34816
    v_mfma_f32_16x16x32_bf16 v[20:23], v[160:163], v[176:179], v[20:23]
    ds_read_b128 v[108:111], v244 offset:36864
    v_mfma_f32_16x16x32_bf16 v[24:27], v[164:167], v[176:179], v[24:27]
    ds_read_b128 v[112:115], v244 offset:38912
    v_mfma_f32_16x16x32_bf16 v[28:31], v[168:171], v[176:179], v[28:31]
    ds_read_b128 v[116:119], v244 offset:40960
    v_mfma_f32_16x16x32_bf16 v[32:35], v[172:175], v[176:179], v[32:35]
    v_mfma_f32_16x16x32_bf16 v[64:67], v[172:175], v[180:183], v[64:67]
    ds_read_b128 v[120:123], v244 offset:43008
    v_mfma_f32_16x16x32_bf16 v[60:63], v[168:171], v[180:183], v[60:63]
    ds_read_b128 v[124:127], v244 offset:45056
    v_mfma_f32_16x16x32_bf16 v[56:59], v[164:167], v[180:183], v[56:59]
    ds_read_b128 v[128:131], v244 offset:47104
    v_mfma_f32_16x16x32_bf16 v[52:55], v[160:163], v[180:183], v[52:55]
    ds_read_b64_tr_b16 v[136:137], v248 offset:2048
    v_mfma_f32_16x16x32_bf16 v[48:51], v[156:159], v[180:183], v[48:51]
    ds_read_b64_tr_b16 v[138:139], v248 offset:2560
    v_mfma_f32_16x16x32_bf16 v[44:47], v[152:155], v[180:183], v[44:47]
    ds_read_b64_tr_b16 v[140:141], v248 offset:4096
    v_mfma_f32_16x16x32_bf16 v[40:43], v[148:151], v[180:183], v[40:43]
    ds_read_b64_tr_b16 v[142:143], v248 offset:4608
    v_mfma_f32_16x16x32_bf16 v[36:39], v[144:147], v[180:183], v[36:39]
    v_mfma_f32_16x16x32_bf16 v[68:71], v[184:187], v[144:147], v[68:71]
    v_mfma_f32_16x16x32_bf16 v[72:75], v[184:187], v[148:151], v[72:75]
    v_mfma_f32_16x16x32_bf16 v[76:79], v[184:187], v[152:155], v[76:79]
    v_mfma_f32_16x16x32_bf16 v[80:83], v[184:187], v[156:159], v[80:83]
    v_mfma_f32_16x16x32_bf16 v[84:87], v[184:187], v[160:163], v[84:87]
    v_mfma_f32_16x16x32_bf16 v[88:91], v[184:187], v[164:167], v[88:91]
    v_mfma_f32_16x16x32_bf16 v[92:95], v[184:187], v[168:171], v[92:95]
    v_mfma_f32_16x16x32_bf16 v[96:99], v[184:187], v[172:175], v[96:99]
    s_waitcnt lgkmcnt(0)
    s_nop 0
    v_mfma_f32_16x16x32_bf16 v[4:7], v[100:103], v[132:135], v[4:7]
    ds_read_b128 v[144:147], v245 offset:32768
    v_mfma_f32_16x16x32_bf16 v[8:11], v[104:107], v[132:135], v[8:11]
    ds_read_b64_tr_b16 v[176:177], v248 offset:12288
    v_mfma_f32_16x16x32_bf16 v[12:15], v[108:111], v[132:135], v[12:15]
    ds_read_b64_tr_b16 v[178:179], v248 offset:12800
    v_mfma_f32_16x16x32_bf16 v[16:19], v[112:115], v[132:135], v[16:19]
    ds_read_b128 v[148:151], v245 offset:34816
    v_mfma_f32_16x16x32_bf16 v[20:23], v[116:119], v[132:135], v[20:23]
    ds_read_b128 v[152:155], v245 offset:36864
    v_mfma_f32_16x16x32_bf16 v[24:27], v[120:123], v[132:135], v[24:27]
    ds_read_b128 v[156:159], v245 offset:38912
    v_mfma_f32_16x16x32_bf16 v[28:31], v[124:127], v[132:135], v[28:31]
    ds_read_b128 v[160:163], v245 offset:40960
    v_mfma_f32_16x16x32_bf16 v[32:35], v[128:131], v[132:135], v[32:35]
    v_mfma_f32_16x16x32_bf16 v[64:67], v[128:131], v[136:139], v[64:67]
    ds_read_b128 v[164:167], v245 offset:43008
    v_mfma_f32_16x16x32_bf16 v[60:63], v[124:127], v[136:139], v[60:63]
    ds_read_b128 v[168:171], v245 offset:45056
    v_mfma_f32_16x16x32_bf16 v[56:59], v[120:123], v[136:139], v[56:59]
    ds_read_b128 v[172:175], v245 offset:47104
    v_mfma_f32_16x16x32_bf16 v[52:55], v[116:119], v[136:139], v[52:55]
    ds_read_b64_tr_b16 v[180:181], v248 offset:14336
    v_mfma_f32_16x16x32_bf16 v[48:51], v[112:115], v[136:139], v[48:51]
    ds_read_b64_tr_b16 v[182:183], v248 offset:14848
    v_mfma_f32_16x16x32_bf16 v[44:47], v[108:111], v[136:139], v[44:47]
    ds_read_b64_tr_b16 v[184:185], v248 offset:16384
    v_mfma_f32_16x16x32_bf16 v[40:43], v[104:107], v[136:139], v[40:43]
    ds_read_b64_tr_b16 v[186:187], v248 offset:16896
    v_mfma_f32_16x16x32_bf16 v[36:39], v[100:103], v[136:139], v[36:39]
    v_mfma_f32_16x16x32_bf16 v[68:71], v[140:143], v[100:103], v[68:71]
    v_mfma_f32_16x16x32_bf16 v[72:75], v[140:143], v[104:107], v[72:75]
    v_mfma_f32_16x16x32_bf16 v[76:79], v[140:143], v[108:111], v[76:79]
    v_mfma_f32_16x16x32_bf16 v[80:83], v[140:143], v[112:115], v[80:83]
    v_mfma_f32_16x16x32_bf16 v[84:87], v[140:143], v[116:119], v[84:87]
    v_mfma_f32_16x16x32_bf16 v[88:91], v[140:143], v[120:123], v[88:91]
    v_mfma_f32_16x16x32_bf16 v[92:95], v[140:143], v[124:127], v[92:95]
    v_mfma_f32_16x16x32_bf16 v[96:99], v[140:143], v[128:131], v[96:99]
    s_waitcnt lgkmcnt(0)
L_anchor_ca:
    s_barrier
    v_mfma_f32_16x16x32_bf16 v[4:7], v[144:147], v[176:179], v[4:7]
    ds_read_b128 v[100:103], v244 offset:0
    v_mfma_f32_16x16x32_bf16 v[8:11], v[148:151], v[176:179], v[8:11]
    ds_read_b64_tr_b16 v[132:133], v246 offset:0
    v_mfma_f32_16x16x32_bf16 v[12:15], v[152:155], v[176:179], v[12:15]
    ds_read_b64_tr_b16 v[134:135], v246 offset:512
    v_mfma_f32_16x16x32_bf16 v[16:19], v[156:159], v[176:179], v[16:19]
    ds_read_b128 v[104:107], v244 offset:2048
    v_mfma_f32_16x16x32_bf16 v[20:23], v[160:163], v[176:179], v[20:23]
    ds_read_b128 v[108:111], v244 offset:4096
    v_mfma_f32_16x16x32_bf16 v[24:27], v[164:167], v[176:179], v[24:27]
    ds_read_b128 v[112:115], v244 offset:6144
    v_mfma_f32_16x16x32_bf16 v[28:31], v[168:171], v[176:179], v[28:31]
    ds_read_b128 v[116:119], v244 offset:8192
    v_mfma_f32_16x16x32_bf16 v[32:35], v[172:175], v[176:179], v[32:35]
    v_mfma_f32_16x16x32_bf16 v[64:67], v[172:175], v[180:183], v[64:67]
    ds_read_b128 v[120:123], v244 offset:10240
    v_mfma_f32_16x16x32_bf16 v[60:63], v[168:171], v[180:183], v[60:63]
    ds_read_b128 v[124:127], v244 offset:12288
    v_mfma_f32_16x16x32_bf16 v[56:59], v[164:167], v[180:183], v[56:59]
    ds_read_b128 v[128:131], v244 offset:14336
    v_mfma_f32_16x16x32_bf16 v[52:55], v[160:163], v[180:183], v[52:55]
    ds_read_b64_tr_b16 v[136:137], v246 offset:2048
    v_mfma_f32_16x16x32_bf16 v[48:51], v[156:159], v[180:183], v[48:51]
    ds_read_b64_tr_b16 v[138:139], v246 offset:2560
    v_mfma_f32_16x16x32_bf16 v[44:47], v[152:155], v[180:183], v[44:47]
    ds_read_b64_tr_b16 v[140:141], v246 offset:4096
    v_mfma_f32_16x16x32_bf16 v[40:43], v[148:151], v[180:183], v[40:43]
    ds_read_b64_tr_b16 v[142:143], v246 offset:4608
    v_mfma_f32_16x16x32_bf16 v[36:39], v[144:147], v[180:183], v[36:39]
    v_mfma_f32_16x16x32_bf16 v[68:71], v[184:187], v[144:147], v[68:71]
    v_mfma_f32_16x16x32_bf16 v[72:75], v[184:187], v[148:151], v[72:75]
    v_mfma_f32_16x16x32_bf16 v[76:79], v[184:187], v[152:155], v[76:79]
    v_mfma_f32_16x16x32_bf16 v[80:83], v[184:187], v[156:159], v[80:83]
    v_mfma_f32_16x16x32_bf16 v[84:87], v[184:187], v[160:163], v[84:87]
    v_mfma_f32_16x16x32_bf16 v[88:91], v[184:187], v[164:167], v[88:91]
    v_mfma_f32_16x16x32_bf16 v[92:95], v[184:187], v[168:171], v[92:95]
    v_mfma_f32_16x16x32_bf16 v[96:99], v[184:187], v[172:175], v[96:99]
    s_waitcnt lgkmcnt(0)
    s_nop 0
    v_mfma_f32_16x16x32_bf16 v[4:7], v[100:103], v[132:135], v[4:7]
    ds_read_b128 v[144:147], v245 offset:0
    v_mfma_f32_16x16x32_bf16 v[8:11], v[104:107], v[132:135], v[8:11]
    ds_read_b64_tr_b16 v[176:177], v246 offset:12288
    v_mfma_f32_16x16x32_bf16 v[12:15], v[108:111], v[132:135], v[12:15]
    ds_read_b64_tr_b16 v[178:179], v246 offset:12800
    v_mfma_f32_16x16x32_bf16 v[16:19], v[112:115], v[132:135], v[16:19]
    ds_read_b128 v[148:151], v245 offset:2048
    v_mfma_f32_16x16x32_bf16 v[20:23], v[116:119], v[132:135], v[20:23]
    ds_read_b128 v[152:155], v245 offset:4096
    v_mfma_f32_16x16x32_bf16 v[24:27], v[120:123], v[132:135], v[24:27]
    ds_read_b128 v[156:159], v245 offset:6144
    v_mfma_f32_16x16x32_bf16 v[28:31], v[124:127], v[132:135], v[28:31]
    ds_read_b128 v[160:163], v245 offset:8192
    v_mfma_f32_16x16x32_bf16 v[32:35], v[128:131], v[132:135], v[32:35]
    v_mfma_f32_16x16x32_bf16 v[64:67], v[128:131], v[136:139], v[64:67]
    ds_read_b128 v[164:167], v245 offset:10240
    v_mfma_f32_16x16x32_bf16 v[60:63], v[124:127], v[136:139], v[60:63]
    ds_read_b128 v[168:171], v245 offset:12288
    v_mfma_f32_16x16x32_bf16 v[56:59], v[120:123], v[136:139], v[56:59]
    ds_read_b128 v[172:175], v245 offset:14336
    v_mfma_f32_16x16x32_bf16 v[52:55], v[116:119], v[136:139], v[52:55]
    ds_read_b64_tr_b16 v[180:181], v246 offset:14336
    v_mfma_f32_16x16x32_bf16 v[48:51], v[112:115], v[136:139], v[48:51]
    ds_read_b64_tr_b16 v[182:183], v246 offset:14848
    v_mfma_f32_16x16x32_bf16 v[44:47], v[108:111], v[136:139], v[44:47]
    ds_read_b64_tr_b16 v[184:185], v246 offset:16384
    v_mfma_f32_16x16x32_bf16 v[40:43], v[104:107], v[136:139], v[40:43]
    ds_read_b64_tr_b16 v[186:187], v246 offset:16896
    v_mfma_f32_16x16x32_bf16 v[36:39], v[100:103], v[136:139], v[36:39]
    v_mfma_f32_16x16x32_bf16 v[68:71], v[140:143], v[100:103], v[68:71]
    v_mfma_f32_16x16x32_bf16 v[72:75], v[140:143], v[104:107], v[72:75]
    v_mfma_f32_16x16x32_bf16 v[76:79], v[140:143], v[108:111], v[76:79]
    v_mfma_f32_16x16x32_bf16 v[80:83], v[140:143], v[112:115], v[80:83]
    v_mfma_f32_16x16x32_bf16 v[84:87], v[140:143], v[116:119], v[84:87]
    v_mfma_f32_16x16x32_bf16 v[88:91], v[140:143], v[120:123], v[88:91]
    v_mfma_f32_16x16x32_bf16 v[92:95], v[140:143], v[124:127], v[92:95]
    v_mfma_f32_16x16x32_bf16 v[96:99], v[140:143], v[128:131], v[96:99]
    s_waitcnt lgkmcnt(0)
    s_barrier
    v_mfma_f32_16x16x32_bf16 v[4:7], v[144:147], v[176:179], v[4:7]
    ds_read_b128 v[100:103], v244 offset:16384
    v_mfma_f32_16x16x32_bf16 v[8:11], v[148:151], v[176:179], v[8:11]
    ds_read_b64_tr_b16 v[132:133], v246 offset:24576
    v_mfma_f32_16x16x32_bf16 v[12:15], v[152:155], v[176:179], v[12:15]
    ds_read_b64_tr_b16 v[134:135], v246 offset:25088
    v_mfma_f32_16x16x32_bf16 v[16:19], v[156:159], v[176:179], v[16:19]
    ds_read_b128 v[104:107], v244 offset:18432
    v_mfma_f32_16x16x32_bf16 v[20:23], v[160:163], v[176:179], v[20:23]
    ds_read_b128 v[108:111], v244 offset:20480
    v_mfma_f32_16x16x32_bf16 v[24:27], v[164:167], v[176:179], v[24:27]
    ds_read_b128 v[112:115], v244 offset:22528
    v_mfma_f32_16x16x32_bf16 v[28:31], v[168:171], v[176:179], v[28:31]
    ds_read_b128 v[116:119], v244 offset:24576
    v_mfma_f32_16x16x32_bf16 v[32:35], v[172:175], v[176:179], v[32:35]
    v_mfma_f32_16x16x32_bf16 v[64:67], v[172:175], v[180:183], v[64:67]
    ds_read_b128 v[120:123], v244 offset:26624
    v_mfma_f32_16x16x32_bf16 v[60:63], v[168:171], v[180:183], v[60:63]
    ds_read_b128 v[124:127], v244 offset:28672
    v_mfma_f32_16x16x32_bf16 v[56:59], v[164:167], v[180:183], v[56:59]
    ds_read_b128 v[128:131], v244 offset:30720
    v_mfma_f32_16x16x32_bf16 v[52:55], v[160:163], v[180:183], v[52:55]
    ds_read_b64_tr_b16 v[136:137], v246 offset:26624
    v_mfma_f32_16x16x32_bf16 v[48:51], v[156:159], v[180:183], v[48:51]
    ds_read_b64_tr_b16 v[138:139], v246 offset:27136
    v_mfma_f32_16x16x32_bf16 v[44:47], v[152:155], v[180:183], v[44:47]
    ds_read_b64_tr_b16 v[140:141], v246 offset:28672
    v_mfma_f32_16x16x32_bf16 v[40:43], v[148:151], v[180:183], v[40:43]
    ds_read_b64_tr_b16 v[142:143], v246 offset:29184
    v_mfma_f32_16x16x32_bf16 v[36:39], v[144:147], v[180:183], v[36:39]
    v_mfma_f32_16x16x32_bf16 v[68:71], v[184:187], v[144:147], v[68:71]
    s_lshl_b32 s80, s84, 8
    s_add_u32 s80, s80, 147456
    v_mfma_f32_16x16x32_bf16 v[72:75], v[184:187], v[148:151], v[72:75]
    v_and_b32 v243, 15, v0
    v_add_u32 v241, s80, v252
    v_mfma_f32_16x16x32_bf16 v[76:79], v[184:187], v[152:155], v[76:79]
    v_lshl_add_u32 v240, v243, 2, s80
    v_mfma_f32_16x16x32_bf16 v[80:83], v[184:187], v[156:159], v[80:83]
    v_mfma_f32_16x16x32_bf16 v[84:87], v[184:187], v[160:163], v[84:87]
    s_lshl_b32 s80, s47, 6
    s_add_u32 s80, s80, 148480
    v_mfma_f32_16x16x32_bf16 v[88:91], v[184:187], v[164:167], v[88:91]
    v_lshl_add_u32 v243, v243, 2, s80
    v_mfma_f32_16x16x32_bf16 v[92:95], v[184:187], v[168:171], v[92:95]
    v_add_u32_e64 v242, s80, v252
    v_mfma_f32_16x16x32_bf16 v[96:99], v[184:187], v[172:175], v[96:99]
    s_waitcnt lgkmcnt(0)
    s_nop 0
    v_mfma_f32_16x16x32_bf16 v[4:7], v[100:103], v[132:135], v[4:7]
    ds_read_b128 v[144:147], v245 offset:16384
    v_mfma_f32_16x16x32_bf16 v[8:11], v[104:107], v[132:135], v[8:11]
    ds_read_b64_tr_b16 v[176:177], v246 offset:36864
    v_mfma_f32_16x16x32_bf16 v[12:15], v[108:111], v[132:135], v[12:15]
    ds_read_b64_tr_b16 v[178:179], v246 offset:37376
    v_mfma_f32_16x16x32_bf16 v[16:19], v[112:115], v[132:135], v[16:19]
    ds_read_b128 v[148:151], v245 offset:18432
    v_mfma_f32_16x16x32_bf16 v[20:23], v[116:119], v[132:135], v[20:23]
    ds_read_b128 v[152:155], v245 offset:20480
    v_mfma_f32_16x16x32_bf16 v[24:27], v[120:123], v[132:135], v[24:27]
    ds_read_b128 v[156:159], v245 offset:22528
    v_mfma_f32_16x16x32_bf16 v[28:31], v[124:127], v[132:135], v[28:31]
    ds_read_b128 v[160:163], v245 offset:24576
    v_mfma_f32_16x16x32_bf16 v[32:35], v[128:131], v[132:135], v[32:35]
    v_mfma_f32_16x16x32_bf16 v[64:67], v[128:131], v[136:139], v[64:67]
    ds_read_b128 v[164:167], v245 offset:26624
    v_mfma_f32_16x16x32_bf16 v[60:63], v[124:127], v[136:139], v[60:63]
    ds_read_b128 v[168:171], v245 offset:28672
    v_mfma_f32_16x16x32_bf16 v[56:59], v[120:123], v[136:139], v[56:59]
    ds_read_b128 v[172:175], v245 offset:30720
    v_mfma_f32_16x16x32_bf16 v[52:55], v[116:119], v[136:139], v[52:55]
    ds_read_b64_tr_b16 v[180:181], v246 offset:38912
    v_mfma_f32_16x16x32_bf16 v[48:51], v[112:115], v[136:139], v[48:51]
    ds_read_b64_tr_b16 v[182:183], v246 offset:39424
    v_mfma_f32_16x16x32_bf16 v[44:47], v[108:111], v[136:139], v[44:47]
    ds_read_b64_tr_b16 v[184:185], v246 offset:40960
    v_mfma_f32_16x16x32_bf16 v[40:43], v[104:107], v[136:139], v[40:43]
    ds_read_b64_tr_b16 v[186:187], v246 offset:41472
    v_mfma_f32_16x16x32_bf16 v[36:39], v[100:103], v[136:139], v[36:39]
    v_mfma_f32_16x16x32_bf16 v[68:71], v[140:143], v[100:103], v[68:71]
    v_mfma_f32_16x16x32_bf16 v[72:75], v[140:143], v[104:107], v[72:75]
    v_mfma_f32_16x16x32_bf16 v[76:79], v[140:143], v[108:111], v[76:79]
    v_mfma_f32_16x16x32_bf16 v[80:83], v[140:143], v[112:115], v[80:83]
    v_mfma_f32_16x16x32_bf16 v[84:87], v[140:143], v[116:119], v[84:87]
    v_mfma_f32_16x16x32_bf16 v[88:91], v[140:143], v[120:123], v[88:91]
    v_mfma_f32_16x16x32_bf16 v[92:95], v[140:143], v[124:127], v[92:95]
    v_mfma_f32_16x16x32_bf16 v[96:99], v[140:143], v[128:131], v[96:99]
    s_waitcnt lgkmcnt(0)
    s_nop 0
    v_mfma_f32_16x16x32_bf16 v[4:7], v[144:147], v[176:179], v[4:7]
    ds_read_b128 v[188:191], v241 offset:0
    v_mfma_f32_16x16x32_bf16 v[8:11], v[148:151], v[176:179], v[8:11]
    ds_read_b128 v[192:195], v241 offset:64
    v_mfma_f32_16x16x32_bf16 v[12:15], v[152:155], v[176:179], v[12:15]
    ds_read_b128 v[196:199], v241 offset:128
    v_mfma_f32_16x16x32_bf16 v[16:19], v[156:159], v[176:179], v[16:19]
    ds_read_b128 v[200:203], v241 offset:192
    v_mfma_f32_16x16x32_bf16 v[20:23], v[160:163], v[176:179], v[20:23]
    ds_read_b128 v[204:207], v241 offset:256
    v_mfma_f32_16x16x32_bf16 v[24:27], v[164:167], v[176:179], v[24:27]
    ds_read_b128 v[208:211], v241 offset:320
    v_mfma_f32_16x16x32_bf16 v[28:31], v[168:171], v[176:179], v[28:31]
    ds_read_b128 v[212:215], v241 offset:384
    v_mfma_f32_16x16x32_bf16 v[32:35], v[172:175], v[176:179], v[32:35]
    ds_read_b128 v[216:219], v241 offset:448
    v_mfma_f32_16x16x32_bf16 v[64:67], v[172:175], v[180:183], v[64:67]
    ds_read_b128 v[100:103], v241 offset:512
    v_mfma_f32_16x16x32_bf16 v[60:63], v[168:171], v[180:183], v[60:63]
    ds_read_b128 v[104:107], v241 offset:576
    v_mfma_f32_16x16x32_bf16 v[56:59], v[164:167], v[180:183], v[56:59]
    ds_read_b128 v[108:111], v241 offset:640
    v_mfma_f32_16x16x32_bf16 v[52:55], v[160:163], v[180:183], v[52:55]
    ds_read_b128 v[112:115], v241 offset:704
    v_mfma_f32_16x16x32_bf16 v[48:51], v[156:159], v[180:183], v[48:51]
    ds_read_b128 v[116:119], v241 offset:768
    v_mfma_f32_16x16x32_bf16 v[44:47], v[152:155], v[180:183], v[44:47]
    ds_read_b128 v[120:123], v241 offset:832
    v_mfma_f32_16x16x32_bf16 v[40:43], v[148:151], v[180:183], v[40:43]
    ds_read_b128 v[124:127], v241 offset:896
    v_mfma_f32_16x16x32_bf16 v[36:39], v[144:147], v[180:183], v[36:39]
    ds_read_b128 v[128:131], v241 offset:960
    v_mfma_f32_16x16x32_bf16 v[68:71], v[184:187], v[144:147], v[68:71]
    ds_read_b32 v220, v243
    v_mfma_f32_16x16x32_bf16 v[72:75], v[184:187], v[148:151], v[72:75]
    ds_read_b32 v222, v243 offset:512
    v_mfma_f32_16x16x32_bf16 v[76:79], v[184:187], v[152:155], v[76:79]
    ds_read_b128 v[224:227], v242 offset:256
    v_mfma_f32_16x16x32_bf16 v[80:83], v[184:187], v[156:159], v[80:83]
    ds_read_b32 v3, v243 offset:768
    v_mfma_f32_16x16x32_bf16 v[84:87], v[184:187], v[160:163], v[84:87]
    v_mfma_f32_16x16x32_bf16 v[88:91], v[184:187], v[164:167], v[88:91]
    v_mfma_f32_16x16x32_bf16 v[92:95], v[184:187], v[168:171], v[92:95]
    v_mfma_f32_16x16x32_bf16 v[96:99], v[184:187], v[172:175], v[96:99]
    s_waitcnt lgkmcnt(0)
    s_nop 0
    ds_write_b32 v1, v2
    v_pk_mul_f32 v[36:37], v[36:37], v[188:189]
    v_pk_mul_f32 v[38:39], v[38:39], v[190:191]
    v_pk_mul_f32 v[40:41], v[40:41], v[192:193]
    v_pk_mul_f32 v[42:43], v[42:43], v[194:195]
    v_pk_mul_f32 v[44:45], v[44:45], v[196:197]
    v_pk_mul_f32 v[46:47], v[46:47], v[198:199]
    v_pk_mul_f32 v[48:49], v[48:49], v[200:201]
    v_pk_mul_f32 v[50:51], v[50:51], v[202:203]
    v_pk_fma_f32 v[36:37], v[100:101], v[222:223], v[36:37] op_sel_hi:[1,0,1]
    v_pk_fma_f32 v[38:39], v[102:103], v[222:223], v[38:39] op_sel_hi:[1,0,1]
    v_pk_fma_f32 v[40:41], v[104:105], v[222:223], v[40:41] op_sel_hi:[1,0,1]
    v_pk_fma_f32 v[42:43], v[106:107], v[222:223], v[42:43] op_sel_hi:[1,0,1]
    v_pk_fma_f32 v[44:45], v[108:109], v[222:223], v[44:45] op_sel_hi:[1,0,1]
    v_pk_fma_f32 v[46:47], v[110:111], v[222:223], v[46:47] op_sel_hi:[1,0,1]
    v_pk_fma_f32 v[48:49], v[112:113], v[222:223], v[48:49] op_sel_hi:[1,0,1]
    v_pk_fma_f32 v[50:51], v[114:115], v[222:223], v[50:51] op_sel_hi:[1,0,1]
    v_cvt_pk_bf16_f32 v164, v36, v37
    v_cvt_pk_bf16_f32 v165, v38, v39
    v_cvt_pk_bf16_f32 v166, v40, v41
    v_cvt_pk_bf16_f32 v167, v42, v43
    v_cvt_pk_bf16_f32 v168, v44, v45
    v_cvt_pk_bf16_f32 v169, v46, v47
    v_cvt_pk_bf16_f32 v170, v48, v49
    v_cvt_pk_bf16_f32 v171, v50, v51
    v_pk_fma_f32 v[4:5], v[4:5], v[188:189], s[88:89]
    v_pk_fma_f32 v[6:7], v[6:7], v[190:191], s[88:89]
    v_pk_fma_f32 v[8:9], v[8:9], v[192:193], s[88:89]
    v_pk_fma_f32 v[10:11], v[10:11], v[194:195], s[88:89]
    v_pk_fma_f32 v[12:13], v[12:13], v[196:197], s[88:89]
    v_pk_fma_f32 v[14:15], v[14:15], v[198:199], s[88:89]
    v_pk_fma_f32 v[16:17], v[16:17], v[200:201], s[88:89]
    v_pk_fma_f32 v[18:19], v[18:19], v[202:203], s[88:89]
    v_pk_fma_f32 v[4:5], v[100:101], v[220:221], v[4:5] op_sel_hi:[1,0,1]
    v_pk_fma_f32 v[6:7], v[102:103], v[220:221], v[6:7] op_sel_hi:[1,0,1]
    v_pk_fma_f32 v[8:9], v[104:105], v[220:221], v[8:9] op_sel_hi:[1,0,1]
    v_pk_fma_f32 v[10:11], v[106:107], v[220:221], v[10:11] op_sel_hi:[1,0,1]
    v_pk_fma_f32 v[12:13], v[108:109], v[220:221], v[12:13] op_sel_hi:[1,0,1]
    v_pk_fma_f32 v[14:15], v[110:111], v[220:221], v[14:15] op_sel_hi:[1,0,1]
    v_pk_fma_f32 v[16:17], v[112:113], v[220:221], v[16:17] op_sel_hi:[1,0,1]
    v_pk_fma_f32 v[18:19], v[114:115], v[220:221], v[18:19] op_sel_hi:[1,0,1]
    v_pk_mul_f32 v[132:133], v[4:5], s[90:91]
    v_pk_mul_f32 v[134:135], v[6:7], s[90:91]
    v_pk_mul_f32 v[136:137], v[8:9], s[90:91]
    v_pk_mul_f32 v[138:139], v[10:11], s[90:91]
    v_pk_mul_f32 v[140:141], v[12:13], s[90:91]
    v_pk_mul_f32 v[142:143], v[14:15], s[90:91]
    v_pk_mul_f32 v[144:145], v[16:17], s[90:91]
    v_pk_mul_f32 v[146:147], v[18:19], s[90:91]
    v_exp_f32_e64 v132, v132 clamp
    v_max_f32_e64 v4, s88, v4
    v_exp_f32_e64 v133, v133 clamp
    v_max_f32_e64 v5, s88, v5
    v_exp_f32_e64 v134, v134 clamp
    v_max_f32_e64 v6, s88, v6
    v_exp_f32_e64 v135, v135 clamp
    v_max_f32_e64 v7, s88, v7
    v_exp_f32_e64 v136, v136 clamp
    v_max_f32_e64 v8, s88, v8
    v_exp_f32_e64 v137, v137 clamp
    v_max_f32_e64 v9, s88, v9
    v_exp_f32_e64 v138, v138 clamp
    v_max_f32_e64 v10, s88, v10
    v_exp_f32_e64 v139, v139 clamp
    v_max_f32_e64 v11, s88, v11
    v_exp_f32_e64 v140, v140 clamp
    v_max_f32_e64 v12, s88, v12
    v_exp_f32_e64 v141, v141 clamp
    v_max_f32_e64 v13, s88, v13
    v_exp_f32_e64 v142, v142 clamp
    v_max_f32_e64 v14, s88, v14
    v_exp_f32_e64 v143, v143 clamp
    v_max_f32_e64 v15, s88, v15
    v_exp_f32_e64 v144, v144 clamp
    v_max_f32_e64 v16, s88, v16
    v_exp_f32_e64 v145, v145 clamp
    v_max_f32_e64 v17, s88, v17
    v_exp_f32_e64 v146, v146 clamp
    v_max_f32_e64 v18, s88, v18
    v_exp_f32_e64 v147, v147 clamp
    v_max_f32_e64 v19, s88, v19
    v_pk_add_f32 v[4:5], v[4:5], v[132:133]
    v_pk_add_f32 v[6:7], v[6:7], v[134:135]
    v_pk_add_f32 v[8:9], v[8:9], v[136:137]
    v_pk_add_f32 v[10:11], v[10:11], v[138:139]
    v_pk_add_f32 v[12:13], v[12:13], v[140:141]
    v_pk_add_f32 v[14:15], v[14:15], v[142:143]
    v_pk_add_f32 v[16:17], v[16:17], v[144:145]
    v_pk_add_f32 v[18:19], v[18:19], v[146:147]
    v_cvt_pk_bf16_f32 v148, v4, v5
    v_cvt_pk_bf16_f32 v149, v6, v7
    v_cvt_pk_bf16_f32 v150, v8, v9
    v_cvt_pk_bf16_f32 v151, v10, v11
    v_cvt_pk_bf16_f32 v152, v12, v13
    v_cvt_pk_bf16_f32 v153, v14, v15
    v_cvt_pk_bf16_f32 v154, v16, v17
    v_cvt_pk_bf16_f32 v155, v18, v19
    v_pk_mul_f32 v[52:53], v[52:53], v[204:205]
    v_pk_mul_f32 v[54:55], v[54:55], v[206:207]
    v_pk_mul_f32 v[56:57], v[56:57], v[208:209]
    v_pk_mul_f32 v[58:59], v[58:59], v[210:211]
    v_pk_mul_f32 v[60:61], v[60:61], v[212:213]
    v_pk_mul_f32 v[62:63], v[62:63], v[214:215]
    v_pk_mul_f32 v[64:65], v[64:65], v[216:217]
    v_pk_mul_f32 v[66:67], v[66:67], v[218:219]
    v_pk_fma_f32 v[52:53], v[116:117], v[222:223], v[52:53] op_sel_hi:[1,0,1]
    v_pk_fma_f32 v[54:55], v[118:119], v[222:223], v[54:55] op_sel_hi:[1,0,1]
    v_pk_fma_f32 v[56:57], v[120:121], v[222:223], v[56:57] op_sel_hi:[1,0,1]
    v_pk_fma_f32 v[58:59], v[122:123], v[222:223], v[58:59] op_sel_hi:[1,0,1]
    v_pk_fma_f32 v[60:61], v[124:125], v[222:223], v[60:61] op_sel_hi:[1,0,1]
    v_pk_fma_f32 v[62:63], v[126:127], v[222:223], v[62:63] op_sel_hi:[1,0,1]
    v_pk_fma_f32 v[64:65], v[128:129], v[222:223], v[64:65] op_sel_hi:[1,0,1]
    v_pk_fma_f32 v[66:67], v[130:131], v[222:223], v[66:67] op_sel_hi:[1,0,1]
    v_cvt_pk_bf16_f32 v172, v52, v53
    v_cvt_pk_bf16_f32 v173, v54, v55
    v_cvt_pk_bf16_f32 v174, v56, v57
    v_cvt_pk_bf16_f32 v175, v58, v59
    v_cvt_pk_bf16_f32 v176, v60, v61
    v_cvt_pk_bf16_f32 v177, v62, v63
    v_cvt_pk_bf16_f32 v178, v64, v65
    v_cvt_pk_bf16_f32 v179, v66, v67
    v_pk_fma_f32 v[20:21], v[20:21], v[204:205], s[88:89]
    v_pk_fma_f32 v[22:23], v[22:23], v[206:207], s[88:89]
    v_pk_fma_f32 v[24:25], v[24:25], v[208:209], s[88:89]
    v_pk_fma_f32 v[26:27], v[26:27], v[210:211], s[88:89]
    v_pk_fma_f32 v[28:29], v[28:29], v[212:213], s[88:89]
    v_pk_fma_f32 v[30:31], v[30:31], v[214:215], s[88:89]
    v_pk_fma_f32 v[32:33], v[32:33], v[216:217], s[88:89]
    v_pk_fma_f32 v[34:35], v[34:35], v[218:219], s[88:89]
    v_pk_fma_f32 v[20:21], v[116:117], v[220:221], v[20:21] op_sel_hi:[1,0,1]
    v_pk_fma_f32 v[22:23], v[118:119], v[220:221], v[22:23] op_sel_hi:[1,0,1]
    v_pk_fma_f32 v[24:25], v[120:121], v[220:221], v[24:25] op_sel_hi:[1,0,1]
    v_pk_fma_f32 v[26:27], v[122:123], v[220:221], v[26:27] op_sel_hi:[1,0,1]
    v_pk_fma_f32 v[28:29], v[124:125], v[220:221], v[28:29] op_sel_hi:[1,0,1]
    v_pk_fma_f32 v[30:31], v[126:127], v[220:221], v[30:31] op_sel_hi:[1,0,1]
    v_pk_fma_f32 v[32:33], v[128:129], v[220:221], v[32:33] op_sel_hi:[1,0,1]
    v_pk_fma_f32 v[34:35], v[130:131], v[220:221], v[34:35] op_sel_hi:[1,0,1]
    v_pk_mul_f32 v[132:133], v[20:21], s[90:91]
    v_pk_mul_f32 v[134:135], v[22:23], s[90:91]
    v_pk_mul_f32 v[136:137], v[24:25], s[90:91]
    v_pk_mul_f32 v[138:139], v[26:27], s[90:91]
    v_pk_mul_f32 v[140:141], v[28:29], s[90:91]
    v_pk_mul_f32 v[142:143], v[30:31], s[90:91]
    v_pk_mul_f32 v[144:145], v[32:33], s[90:91]
    v_pk_mul_f32 v[146:147], v[34:35], s[90:91]
    v_mfma_f32_16x16x32_bf16 v[180:183], v[148:151], v[164:167], 0
    v_exp_f32_e64 v132, v132 clamp
    v_max_f32_e64 v20, s88, v20
    v_exp_f32_e64 v133, v133 clamp
    v_max_f32_e64 v21, s88, v21
    v_mfma_f32_16x16x32_bf16 v[184:187], v[148:151], v[236:239], 0
    v_exp_f32_e64 v134, v134 clamp
    v_max_f32_e64 v22, s88, v22
    v_exp_f32_e64 v135, v135 clamp
    v_max_f32_e64 v23, s88, v23
    v_mfma_f32_16x16x32_bf16 v[180:183], v[152:155], v[168:171], v[180:183]
    v_exp_f32_e64 v136, v136 clamp
    v_max_f32_e64 v24, s88, v24
    v_exp_f32_e64 v137, v137 clamp
    v_max_f32_e64 v25, s88, v25
    v_mfma_f32_16x16x32_bf16 v[184:187], v[152:155], v[236:239], v[184:187]
    v_exp_f32_e64 v138, v138 clamp
    v_max_f32_e64 v26, s88, v26
    v_exp_f32_e64 v139, v139 clamp
    v_max_f32_e64 v27, s88, v27
    v_exp_f32_e64 v140, v140 clamp
    v_max_f32_e64 v28, s88, v28
    v_exp_f32_e64 v141, v141 clamp
    v_max_f32_e64 v29, s88, v29
    v_exp_f32_e64 v142, v142 clamp
    v_max_f32_e64 v30, s88, v30
    v_exp_f32_e64 v143, v143 clamp
    v_max_f32_e64 v31, s88, v31
    v_exp_f32_e64 v144, v144 clamp
    v_max_f32_e64 v32, s88, v32
    v_exp_f32_e64 v145, v145 clamp
    v_max_f32_e64 v33, s88, v33
    v_exp_f32_e64 v146, v146 clamp
    v_max_f32_e64 v34, s88, v34
    v_exp_f32_e64 v147, v147 clamp
    v_max_f32_e64 v35, s88, v35
    v_pk_add_f32 v[20:21], v[20:21], v[132:133]
    v_pk_add_f32 v[22:23], v[22:23], v[134:135]
    v_pk_add_f32 v[24:25], v[24:25], v[136:137]
    v_pk_add_f32 v[26:27], v[26:27], v[138:139]
    v_pk_add_f32 v[28:29], v[28:29], v[140:141]
    v_pk_add_f32 v[30:31], v[30:31], v[142:143]
    v_pk_add_f32 v[32:33], v[32:33], v[144:145]
    v_pk_add_f32 v[34:35], v[34:35], v[146:147]
    v_cvt_pk_bf16_f32 v156, v20, v21
    v_cvt_pk_bf16_f32 v157, v22, v23
    v_cvt_pk_bf16_f32 v158, v24, v25
    v_cvt_pk_bf16_f32 v159, v26, v27
    v_cvt_pk_bf16_f32 v160, v28, v29
    v_cvt_pk_bf16_f32 v161, v30, v31
    v_cvt_pk_bf16_f32 v162, v32, v33
    v_cvt_pk_bf16_f32 v163, v34, v35
    v_mfma_f32_16x16x32_bf16 v[180:183], v[156:159], v[172:175], v[180:183]
    v_mfma_f32_16x16x32_bf16 v[184:187], v[156:159], v[236:239], v[184:187]
    v_mfma_f32_16x16x32_bf16 v[180:183], v[160:163], v[176:179], v[180:183]
    v_mfma_f32_16x16x32_bf16 v[184:187], v[160:163], v[236:239], v[184:187]
    s_lshl4_add_u32 s80, s46, s26
    s_mul_i32 s47, s80, 640
    s_add_u32 s47, s47, 10485760
    v_and_b32 v243, 1, v0
    v_lshlrev_b32 v242, 1, v252
    v_lshl_add_u32 v243, v243, 4, v242
    s_nop 0
    v_cvt_pk_bf16_f32 v132, v180, v181
    v_cvt_pk_bf16_f32 v133, v182, v183
    s_mov_b32 exec_lo, 0x00030003
    s_mov_b32 exec_hi, 0x00030003
    buffer_store_dwordx4 v[184:187], v243, s[32:35], s47 offen offset:512 sc1
    s_mov_b64 exec, -1
    v_permlane32_swap_b32 v132, v134
    v_permlane32_swap_b32 v133, v135
    s_mov_b32 exec_hi, 0
    buffer_store_dwordx4 v[132:135], v250, s[32:35], s47 offen sc1
    s_mov_b32 exec_hi, -1
    s_nop 0
    ds_read_b32 v188, v240 offset:0
    ds_read_b32 v100, v240 offset:512
    ds_read_b32 v190, v240 offset:64
    ds_read_b32 v102, v240 offset:576
    ds_read_b32 v192, v240 offset:128
    ds_read_b32 v104, v240 offset:640
    ds_read_b32 v194, v240 offset:192
    ds_read_b32 v106, v240 offset:704
    ds_read_b32 v196, v240 offset:256
    ds_read_b32 v108, v240 offset:768
    ds_read_b32 v198, v240 offset:320
    ds_read_b32 v110, v240 offset:832
    ds_read_b32 v200, v240 offset:384
    ds_read_b32 v112, v240 offset:896
    ds_read_b32 v202, v240 offset:448
    ds_read_b32 v114, v240 offset:960
    v_readfirstlane_b32 s50, v3
    s_lshr_b32 s82, s26, 3
    s_lshl_b32 s82, s82, 5
    s_and_b32 s43, s26, 7
    s_add_u32 s82, s82, s43
    s_lshl_b32 s82, s82, 2
    s_lshl_b32 s80, s46, 13
    s_add_u32 s82, s82, s80
    s_add_u32 s82, s82, 11337728
    v_lshlrev_b32 v241, 9, v0
    s_add_u32 s94, s24, s82
    s_addc_u32 s95, s25, 0
    s_waitcnt lgkmcnt(0)
    v_pk_fma_f32 v[68:69], v[68:69], v[188:189], s[88:89] op_sel_hi:[1,0,1]
    v_pk_fma_f32 v[70:71], v[70:71], v[188:189], s[88:89] op_sel_hi:[1,0,1]
    v_pk_fma_f32 v[72:73], v[72:73], v[190:191], s[88:89] op_sel_hi:[1,0,1]
    v_pk_fma_f32 v[74:75], v[74:75], v[190:191], s[88:89] op_sel_hi:[1,0,1]
    v_pk_fma_f32 v[76:77], v[76:77], v[192:193], s[88:89] op_sel_hi:[1,0,1]
    v_pk_fma_f32 v[78:79], v[78:79], v[192:193], s[88:89] op_sel_hi:[1,0,1]
    v_pk_fma_f32 v[80:81], v[80:81], v[194:195], s[88:89] op_sel_hi:[1,0,1]
    v_pk_fma_f32 v[82:83], v[82:83], v[194:195], s[88:89] op_sel_hi:[1,0,1]
    v_pk_fma_f32 v[68:69], v[224:225], v[100:101], v[68:69] op_sel_hi:[1,0,1]
    v_pk_fma_f32 v[70:71], v[226:227], v[100:101], v[70:71] op_sel_hi:[1,0,1]
    v_pk_fma_f32 v[72:73], v[224:225], v[102:103], v[72:73] op_sel_hi:[1,0,1]
    v_pk_fma_f32 v[74:75], v[226:227], v[102:103], v[74:75] op_sel_hi:[1,0,1]
    v_pk_fma_f32 v[76:77], v[224:225], v[104:105], v[76:77] op_sel_hi:[1,0,1]
    v_pk_fma_f32 v[78:79], v[226:227], v[104:105], v[78:79] op_sel_hi:[1,0,1]
    v_pk_fma_f32 v[80:81], v[224:225], v[106:107], v[80:81] op_sel_hi:[1,0,1]
    v_pk_fma_f32 v[82:83], v[226:227], v[106:107], v[82:83] op_sel_hi:[1,0,1]
    v_pk_mul_f32 v[116:117], v[68:69], s[90:91]
    v_pk_mul_f32 v[118:119], v[70:71], s[90:91]
    v_pk_mul_f32 v[120:121], v[72:73], s[90:91]
    v_pk_mul_f32 v[122:123], v[74:75], s[90:91]
    v_pk_mul_f32 v[124:125], v[76:77], s[90:91]
    v_pk_mul_f32 v[126:127], v[78:79], s[90:91]
    v_pk_mul_f32 v[128:129], v[80:81], s[90:91]
    v_pk_mul_f32 v[130:131], v[82:83], s[90:91]
    v_exp_f32_e64 v116, v116 clamp
    v_max_f32_e64 v68, s88, v68
    v_exp_f32_e64 v117, v117 clamp
    v_max_f32_e64 v69, s88, v69
    v_exp_f32_e64 v118, v118 clamp
    v_max_f32_e64 v70, s88, v70
    v_exp_f32_e64 v119, v119 clamp
    v_max_f32_e64 v71, s88, v71
    v_exp_f32_e64 v120, v120 clamp
    v_max_f32_e64 v72, s88, v72
    v_exp_f32_e64 v121, v121 clamp
    v_max_f32_e64 v73, s88, v73
    v_exp_f32_e64 v122, v122 clamp
    v_max_f32_e64 v74, s88, v74
    v_exp_f32_e64 v123, v123 clamp
    v_max_f32_e64 v75, s88, v75
    v_exp_f32_e64 v124, v124 clamp
    v_max_f32_e64 v76, s88, v76
    v_exp_f32_e64 v125, v125 clamp
    v_max_f32_e64 v77, s88, v77
    v_exp_f32_e64 v126, v126 clamp
    v_max_f32_e64 v78, s88, v78
    v_exp_f32_e64 v127, v127 clamp
    v_max_f32_e64 v79, s88, v79
    v_exp_f32_e64 v128, v128 clamp
    v_max_f32_e64 v80, s88, v80
    v_exp_f32_e64 v129, v129 clamp
    v_max_f32_e64 v81, s88, v81
    v_exp_f32_e64 v130, v130 clamp
    v_max_f32_e64 v82, s88, v82
    v_exp_f32_e64 v131, v131 clamp
    v_max_f32_e64 v83, s88, v83
    v_pk_add_f32 v[68:69], v[68:69], v[116:117]
    v_pk_add_f32 v[70:71], v[70:71], v[118:119]
    v_pk_add_f32 v[72:73], v[72:73], v[120:121]
    v_pk_add_f32 v[74:75], v[74:75], v[122:123]
    v_pk_add_f32 v[76:77], v[76:77], v[124:125]
    v_pk_add_f32 v[78:79], v[78:79], v[126:127]
    v_pk_add_f32 v[80:81], v[80:81], v[128:129]
    v_pk_add_f32 v[82:83], v[82:83], v[130:131]
    v_cvt_pk_bf16_f32 v148, v68, v69
    v_cvt_pk_bf16_f32 v149, v70, v71
    v_cvt_pk_bf16_f32 v150, v72, v73
    v_cvt_pk_bf16_f32 v151, v74, v75
    v_cvt_pk_bf16_f32 v152, v76, v77
    v_cvt_pk_bf16_f32 v153, v78, v79
    v_cvt_pk_bf16_f32 v154, v80, v81
    v_cvt_pk_bf16_f32 v155, v82, v83
    v_pk_fma_f32 v[84:85], v[84:85], v[196:197], s[88:89] op_sel_hi:[1,0,1]
    v_pk_fma_f32 v[86:87], v[86:87], v[196:197], s[88:89] op_sel_hi:[1,0,1]
    v_pk_fma_f32 v[88:89], v[88:89], v[198:199], s[88:89] op_sel_hi:[1,0,1]
    v_pk_fma_f32 v[90:91], v[90:91], v[198:199], s[88:89] op_sel_hi:[1,0,1]
    v_pk_fma_f32 v[92:93], v[92:93], v[200:201], s[88:89] op_sel_hi:[1,0,1]
    v_pk_fma_f32 v[94:95], v[94:95], v[200:201], s[88:89] op_sel_hi:[1,0,1]
    v_pk_fma_f32 v[96:97], v[96:97], v[202:203], s[88:89] op_sel_hi:[1,0,1]
    v_pk_fma_f32 v[98:99], v[98:99], v[202:203], s[88:89] op_sel_hi:[1,0,1]
    v_pk_fma_f32 v[84:85], v[224:225], v[108:109], v[84:85] op_sel_hi:[1,0,1]
    v_pk_fma_f32 v[86:87], v[226:227], v[108:109], v[86:87] op_sel_hi:[1,0,1]
    v_pk_fma_f32 v[88:89], v[224:225], v[110:111], v[88:89] op_sel_hi:[1,0,1]
    v_pk_fma_f32 v[90:91], v[226:227], v[110:111], v[90:91] op_sel_hi:[1,0,1]
    v_pk_fma_f32 v[92:93], v[224:225], v[112:113], v[92:93] op_sel_hi:[1,0,1]
    v_pk_fma_f32 v[94:95], v[226:227], v[112:113], v[94:95] op_sel_hi:[1,0,1]
    v_pk_fma_f32 v[96:97], v[224:225], v[114:115], v[96:97] op_sel_hi:[1,0,1]
    v_pk_fma_f32 v[98:99], v[226:227], v[114:115], v[98:99] op_sel_hi:[1,0,1]
    v_pk_mul_f32 v[116:117], v[84:85], s[90:91]
    v_pk_mul_f32 v[118:119], v[86:87], s[90:91]
    v_pk_mul_f32 v[120:121], v[88:89], s[90:91]
    v_pk_mul_f32 v[122:123], v[90:91], s[90:91]
    v_pk_mul_f32 v[124:125], v[92:93], s[90:91]
    v_pk_mul_f32 v[126:127], v[94:95], s[90:91]
    v_pk_mul_f32 v[128:129], v[96:97], s[90:91]
    v_pk_mul_f32 v[130:131], v[98:99], s[90:91]
    s_waitcnt vmcnt(0)
    s_nop 0
    s_atomic_swap s50, s[94:95], 0
    s_atomic_swap s50, s[94:95], 512
    s_atomic_swap s50, s[94:95], 1024
    s_atomic_swap s50, s[94:95], 1536
    s_atomic_swap s50, s[94:95], 2048
    s_atomic_swap s50, s[94:95], 2560
    s_atomic_swap s50, s[94:95], 3072
    s_atomic_swap s50, s[94:95], 3584
    v_exp_f32_e64 v116, v116 clamp
    v_max_f32_e64 v84, s88, v84
    v_exp_f32_e64 v117, v117 clamp
    v_max_f32_e64 v85, s88, v85
    v_exp_f32_e64 v118, v118 clamp
    v_max_f32_e64 v86, s88, v86
    v_exp_f32_e64 v119, v119 clamp
    v_max_f32_e64 v87, s88, v87
    v_exp_f32_e64 v120, v120 clamp
    v_max_f32_e64 v88, s88, v88
    v_exp_f32_e64 v121, v121 clamp
    v_max_f32_e64 v89, s88, v89
    v_exp_f32_e64 v122, v122 clamp
    v_max_f32_e64 v90, s88, v90
    v_exp_f32_e64 v123, v123 clamp
    v_max_f32_e64 v91, s88, v91
    v_exp_f32_e64 v124, v124 clamp
    v_max_f32_e64 v92, s88, v92
    v_exp_f32_e64 v125, v125 clamp
    v_max_f32_e64 v93, s88, v93
    v_exp_f32_e64 v126, v126 clamp
    v_max_f32_e64 v94, s88, v94
    v_exp_f32_e64 v127, v127 clamp
    v_max_f32_e64 v95, s88, v95
    v_exp_f32_e64 v128, v128 clamp
    v_max_f32_e64 v96, s88, v96
    v_exp_f32_e64 v129, v129 clamp
    v_max_f32_e64 v97, s88, v97
    v_exp_f32_e64 v130, v130 clamp
    v_max_f32_e64 v98, s88, v98
    v_exp_f32_e64 v131, v131 clamp
    v_max_f32_e64 v99, s88, v99
    v_pk_add_f32 v[84:85], v[84:85], v[116:117]
    v_pk_add_f32 v[86:87], v[86:87], v[118:119]
    v_pk_add_f32 v[88:89], v[88:89], v[120:121]
    v_pk_add_f32 v[90:91], v[90:91], v[122:123]
    v_pk_add_f32 v[92:93], v[92:93], v[124:125]
    v_pk_add_f32 v[94:95], v[94:95], v[126:127]
    v_pk_add_f32 v[96:97], v[96:97], v[128:129]
    v_pk_add_f32 v[98:99], v[98:99], v[130:131]
    v_cvt_pk_bf16_f32 v156, v84, v85
    v_cvt_pk_bf16_f32 v157, v86, v87
    v_cvt_pk_bf16_f32 v158, v88, v89
    v_cvt_pk_bf16_f32 v159, v90, v91
    v_cvt_pk_bf16_f32 v160, v92, v93
    v_cvt_pk_bf16_f32 v161, v94, v95
    v_cvt_pk_bf16_f32 v162, v96, v97
    v_cvt_pk_bf16_f32 v163, v98, v99
    s_mov_b32 s51, s50
    s_mul_i32 s47, s49, 10240
    s_add_u32 s47, s47, 10485760
    v_and_b32 v243, 15, v0
    v_mul_u32_u24 v241, 640, v243
    v_add_u32 v242, v242, v241
    v_lshrrev_b32 v241, 5, v0
    v_lshl_add_u32 v240, v241, 7, v250
    s_and_b32 s81, s49, 1
    s_lshl_b32 s81, s81, 9
    v_lshl_add_u32 v246, v243, 4, s81
    v_lshl_add_u32 v246, v241, 8, v246
    v_lshrrev_b32 v248, 7, v246
    v_cmp_eq_u32 vcc, 3, v248
    v_add_u32 v248, 4224, v246
    s_nop 0
    v_cndmask_b32 v246, v246, v248, vcc
    v_cndmask_b32_e64 v248, 8, 1, vcc
    v_lshlrev_b32 v248, 7, v248
    v_bfe_u32 v243, v0, 4, 1
    v_mad_u32_u24 v246, v243, v248, v246
    v_lshl_add_u32 v247, v248, 1, v246
    s_lshr_b32 s80, s49, 1
    s_add_u32 s80, s80, 43
    s_mul_i32 s80, s80, 5120
    s_add_u32 s92, s92, s80
    s_add_u32 s48, s92, 327680
    s_lshr_b32 s80, s49, 3
    s_lshl_b32 s81, s26, 6
    s_add_u32 s80, s80, s81
    s_lshl_b32 s80, s80, 9
    s_and_b32 s81, s49, 7
    s_lshr_b32 s93, s81, 3
    s_lshl_b32 s93, s93, 5
    s_and_b32 s43, s81, 7
    s_add_u32 s93, s93, s43
    s_lshl_b32 s93, s93, 2
    s_add_u32 s93, s93, s80
    s_add_u32 s93, s93, 10813472
    v_bfe_u32 v172, v0, 2, 1
    v_bfe_u32 v173, v0, 4, 1
    v_xor_b32 v172, v172, v173
    v_bfe_u32 v173, v0, 3, 1
    v_lshl_add_u32 v172, v172, 1, v173
    v_bfe_u32 v173, v0, 1, 1
    v_lshl_add_u32 v172, v172, 1, v173
    v_and_b32 v173, 1, v0
    v_lshlrev_b32 v173, 4, v173
    v_mov_b32 v174, 0x3f80
    v_lshlrev_b32 v173, v173, v174
    v_cmp_eq_u32 vcc, 0, v172
    s_nop 1
    v_cndmask_b32 v168, 0, v173, vcc
    v_cmp_eq_u32 vcc, 1, v172
    s_nop 1
    v_cndmask_b32 v169, 0, v173, vcc
    v_cmp_eq_u32 vcc, 2, v172
    s_nop 1
    v_cndmask_b32 v170, 0, v173, vcc
    v_cmp_eq_u32 vcc, 3, v172
    s_nop 1
    v_cndmask_b32 v171, 0, v173, vcc
    s_mov_b32 s80, 200000
L_fl_29:
    s_load_dwordx8 s[64:71], s[44:45], 0 glc
    s_load_dwordx8 s[72:79], s[44:45], 128 glc
    s_sub_u32 s80, s80, 1
    s_waitcnt lgkmcnt(0)
    s_cbranch_scc1 L_flok_30
    s_xor_b64 s[64:65], s[64:65], s[50:51]
    s_xor_b64 s[66:67], s[66:67], s[50:51]
    s_xor_b64 s[68:69], s[68:69], s[50:51]
    s_xor_b64 s[70:71], s[70:71], s[50:51]
    s_xor_b64 s[72:73], s[72:73], s[50:51]
    s_xor_b64 s[74:75], s[74:75], s[50:51]
    s_xor_b64 s[76:77], s[76:77], s[50:51]
    s_xor_b64 s[78:79], s[78:79], s[50:51]
    s_or_b64 s[64:65], s[64:65], s[72:73]
    s_or_b64 s[66:67], s[66:67], s[74:75]
    s_or_b64 s[68:69], s[68:69], s[76:77]
    s_or_b64 s[70:71], s[70:71], s[78:79]
    s_or_b64 s[64:65], s[64:65], s[68:69]
    s_or_b64 s[66:67], s[66:67], s[70:71]
    s_or_b64 s[64:65], s[64:65], s[66:67]
    s_cbranch_scc1 L_fl_29
L_flok_30:
    buffer_load_dwordx4 v[20:23], v242, s[32:35], s47 offen offset:512 sc1
    buffer_load_dwordx4 v[36:39], v240, s[32:35], s47 offen offset:0 sc1
    buffer_load_dwordx4 v[40:43], v240, s[32:35], s47 offen offset:1280 sc1
    buffer_load_dwordx4 v[44:47], v240, s[32:35], s47 offen offset:2560 sc1
    buffer_load_dwordx4 v[48:51], v240, s[32:35], s47 offen offset:3840 sc1
    s_add_u32 s47, s47, 5120
    buffer_load_dwordx4 v[52:55], v240, s[32:35], s47 offen offset:0 sc1
    buffer_load_dwordx4 v[56:59], v240, s[32:35], s47 offen offset:1280 sc1
    buffer_load_dwordx4 v[60:63], v240, s[32:35], s47 offen offset:2560 sc1
    buffer_load_dwordx4 v[64:67], v240, s[32:35], s47 offen offset:3840 sc1
    s_waitcnt vmcnt(8)
    s_nop 0
    v_add_f32_dpp v20, v20, v20 row_ror:8 row_mask:0xf bank_mask:0xf
    v_add_f32_dpp v21, v21, v21 row_ror:8 row_mask:0xf bank_mask:0xf
    v_add_f32_dpp v22, v22, v22 row_ror:8 row_mask:0xf bank_mask:0xf
    v_add_f32_dpp v23, v23, v23 row_ror:8 row_mask:0xf bank_mask:0xf
    v_add_f32_dpp v20, v20, v20 row_ror:4 row_mask:0xf bank_mask:0xf
    v_add_f32_dpp v21, v21, v21 row_ror:4 row_mask:0xf bank_mask:0xf
    v_add_f32_dpp v22, v22, v22 row_ror:4 row_mask:0xf bank_mask:0xf
    v_add_f32_dpp v23, v23, v23 row_ror:4 row_mask:0xf bank_mask:0xf
    v_add_f32_dpp v20, v20, v20 row_ror:2 row_mask:0xf bank_mask:0xf
    v_add_f32_dpp v21, v21, v21 row_ror:2 row_mask:0xf bank_mask:0xf
    v_add_f32_dpp v22, v22, v22 row_ror:2 row_mask:0xf bank_mask:0xf
    v_add_f32_dpp v23, v23, v23 row_ror:2 row_mask:0xf bank_mask:0xf
    v_add_f32_dpp v20, v20, v20 row_ror:1 row_mask:0xf bank_mask:0xf
    v_add_f32_dpp v21, v21, v21 row_ror:1 row_mask:0xf bank_mask:0xf
    v_add_f32_dpp v22, v22, v22 row_ror:1 row_mask:0xf bank_mask:0xf
    v_add_f32_dpp v23, v23, v23 row_ror:1 row_mask:0xf bank_mask:0xf
    v_cvt_pk_bf16_f32 v166, v20, v21
    v_cvt_pk_bf16_f32 v167, v22, v23
    s_nop 1
    v_mfma_f32_16x16x16_bf16 v[68:71], v[166:167], v[148:149], 0
    v_mfma_f32_16x16x16_bf16 v[72:75], v[166:167], v[150:151], 0
    v_mfma_f32_16x16x16_bf16 v[76:79], v[166:167], v[152:153], 0
    v_mfma_f32_16x16x16_bf16 v[80:83], v[166:167], v[154:155], 0
    v_mfma_f32_16x16x16_bf16 v[84:87], v[166:167], v[156:157], 0
    v_mfma_f32_16x16x16_bf16 v[88:91], v[166:167], v[158:159], 0
    v_mfma_f32_16x16x16_bf16 v[92:95], v[166:167], v[160:161], 0
    v_mfma_f32_16x16x16_bf16 v[96:99], v[166:167], v[162:163], 0
    s_waitcnt vmcnt(7)
    v_mfma_f32_16x16x32_bf16 v[4:7], v[168:171], v[36:39], 0
    v_add_f32 v68, s88, v68
    v_rcp_f32 v68, v68
    s_waitcnt vmcnt(6)
    v_mfma_f32_16x16x32_bf16 v[4:7], v[168:171], v[40:43], v[4:7]
    s_waitcnt vmcnt(5)
    v_mfma_f32_16x16x32_bf16 v[4:7], v[168:171], v[44:47], v[4:7]
    v_add_f32 v72, s88, v72
    v_rcp_f32 v72, v72
    s_waitcnt vmcnt(4)
    v_mfma_f32_16x16x32_bf16 v[4:7], v[168:171], v[48:51], v[4:7]
    s_waitcnt vmcnt(3)
    v_mfma_f32_16x16x32_bf16 v[4:7], v[168:171], v[52:55], v[4:7]
    v_add_f32 v76, s88, v76
    v_rcp_f32 v76, v76
    s_waitcnt vmcnt(2)
    v_mfma_f32_16x16x32_bf16 v[4:7], v[168:171], v[56:59], v[4:7]
    s_waitcnt vmcnt(1)
    v_mfma_f32_16x16x32_bf16 v[4:7], v[168:171], v[60:63], v[4:7]
    v_add_f32 v80, s88, v80
    v_rcp_f32 v80, v80
    s_waitcnt vmcnt(0)
    v_mfma_f32_16x16x32_bf16 v[4:7], v[168:171], v[64:67], v[4:7]
    v_add_f32 v84, s88, v84
    v_rcp_f32 v84, v84
    v_add_f32 v88, s88, v88
    v_rcp_f32 v88, v88
    v_add_f32 v92, s88, v92
    v_rcp_f32 v92, v92
    v_add_f32 v96, s88, v96
    v_rcp_f32 v96, v96
    v_cvt_pk_bf16_f32 v164, v4, v5
    v_cvt_pk_bf16_f32 v165, v6, v7
    s_nop 1
    v_mfma_f32_16x16x16_bf16 v[188:191], v[164:165], v[148:149], 0
    v_mfma_f32_16x16x16_bf16 v[192:195], v[164:165], v[150:151], 0
    v_mfma_f32_16x16x16_bf16 v[196:199], v[164:165], v[152:153], 0
    v_mfma_f32_16x16x16_bf16 v[200:203], v[164:165], v[154:155], 0
    v_mfma_f32_16x16x16_bf16 v[204:207], v[164:165], v[156:157], 0
    v_mfma_f32_16x16x16_bf16 v[208:211], v[164:165], v[158:159], 0
    v_mfma_f32_16x16x16_bf16 v[212:215], v[164:165], v[160:161], 0
    v_mfma_f32_16x16x16_bf16 v[216:219], v[164:165], v[162:163], 0
    s_nop 0
    v_mul_f32 v188, v188, v68
    v_mul_f32 v189, v189, v68
    v_mul_f32 v190, v190, v68
    v_mul_f32 v191, v191, v68
    v_mul_f32 v192, v192, v72
    v_mul_f32 v193, v193, v72
    v_mul_f32 v194, v194, v72
    v_mul_f32 v195, v195, v72
    v_cvt_pk_bf16_f32 v100, v188, v189
    v_cvt_pk_bf16_f32 v102, v192, v193
    v_cvt_pk_bf16_f32 v101, v190, v191
    v_cvt_pk_bf16_f32 v103, v194, v195
    v_permlane16_swap_b32 v100, v102
    s_nop 0
    v_permlane16_swap_b32 v101, v103
    buffer_store_dwordx4 v[100:103], v246, s[32:35], s92 offen sc1
    v_mul_f32 v196, v196, v76
    v_mul_f32 v197, v197, v76
    v_mul_f32 v198, v198, v76
    v_mul_f32 v199, v199, v76
    v_mul_f32 v200, v200, v80
    v_mul_f32 v201, v201, v80
    v_mul_f32 v202, v202, v80
    v_mul_f32 v203, v203, v80
    v_cvt_pk_bf16_f32 v104, v196, v197
    v_cvt_pk_bf16_f32 v106, v200, v201
    v_cvt_pk_bf16_f32 v105, v198, v199
    v_cvt_pk_bf16_f32 v107, v202, v203
    v_permlane16_swap_b32 v104, v106
    s_nop 0
    v_permlane16_swap_b32 v105, v107
    buffer_store_dwordx4 v[104:107], v247, s[32:35], s92 offen sc1
    v_mul_f32 v204, v204, v84
    v_mul_f32 v205, v205, v84
    v_mul_f32 v206, v206, v84
    v_mul_f32 v207, v207, v84
    v_mul_f32 v208, v208, v88
    v_mul_f32 v209, v209, v88
    v_mul_f32 v210, v210, v88
    v_mul_f32 v211, v211, v88
    v_cvt_pk_bf16_f32 v108, v204, v205
    v_cvt_pk_bf16_f32 v110, v208, v209
    v_cvt_pk_bf16_f32 v109, v206, v207
    v_cvt_pk_bf16_f32 v111, v210, v211
    v_permlane16_swap_b32 v108, v110
    s_nop 0
    v_permlane16_swap_b32 v109, v111
    buffer_store_dwordx4 v[108:111], v246, s[32:35], s48 offen sc1
    v_mul_f32 v212, v212, v92
    v_mul_f32 v213, v213, v92
    v_mul_f32 v214, v214, v92
    v_mul_f32 v215, v215, v92
    v_mul_f32 v216, v216, v96
    v_mul_f32 v217, v217, v96
    v_mul_f32 v218, v218, v96
    v_mul_f32 v219, v219, v96
    v_cvt_pk_bf16_f32 v112, v212, v213
    v_cvt_pk_bf16_f32 v114, v216, v217
    v_cvt_pk_bf16_f32 v113, v214, v215
    v_cvt_pk_bf16_f32 v115, v218, v219
    v_permlane16_swap_b32 v112, v114
    s_nop 0
    v_permlane16_swap_b32 v113, v115
    buffer_store_dwordx4 v[112:115], v247, s[32:35], s48 offen sc1
    v_readfirstlane_b32 s87, v3
    s_add_u32 s94, s24, s93
    s_addc_u32 s95, s25, 0
    s_waitcnt vmcnt(0)
    s_atomic_swap s87, s[94:95], 0
    s_atomic_swap s87, s[94:95], 2048
    s_atomic_swap s87, s[94:95], 4096
    s_atomic_swap s87, s[94:95], 6144
    s_atomic_swap s87, s[94:95], 16384
    s_atomic_swap s87, s[94:95], 18432
    s_atomic_swap s87, s[94:95], 20480
    s_atomic_swap s87, s[94:95], 22528
    s_waitcnt lgkmcnt(0)
    s_endpgm
L_end:
.section .rodata,"a"
.p2align 6
.amdhsa_kernel parallel_sum__linear_attn_block__dense_activation_squared_relu__prompt_kernel
  .amdhsa_next_free_vgpr 256
  .amdhsa_next_free_sgpr 102
  .amdhsa_accum_offset 256
  .amdhsa_group_segment_fixed_size 0
  .amdhsa_kernarg_size 88
  .amdhsa_user_sgpr_count 2
  .amdhsa_user_sgpr_kernarg_segment_ptr 1
  .amdhsa_system_sgpr_workgroup_id_x 1
.end_amdhsa_kernel
```
